```python
import torch

def _softmax(x, axis=-1):
    return torch.softmax(x, dim=axis)
def _gelu(x):
    return torch.nn.functional.gelu(x, approximate="tanh")
def _silu(x):
    return torch.nn.functional.silu(x)
def _sigmoid(x):
    return torch.sigmoid(x)
def _layernorm(x, axis=-1, eps=1e-5):
    m = x.mean(dim=axis, keepdim=True)
    v = x.var(dim=axis, keepdim=True, unbiased=False)
    return (x - m) / torch.sqrt(v + eps)
def _scatter_add(tgt, idx, src, axis=0):
    return tgt.clone().index_add_(axis, idx, src)
def _segment_sum(src, seg, n):
    out = torch.zeros((n,) + src.shape[1:], dtype=src.dtype)
    return out.index_add_(0, seg, src)
def _pad(x, pw):
    flat = tuple(v for pair in reversed(pw) for v in pair)
    return torch.nn.functional.pad(x, flat)

kernel_name = 'sequential_preLN__sliding_local_dilated__glu_gated_bilinear__prompt'

def setup_inputs():

    _w = (lambda a: (lambda t: t.to(torch.bfloat16) if t.is_floating_point() else t)(torch.as_tensor(a)))
    def _A_setup():
        B, S, D = 1, 2048, 640
        return {
            "x": _w((lambda *s: torch.randn(*s, dtype=torch.bfloat16) * 0.05)(B, S, D)),
            "wqkv": _w((lambda *s: torch.randn(*s, dtype=torch.bfloat16) * 0.05)(D, 3 * D)),
            "wo": _w((lambda *s: torch.randn(*s, dtype=torch.bfloat16) * 0.05)(D, D)),
        }
    _A_in = _A_setup()

    def _B_setup():
        B, S, D, F = 1, 2048, 640, 1728
        return {
            "x": _w((lambda *s: torch.randn(*s, dtype=torch.bfloat16) * 0.05)(B, S, D)),
            "w_gate": _w((lambda *s: torch.randn(*s, dtype=torch.bfloat16) * 0.8)(D, F) * (D ** -0.5)),
            "w_up": _w((lambda *s: torch.randn(*s, dtype=torch.bfloat16) * 0.8)(D, F) * (D ** -0.5)),
            "w_down": _w((lambda *s: torch.randn(*s, dtype=torch.bfloat16) * 0.8)(F, D) * (F ** -0.5)),
        }
    _B_in = _B_setup()

    return {
        "A_x": _A_in["x"],
        "A_wqkv": _A_in["wqkv"],
        "A_wo": _A_in["wo"],
        "B_x": _B_in["x"],
        "B_w_gate": _B_in["w_gate"],
        "B_w_up": _B_in["w_up"],
        "B_w_down": _B_in["w_down"],
    }

def reference(A_x, A_wqkv, A_wo, B_x, B_w_gate, B_w_up, B_w_down):
    def _A_ref(x, wqkv, wo):
        B, S, D = x.shape
        H = 32; Dh = D // H
        W, dil = 8, 2
        qkv = (lambda x, *d: x.permute(*d))((x @ wqkv).reshape(B, S, 3, H, Dh), 2, 0, 3, 1, 4)
        q, k, v = qkv[0], qkv[1], qkv[2]
        scale = Dh ** -0.5
        pos = torch.arange(S)
        off = torch.arange(W) * dil
        idx = pos[:, None] - off[None, :]
        mask = idx >= 0
        idx_c = torch.where(mask, idx, 0).reshape(-1)
        kg = k[:, :, idx_c, :].reshape(B, H, S, W, Dh)
        vg = v[:, :, idx_c, :].reshape(B, H, S, W, Dh)
        logits = torch.einsum("bhsd,bhswd->bhsw", q, kg) * scale
        logits = torch.where(mask[None, None, :, :], logits, -1e9)
        attn = _softmax(logits, axis=-1)
        o = torch.einsum("bhsw,bhswd->bhsd", attn, vg)
        return (lambda x, *d: x.permute(*d))(o, 0, 2, 1, 3).reshape(B, S, D) @ wo

    def _B_ref(x, w_gate, w_up, w_down):
        g = torch.einsum("bsd,df->bsf", x, w_gate)
        u = torch.einsum("bsd,df->bsf", x, w_up)
        h = g * u
        return torch.einsum("bsf,fd->bsd", h, w_down)

    x = A_x
    h = x + _A_ref(_layernorm(x, axis=-1), A_wqkv, A_wo)
    h2 = h + _B_ref(_layernorm(h, axis=-1), B_w_gate, B_w_up, B_w_down)
    return h2
```

```asm
; @launch grid=(256,1,1) block=(512,1,1) lds=163840
.amdgcn_target "amdgcn-amd-amdhsa--gfx950"
.text
.globl sequential_preLN__sliding_local_dilated__glu_gated_bilinear__prompt_kernel
.p2align 8
.type sequential_preLN__sliding_local_dilated__glu_gated_bilinear__prompt_kernel,@function
sequential_preLN__sliding_local_dilated__glu_gated_bilinear__prompt_kernel:
    s_cmp_ge_u32 s2, 256
    s_cbranch_scc1 P_end
    s_load_dwordx16 s[16:31], s[0:1], 0
    s_load_dwordx4 s[32:35], s[0:1], 64
    v_and_b32 v1, 63, v0
    v_lshrrev_b32 v2, 6, v0
    s_nop 0
    v_readfirstlane_b32 s3, v2
    s_and_b32 s36, s2, 7
    s_lshr_b32 s37, s2, 3
    s_lshr_b32 s38, s36, 1
    s_lshl_b32 s39, s38, 2
    s_lshr_b32 s40, s37, 3
    s_add_u32 s56, s39, s40
    s_and_b32 s36, s36, 1
    s_lshl_b32 s39, s36, 3
    s_and_b32 s40, s37, 7
    s_add_u32 s57, s39, s40
    s_lshr_b32 s40, s37, 2
    s_and_b32 s40, s40, 1
    s_lshl_b32 s39, s56, 1
    s_add_u32 s58, s39, s40
    s_lshl_b32 s39, s36, 2
    s_and_b32 s40, s37, 3
    s_add_u32 s59, s39, s40
    s_waitcnt lgkmcnt(0)
    s_mov_b32 s36, 37748736
    s_load_dword s60, s[34:35], s36
    s_mov_b32 s8, s34
    s_mov_b32 s9, s35
    s_mov_b32 s10, 268435456
    s_mov_b32 s11, 0x00020000
    s_lshr_b32 s36, s2, 3
    s_cmp_ge_u32 s36, 4
    s_cbranch_scc1 sequential_preLN__sliding_local_dilated__glu_gated_bilinear__prompt_kernel_cpf1
    s_cmp_lg_u32 s3, 7
    s_cbranch_scc1 sequential_preLN__sliding_local_dilated__glu_gated_bilinear__prompt_kernel_cpf1
    s_getpc_b64 s[38:39]
P_pc:
    s_mul_i32 s36, s36, 16384
    v_lshlrev_b32 v5, 7, v1
    v_add_u32 v5, s36, v5
    v_min_u32 v6, P_end-P_pc-4, v5
    global_load_dword v127, v6, s[38:39]
    v_add_u32 v5, 0x2000, v5
    v_min_u32 v6, P_end-P_pc-4, v5
    global_load_dword v127, v6, s[38:39]
    v_add_u32 v5, 0x2000, v5
sequential_preLN__sliding_local_dilated__glu_gated_bilinear__prompt_kernel_cpf1:
    s_cmp_ge_u32 s3, 4
    s_cbranch_scc1 P_B
    s_setprio 3
    s_mov_b32 s4, s18
    s_mov_b32 s5, s19
    s_mov_b32 s6, 2457600
    s_mov_b32 s7, 0x00020000
    v_and_b32 v2, 15, v1
    v_lshrrev_b32 v3, 4, v1
    v_mul_u32_u24 v4, 0x7800, v3
    s_mul_i32 s39, s57, 80
    v_add_u32 v4, s39, v4
    v_and_b32 v5, 3, v2
    v_lshl_add_u32 v4, v5, 2, v4
    v_lshrrev_b32 v5, 2, v2
    s_movk_i32 s41, 3840
    s_movk_i32 s42, 7680
    s_movk_i32 s43, 11520
    s_movk_i32 s44, 15360
    s_movk_i32 s45, 19200
    s_movk_i32 s46, 23040
    s_movk_i32 s47, 26880
    s_mov_b32 s40, 0
    s_mul_i32 s50, s56, 5
    s_add_u32 s50, s50, s3
    s_cmp_eq_u32 s3, 3
    s_cselect_b32 s36, 1, 0
    s_add_u32 s50, s50, s36
    v_lshlrev_b32 v9, 4, v1
    s_add_u32 s52, s50, 0
    s_lshr_b32 s53, s52, 2
    s_and_b32 s54, s52, 3
    s_lshl_b32 s55, s54, 2
    v_add_u32 v6, s55, v5
    v_mul_u32_u24 v7, 52, v6
    v_lshrrev_b32 v7, 8, v7
    v_mul_u32_u24 v8, 5, v7
    v_sub_u32 v8, v6, v8
    v_mul_u32_u24 v7, 0x500, v7
    v_lshl_add_u32 v7, v8, 4, v7
    v_add_u32 v10, v4, v7
    s_mul_i32 s55, s53, 122880
    v_add_u32 v10, s55, v10
    v_mov_b32 v7, 0x80000000
    v_cmp_eq_u32 vcc, 15, v6
    s_mul_i32 s55, s57, 20
    s_add_u32 s55, s55, s53
    v_cndmask_b32 v10, v10, v7, vcc
    s_lshl_b32 s55, s55, 3
    s_lshl_b32 s54, s54, 1
    s_add_u32 s55, s55, s54
    s_lshl_b32 s55, s55, 10
    s_add_u32 s61, s55, 4194304
    buffer_load_dword v16, v10, s[4:7], s40 offen
    buffer_load_dword v17, v10, s[4:7], s41 offen
    buffer_load_dword v18, v10, s[4:7], s42 offen
    buffer_load_dword v19, v10, s[4:7], s43 offen
    buffer_load_dword v20, v10, s[4:7], s44 offen
    buffer_load_dword v21, v10, s[4:7], s45 offen
    buffer_load_dword v22, v10, s[4:7], s46 offen
    buffer_load_dword v23, v10, s[4:7], s47 offen
    s_cmp_lg_u32 s3, 2
    s_cbranch_scc1 P_as1
    s_add_u32 s52, s50, 1
    s_lshr_b32 s53, s52, 2
    s_and_b32 s54, s52, 3
    s_lshl_b32 s55, s54, 2
    v_add_u32 v6, s55, v5
    v_mul_u32_u24 v7, 52, v6
    v_lshrrev_b32 v7, 8, v7
    v_mul_u32_u24 v8, 5, v7
    v_sub_u32 v8, v6, v8
    v_mul_u32_u24 v7, 0x500, v7
    v_lshl_add_u32 v7, v8, 4, v7
    v_add_u32 v11, v4, v7
    s_mul_i32 s55, s53, 122880
    v_add_u32 v11, s55, v11
    v_mov_b32 v7, 0x80000000
    v_cmp_eq_u32 vcc, 15, v6
    s_mul_i32 s55, s57, 20
    s_add_u32 s55, s55, s53
    v_cndmask_b32 v11, v11, v7, vcc
    s_lshl_b32 s55, s55, 3
    s_lshl_b32 s54, s54, 1
    s_add_u32 s55, s55, s54
    s_lshl_b32 s55, s55, 10
    s_add_u32 s62, s55, 4194304
    buffer_load_dword v24, v11, s[4:7], s40 offen
    buffer_load_dword v25, v11, s[4:7], s41 offen
    buffer_load_dword v26, v11, s[4:7], s42 offen
    buffer_load_dword v27, v11, s[4:7], s43 offen
    buffer_load_dword v28, v11, s[4:7], s44 offen
    buffer_load_dword v29, v11, s[4:7], s45 offen
    buffer_load_dword v30, v11, s[4:7], s46 offen
    buffer_load_dword v31, v11, s[4:7], s47 offen
P_as1:
    s_barrier
    s_waitcnt vmcnt(0)
    s_mov_b32 s48, 0x05040100
    s_mov_b32 s49, 0x07060302
    v_perm_b32 v80, v17, v16, s48
    v_perm_b32 v84, v17, v16, s49
    v_perm_b32 v81, v19, v18, s48
    v_perm_b32 v85, v19, v18, s49
    v_perm_b32 v82, v21, v20, s48
    v_perm_b32 v86, v21, v20, s49
    v_perm_b32 v83, v23, v22, s48
    v_perm_b32 v87, v23, v22, s49
    buffer_store_dwordx4 v[80:83], v9, s[8:11], s61 offen sc1
    buffer_store_dwordx4 v[84:87], v9, s[8:11], s61 offen offset:1024 sc1
    s_cmp_lg_u32 s3, 2
    s_cbranch_scc1 P_as4
    v_perm_b32 v88, v25, v24, s48
    v_perm_b32 v92, v25, v24, s49
    v_perm_b32 v89, v27, v26, s48
    v_perm_b32 v93, v27, v26, s49
    v_perm_b32 v90, v29, v28, s48
    v_perm_b32 v94, v29, v28, s49
    v_perm_b32 v91, v31, v30, s48
    v_perm_b32 v95, v31, v30, s49
    buffer_store_dwordx4 v[88:91], v9, s[8:11], s62 offen sc1
    buffer_store_dwordx4 v[92:95], v9, s[8:11], s62 offen offset:1024 sc1
P_as4:
    s_waitcnt vmcnt(0) lgkmcnt(0)
    s_add_u32 s60, s60, 1
    s_lshl_b32 s40, s57, 6
    s_lshl_b32 s41, s56, 2
    s_add_u32 s40, s40, s41
    s_add_u32 s40, s40, s3
    s_lshl_b32 s40, s40, 1
    s_lshl_b32 s36, s40, 2
    s_add_u32 s36, s36, 37945344
    v_mov_b32 v3, s60
    v_mov_b32 v4, 0
    s_mov_b64 s[38:39], exec
    s_mov_b64 exec, 1
    buffer_atomic_swap v3, v4, s[8:11], s36 offen sc1
    s_mov_b64 exec, s[38:39]
    v_and_b32 v9, 15, v1
    v_lshrrev_b32 v10, 4, v1
    v_and_b32 v11, 7, v9
    v_xor_b32 v12, v10, v11
    v_lshlrev_b32 v12, 4, v12
    v_lshl_add_u32 v4, v9, 7, v12
    v_xor_b32 v5, 64, v4
    v_add_u32 v6, 55296, v4
    v_add_u32 v7, 55296, v5
    s_lshl_b32 s42, s3, 11
    s_add_u32 s42, s42, 92160
    v_lshl_add_u32 v8, v1, 4, s42
    v_mov_b32 v32, 0
    v_mov_b32 v33, 0
    v_mov_b32 v34, 0
    v_mov_b32 v35, 0
    v_mov_b32 v36, 0
    v_mov_b32 v37, 0
    v_mov_b32 v38, 0
    v_mov_b32 v39, 0
    v_mov_b32 v40, 0
    v_mov_b32 v41, 0
    v_mov_b32 v42, 0
    v_mov_b32 v43, 0
    v_mov_b32 v44, 0
    v_mov_b32 v45, 0
    v_mov_b32 v46, 0
    v_mov_b32 v47, 0
    v_mov_b32 v48, 0
    v_mov_b32 v49, 0
    v_mov_b32 v50, 0
    v_mov_b32 v51, 0
    v_mov_b32 v52, 0
    v_mov_b32 v53, 0
    v_mov_b32 v54, 0
    v_mov_b32 v55, 0
    v_mov_b32 v56, 0
    v_mov_b32 v57, 0
    v_mov_b32 v58, 0
    v_mov_b32 v59, 0
    v_mov_b32 v60, 0
    v_mov_b32 v61, 0
    v_mov_b32 v62, 0
    v_mov_b32 v63, 0
    v_mov_b32 v64, 0
    v_mov_b32 v65, 0
    v_mov_b32 v66, 0
    v_mov_b32 v67, 0
    v_mov_b32 v68, 0
    v_mov_b32 v69, 0
    v_mov_b32 v70, 0
    v_mov_b32 v71, 0
    v_mov_b32 v72, 0
    v_mov_b32 v73, 0
    v_mov_b32 v74, 0
    v_mov_b32 v75, 0
    v_mov_b32 v76, 0
    v_mov_b32 v77, 0
    v_mov_b32 v78, 0
    v_mov_b32 v79, 0
    v_mov_b32 v80, 0
    v_mov_b32 v81, 0
    v_mov_b32 v82, 0
    v_mov_b32 v83, 0
    v_mov_b32 v84, 0
    v_mov_b32 v85, 0
    v_mov_b32 v86, 0
    v_mov_b32 v87, 0
    v_mov_b32 v88, 0
    v_mov_b32 v89, 0
    v_mov_b32 v90, 0
    v_mov_b32 v91, 0
    v_mov_b32 v92, 0
    v_mov_b32 v93, 0
    v_mov_b32 v94, 0
    v_mov_b32 v95, 0
    v_mov_b32 v96, 0
    v_mov_b32 v97, 0
    v_mov_b32 v98, 0
    v_mov_b32 v99, 0
    v_mov_b32 v100, 0
    v_mov_b32 v101, 0
    v_mov_b32 v102, 0
    v_mov_b32 v103, 0
    s_cmp_lg_u32 s3, 2
    s_cbranch_scc1 sequential_preLN__sliding_local_dilated__glu_gated_bilinear__prompt_kernel_ones2
    v_lshlrev_b32 v12, 4, v1
    v_mov_b32 v104, 0x3f803f80
    v_mov_b32 v105, 0x3f803f80
    v_mov_b32 v106, 0x3f803f80
    v_mov_b32 v107, 0x3f803f80
    s_mov_b64 exec, 0xff
    ds_write_b128 v12, v[104:107] offset:0
    ds_write_b128 v12, v[104:107] offset:18432
    ds_write_b128 v12, v[104:107] offset:36864
    ds_write_b128 v12, v[104:107] offset:55296
    v_add_u32 v13, 73728, v12
    ds_write_b128 v13, v[104:107]
    s_mov_b64 exec, -1
    s_waitcnt lgkmcnt(0)
sequential_preLN__sliding_local_dilated__glu_gated_bilinear__prompt_kernel_ones2:
    s_barrier
    s_setprio 2
    ds_read_b128 a[0:3], v8 offset:0
    ds_read_b128 a[4:7], v8 offset:1024
    ds_read_b128 v[104:107], v4 offset:0
    ds_read_b128 v[108:111], v4 offset:2048
    ds_read_b128 v[112:115], v4 offset:4096
    ds_read_b128 v[116:119], v4 offset:6144
    s_waitcnt lgkmcnt(3)
    v_mfma_f32_16x16x32_bf16 v[32:35], a[0:3], v[104:107], v[32:35]
    v_mfma_f32_16x16x32_bf16 v[68:71], a[4:7], v[104:107], v[68:71]
    ds_read_b128 v[104:107], v4 offset:8192
    s_waitcnt lgkmcnt(3)
    v_mfma_f32_16x16x32_bf16 v[36:39], a[0:3], v[108:111], v[36:39]
    v_mfma_f32_16x16x32_bf16 v[72:75], a[4:7], v[108:111], v[72:75]
    ds_read_b128 v[108:111], v4 offset:10240
    s_waitcnt lgkmcnt(3)
    v_mfma_f32_16x16x32_bf16 v[40:43], a[0:3], v[112:115], v[40:43]
    v_mfma_f32_16x16x32_bf16 v[76:79], a[4:7], v[112:115], v[76:79]
    ds_read_b128 v[112:115], v4 offset:12288
    s_waitcnt lgkmcnt(3)
    v_mfma_f32_16x16x32_bf16 v[44:47], a[0:3], v[116:119], v[44:47]
    v_mfma_f32_16x16x32_bf16 v[80:83], a[4:7], v[116:119], v[80:83]
    ds_read_b128 v[116:119], v4 offset:14336
    s_waitcnt lgkmcnt(3)
    v_mfma_f32_16x16x32_bf16 v[48:51], a[0:3], v[104:107], v[48:51]
    v_mfma_f32_16x16x32_bf16 v[84:87], a[4:7], v[104:107], v[84:87]
    ds_read_b128 v[104:107], v4 offset:16384
    s_waitcnt lgkmcnt(3)
    v_mfma_f32_16x16x32_bf16 v[52:55], a[0:3], v[108:111], v[52:55]
    v_mfma_f32_16x16x32_bf16 v[88:91], a[4:7], v[108:111], v[88:91]
    ds_read_b128 a[8:11], v8 offset:8192
    ds_read_b128 a[12:15], v8 offset:9216
    ds_read_b128 v[108:111], v5 offset:0
    s_waitcnt lgkmcnt(5)
    v_mfma_f32_16x16x32_bf16 v[56:59], a[0:3], v[112:115], v[56:59]
    v_mfma_f32_16x16x32_bf16 v[92:95], a[4:7], v[112:115], v[92:95]
    ds_read_b128 v[112:115], v5 offset:2048
    s_waitcnt lgkmcnt(5)
    v_mfma_f32_16x16x32_bf16 v[60:63], a[0:3], v[116:119], v[60:63]
    v_mfma_f32_16x16x32_bf16 v[96:99], a[4:7], v[116:119], v[96:99]
    ds_read_b128 v[116:119], v5 offset:4096
    s_waitcnt lgkmcnt(5)
    v_mfma_f32_16x16x32_bf16 v[64:67], a[0:3], v[104:107], v[64:67]
    v_mfma_f32_16x16x32_bf16 v[100:103], a[4:7], v[104:107], v[100:103]
    s_barrier
    ds_read_b128 v[104:107], v5 offset:6144
    s_waitcnt lgkmcnt(3)
    v_mfma_f32_16x16x32_bf16 v[32:35], a[8:11], v[108:111], v[32:35]
    v_mfma_f32_16x16x32_bf16 v[68:71], a[12:15], v[108:111], v[68:71]
    ds_read_b128 v[108:111], v5 offset:8192
    s_waitcnt lgkmcnt(3)
    v_mfma_f32_16x16x32_bf16 v[36:39], a[8:11], v[112:115], v[36:39]
    v_mfma_f32_16x16x32_bf16 v[72:75], a[12:15], v[112:115], v[72:75]
    ds_read_b128 v[112:115], v5 offset:10240
    s_waitcnt lgkmcnt(3)
    v_mfma_f32_16x16x32_bf16 v[40:43], a[8:11], v[116:119], v[40:43]
    v_mfma_f32_16x16x32_bf16 v[76:79], a[12:15], v[116:119], v[76:79]
    ds_read_b128 v[116:119], v5 offset:12288
    s_waitcnt lgkmcnt(3)
    v_mfma_f32_16x16x32_bf16 v[44:47], a[8:11], v[104:107], v[44:47]
    v_mfma_f32_16x16x32_bf16 v[80:83], a[12:15], v[104:107], v[80:83]
    ds_read_b128 v[104:107], v5 offset:14336
    s_waitcnt lgkmcnt(3)
    v_mfma_f32_16x16x32_bf16 v[48:51], a[8:11], v[108:111], v[48:51]
    v_mfma_f32_16x16x32_bf16 v[84:87], a[12:15], v[108:111], v[84:87]
    ds_read_b128 v[108:111], v5 offset:16384
    s_waitcnt lgkmcnt(3)
    v_mfma_f32_16x16x32_bf16 v[52:55], a[8:11], v[112:115], v[52:55]
    v_mfma_f32_16x16x32_bf16 v[88:91], a[12:15], v[112:115], v[88:91]
    ds_read_b128 a[0:3], v8 offset:16384
    ds_read_b128 a[4:7], v8 offset:17408
    ds_read_b128 v[112:115], v4 offset:18432
    s_waitcnt lgkmcnt(5)
    v_mfma_f32_16x16x32_bf16 v[56:59], a[8:11], v[116:119], v[56:59]
    v_mfma_f32_16x16x32_bf16 v[92:95], a[12:15], v[116:119], v[92:95]
    ds_read_b128 v[116:119], v4 offset:20480
    s_waitcnt lgkmcnt(5)
    v_mfma_f32_16x16x32_bf16 v[60:63], a[8:11], v[104:107], v[60:63]
    v_mfma_f32_16x16x32_bf16 v[96:99], a[12:15], v[104:107], v[96:99]
    ds_read_b128 v[104:107], v4 offset:22528
    s_waitcnt lgkmcnt(5)
    v_mfma_f32_16x16x32_bf16 v[64:67], a[8:11], v[108:111], v[64:67]
    v_mfma_f32_16x16x32_bf16 v[100:103], a[12:15], v[108:111], v[100:103]
    s_barrier
    ds_read_b128 v[108:111], v4 offset:24576
    s_waitcnt lgkmcnt(3)
    v_mfma_f32_16x16x32_bf16 v[32:35], a[0:3], v[112:115], v[32:35]
    v_mfma_f32_16x16x32_bf16 v[68:71], a[4:7], v[112:115], v[68:71]
    ds_read_b128 v[112:115], v4 offset:26624
    s_waitcnt lgkmcnt(3)
    v_mfma_f32_16x16x32_bf16 v[36:39], a[0:3], v[116:119], v[36:39]
    v_mfma_f32_16x16x32_bf16 v[72:75], a[4:7], v[116:119], v[72:75]
    ds_read_b128 v[116:119], v4 offset:28672
    s_waitcnt lgkmcnt(3)
    v_mfma_f32_16x16x32_bf16 v[40:43], a[0:3], v[104:107], v[40:43]
    v_mfma_f32_16x16x32_bf16 v[76:79], a[4:7], v[104:107], v[76:79]
    ds_read_b128 v[104:107], v4 offset:30720
    s_waitcnt lgkmcnt(3)
    v_mfma_f32_16x16x32_bf16 v[44:47], a[0:3], v[108:111], v[44:47]
    v_mfma_f32_16x16x32_bf16 v[80:83], a[4:7], v[108:111], v[80:83]
    ds_read_b128 v[108:111], v4 offset:32768
    s_waitcnt lgkmcnt(3)
    v_mfma_f32_16x16x32_bf16 v[48:51], a[0:3], v[112:115], v[48:51]
    v_mfma_f32_16x16x32_bf16 v[84:87], a[4:7], v[112:115], v[84:87]
    ds_read_b128 v[112:115], v4 offset:34816
    s_waitcnt lgkmcnt(3)
    v_mfma_f32_16x16x32_bf16 v[52:55], a[0:3], v[116:119], v[52:55]
    v_mfma_f32_16x16x32_bf16 v[88:91], a[4:7], v[116:119], v[88:91]
    ds_read_b128 a[8:11], v8 offset:24576
    ds_read_b128 a[12:15], v8 offset:25600
    ds_read_b128 v[116:119], v5 offset:18432
    s_waitcnt lgkmcnt(5)
    v_mfma_f32_16x16x32_bf16 v[56:59], a[0:3], v[104:107], v[56:59]
    v_mfma_f32_16x16x32_bf16 v[92:95], a[4:7], v[104:107], v[92:95]
    ds_read_b128 v[104:107], v5 offset:20480
    s_waitcnt lgkmcnt(5)
    v_mfma_f32_16x16x32_bf16 v[60:63], a[0:3], v[108:111], v[60:63]
    v_mfma_f32_16x16x32_bf16 v[96:99], a[4:7], v[108:111], v[96:99]
    ds_read_b128 v[108:111], v5 offset:22528
    s_waitcnt lgkmcnt(5)
    v_mfma_f32_16x16x32_bf16 v[64:67], a[0:3], v[112:115], v[64:67]
    v_mfma_f32_16x16x32_bf16 v[100:103], a[4:7], v[112:115], v[100:103]
    s_barrier
    ds_read_b128 v[112:115], v5 offset:24576
    s_waitcnt lgkmcnt(3)
    v_mfma_f32_16x16x32_bf16 v[32:35], a[8:11], v[116:119], v[32:35]
    v_mfma_f32_16x16x32_bf16 v[68:71], a[12:15], v[116:119], v[68:71]
    ds_read_b128 v[116:119], v5 offset:26624
    s_waitcnt lgkmcnt(3)
    v_mfma_f32_16x16x32_bf16 v[36:39], a[8:11], v[104:107], v[36:39]
    v_mfma_f32_16x16x32_bf16 v[72:75], a[12:15], v[104:107], v[72:75]
    ds_read_b128 v[104:107], v5 offset:28672
    s_waitcnt lgkmcnt(3)
    v_mfma_f32_16x16x32_bf16 v[40:43], a[8:11], v[108:111], v[40:43]
    v_mfma_f32_16x16x32_bf16 v[76:79], a[12:15], v[108:111], v[76:79]
    ds_read_b128 v[108:111], v5 offset:30720
    s_waitcnt lgkmcnt(3)
    v_mfma_f32_16x16x32_bf16 v[44:47], a[8:11], v[112:115], v[44:47]
    v_mfma_f32_16x16x32_bf16 v[80:83], a[12:15], v[112:115], v[80:83]
    ds_read_b128 v[112:115], v5 offset:32768
    s_waitcnt lgkmcnt(3)
    v_mfma_f32_16x16x32_bf16 v[48:51], a[8:11], v[116:119], v[48:51]
    v_mfma_f32_16x16x32_bf16 v[84:87], a[12:15], v[116:119], v[84:87]
    ds_read_b128 v[116:119], v5 offset:34816
    s_waitcnt lgkmcnt(3)
    v_mfma_f32_16x16x32_bf16 v[52:55], a[8:11], v[104:107], v[52:55]
    v_mfma_f32_16x16x32_bf16 v[88:91], a[12:15], v[104:107], v[88:91]
    ds_read_b128 a[0:3], v8 offset:32768
    ds_read_b128 a[4:7], v8 offset:33792
    ds_read_b128 v[104:107], v4 offset:36864
    s_waitcnt lgkmcnt(5)
    v_mfma_f32_16x16x32_bf16 v[56:59], a[8:11], v[108:111], v[56:59]
    v_mfma_f32_16x16x32_bf16 v[92:95], a[12:15], v[108:111], v[92:95]
    ds_read_b128 v[108:111], v4 offset:38912
    s_waitcnt lgkmcnt(5)
    v_mfma_f32_16x16x32_bf16 v[60:63], a[8:11], v[112:115], v[60:63]
    v_mfma_f32_16x16x32_bf16 v[96:99], a[12:15], v[112:115], v[96:99]
    ds_read_b128 v[112:115], v4 offset:40960
    s_waitcnt lgkmcnt(5)
    v_mfma_f32_16x16x32_bf16 v[64:67], a[8:11], v[116:119], v[64:67]
    v_mfma_f32_16x16x32_bf16 v[100:103], a[12:15], v[116:119], v[100:103]
    s_barrier
    ds_read_b128 v[116:119], v4 offset:43008
    s_waitcnt lgkmcnt(3)
    v_mfma_f32_16x16x32_bf16 v[32:35], a[0:3], v[104:107], v[32:35]
    v_mfma_f32_16x16x32_bf16 v[68:71], a[4:7], v[104:107], v[68:71]
    ds_read_b128 v[104:107], v4 offset:45056
    s_waitcnt lgkmcnt(3)
    v_mfma_f32_16x16x32_bf16 v[36:39], a[0:3], v[108:111], v[36:39]
    v_mfma_f32_16x16x32_bf16 v[72:75], a[4:7], v[108:111], v[72:75]
    ds_read_b128 v[108:111], v4 offset:47104
    s_waitcnt lgkmcnt(3)
    v_mfma_f32_16x16x32_bf16 v[40:43], a[0:3], v[112:115], v[40:43]
    v_mfma_f32_16x16x32_bf16 v[76:79], a[4:7], v[112:115], v[76:79]
    ds_read_b128 v[112:115], v4 offset:49152
    s_waitcnt lgkmcnt(3)
    v_mfma_f32_16x16x32_bf16 v[44:47], a[0:3], v[116:119], v[44:47]
    v_mfma_f32_16x16x32_bf16 v[80:83], a[4:7], v[116:119], v[80:83]
    ds_read_b128 v[116:119], v4 offset:51200
    s_waitcnt lgkmcnt(3)
    v_mfma_f32_16x16x32_bf16 v[48:51], a[0:3], v[104:107], v[48:51]
    v_mfma_f32_16x16x32_bf16 v[84:87], a[4:7], v[104:107], v[84:87]
    ds_read_b128 v[104:107], v4 offset:53248
    s_waitcnt lgkmcnt(3)
    v_mfma_f32_16x16x32_bf16 v[52:55], a[0:3], v[108:111], v[52:55]
    v_mfma_f32_16x16x32_bf16 v[88:91], a[4:7], v[108:111], v[88:91]
    ds_read_b128 a[8:11], v8 offset:40960
    ds_read_b128 a[12:15], v8 offset:41984
    ds_read_b128 v[108:111], v5 offset:36864
    s_waitcnt lgkmcnt(5)
    v_mfma_f32_16x16x32_bf16 v[56:59], a[0:3], v[112:115], v[56:59]
    v_mfma_f32_16x16x32_bf16 v[92:95], a[4:7], v[112:115], v[92:95]
    ds_read_b128 v[112:115], v5 offset:38912
    s_waitcnt lgkmcnt(5)
    v_mfma_f32_16x16x32_bf16 v[60:63], a[0:3], v[116:119], v[60:63]
    v_mfma_f32_16x16x32_bf16 v[96:99], a[4:7], v[116:119], v[96:99]
    ds_read_b128 v[116:119], v5 offset:40960
    s_waitcnt lgkmcnt(5)
    v_mfma_f32_16x16x32_bf16 v[64:67], a[0:3], v[104:107], v[64:67]
    v_mfma_f32_16x16x32_bf16 v[100:103], a[4:7], v[104:107], v[100:103]
    s_barrier
    ds_read_b128 v[104:107], v5 offset:43008
    s_waitcnt lgkmcnt(3)
    v_mfma_f32_16x16x32_bf16 v[32:35], a[8:11], v[108:111], v[32:35]
    v_mfma_f32_16x16x32_bf16 v[68:71], a[12:15], v[108:111], v[68:71]
    ds_read_b128 v[108:111], v5 offset:45056
    s_waitcnt lgkmcnt(3)
    v_mfma_f32_16x16x32_bf16 v[36:39], a[8:11], v[112:115], v[36:39]
    v_mfma_f32_16x16x32_bf16 v[72:75], a[12:15], v[112:115], v[72:75]
    ds_read_b128 v[112:115], v5 offset:47104
    s_waitcnt lgkmcnt(3)
    v_mfma_f32_16x16x32_bf16 v[40:43], a[8:11], v[116:119], v[40:43]
    v_mfma_f32_16x16x32_bf16 v[76:79], a[12:15], v[116:119], v[76:79]
    ds_read_b128 v[116:119], v5 offset:49152
    s_waitcnt lgkmcnt(3)
    v_mfma_f32_16x16x32_bf16 v[44:47], a[8:11], v[104:107], v[44:47]
    v_mfma_f32_16x16x32_bf16 v[80:83], a[12:15], v[104:107], v[80:83]
    ds_read_b128 v[104:107], v5 offset:51200
    s_waitcnt lgkmcnt(3)
    v_mfma_f32_16x16x32_bf16 v[48:51], a[8:11], v[108:111], v[48:51]
    v_mfma_f32_16x16x32_bf16 v[84:87], a[12:15], v[108:111], v[84:87]
    ds_read_b128 v[108:111], v5 offset:53248
    s_waitcnt lgkmcnt(3)
    v_mfma_f32_16x16x32_bf16 v[52:55], a[8:11], v[112:115], v[52:55]
    v_mfma_f32_16x16x32_bf16 v[88:91], a[12:15], v[112:115], v[88:91]
    ds_read_b128 a[0:3], v8 offset:49152
    ds_read_b128 a[4:7], v8 offset:50176
    ds_read_b128 v[112:115], v6 offset:0
    s_waitcnt lgkmcnt(5)
    v_mfma_f32_16x16x32_bf16 v[56:59], a[8:11], v[116:119], v[56:59]
    v_mfma_f32_16x16x32_bf16 v[92:95], a[12:15], v[116:119], v[92:95]
    ds_read_b128 v[116:119], v6 offset:2048
    s_waitcnt lgkmcnt(5)
    v_mfma_f32_16x16x32_bf16 v[60:63], a[8:11], v[104:107], v[60:63]
    v_mfma_f32_16x16x32_bf16 v[96:99], a[12:15], v[104:107], v[96:99]
    ds_read_b128 v[104:107], v6 offset:4096
    s_waitcnt lgkmcnt(5)
    v_mfma_f32_16x16x32_bf16 v[64:67], a[8:11], v[108:111], v[64:67]
    v_mfma_f32_16x16x32_bf16 v[100:103], a[12:15], v[108:111], v[100:103]
    s_barrier
    ds_read_b128 v[108:111], v6 offset:6144
    s_waitcnt lgkmcnt(3)
    v_mfma_f32_16x16x32_bf16 v[32:35], a[0:3], v[112:115], v[32:35]
    v_mfma_f32_16x16x32_bf16 v[68:71], a[4:7], v[112:115], v[68:71]
    ds_read_b128 v[112:115], v6 offset:8192
    s_waitcnt lgkmcnt(3)
    v_mfma_f32_16x16x32_bf16 v[36:39], a[0:3], v[116:119], v[36:39]
    v_mfma_f32_16x16x32_bf16 v[72:75], a[4:7], v[116:119], v[72:75]
    ds_read_b128 v[116:119], v6 offset:10240
    s_waitcnt lgkmcnt(3)
    v_mfma_f32_16x16x32_bf16 v[40:43], a[0:3], v[104:107], v[40:43]
    v_mfma_f32_16x16x32_bf16 v[76:79], a[4:7], v[104:107], v[76:79]
    ds_read_b128 v[104:107], v6 offset:12288
    s_waitcnt lgkmcnt(3)
    v_mfma_f32_16x16x32_bf16 v[44:47], a[0:3], v[108:111], v[44:47]
    v_mfma_f32_16x16x32_bf16 v[80:83], a[4:7], v[108:111], v[80:83]
    ds_read_b128 v[108:111], v6 offset:14336
    s_waitcnt lgkmcnt(3)
    v_mfma_f32_16x16x32_bf16 v[48:51], a[0:3], v[112:115], v[48:51]
    v_mfma_f32_16x16x32_bf16 v[84:87], a[4:7], v[112:115], v[84:87]
    ds_read_b128 v[112:115], v6 offset:16384
    s_waitcnt lgkmcnt(3)
    v_mfma_f32_16x16x32_bf16 v[52:55], a[0:3], v[116:119], v[52:55]
    v_mfma_f32_16x16x32_bf16 v[88:91], a[4:7], v[116:119], v[88:91]
    ds_read_b128 a[8:11], v8 offset:57344
    ds_read_b128 a[12:15], v8 offset:58368
    ds_read_b128 v[116:119], v7 offset:0
    s_waitcnt lgkmcnt(5)
    v_mfma_f32_16x16x32_bf16 v[56:59], a[0:3], v[104:107], v[56:59]
    v_mfma_f32_16x16x32_bf16 v[92:95], a[4:7], v[104:107], v[92:95]
    ds_read_b128 v[104:107], v7 offset:2048
    s_waitcnt lgkmcnt(5)
    v_mfma_f32_16x16x32_bf16 v[60:63], a[0:3], v[108:111], v[60:63]
    v_mfma_f32_16x16x32_bf16 v[96:99], a[4:7], v[108:111], v[96:99]
    ds_read_b128 v[108:111], v7 offset:4096
    s_waitcnt lgkmcnt(5)
    v_mfma_f32_16x16x32_bf16 v[64:67], a[0:3], v[112:115], v[64:67]
    v_mfma_f32_16x16x32_bf16 v[100:103], a[4:7], v[112:115], v[100:103]
    s_barrier
    ds_read_b128 v[112:115], v7 offset:6144
    s_waitcnt lgkmcnt(3)
    v_mfma_f32_16x16x32_bf16 v[32:35], a[8:11], v[116:119], v[32:35]
    v_mfma_f32_16x16x32_bf16 v[68:71], a[12:15], v[116:119], v[68:71]
    ds_read_b128 v[116:119], v7 offset:8192
    s_waitcnt lgkmcnt(3)
    v_mfma_f32_16x16x32_bf16 v[36:39], a[8:11], v[104:107], v[36:39]
    v_mfma_f32_16x16x32_bf16 v[72:75], a[12:15], v[104:107], v[72:75]
    ds_read_b128 v[104:107], v7 offset:10240
    s_waitcnt lgkmcnt(3)
    v_mfma_f32_16x16x32_bf16 v[40:43], a[8:11], v[108:111], v[40:43]
    v_mfma_f32_16x16x32_bf16 v[76:79], a[12:15], v[108:111], v[76:79]
    ds_read_b128 v[108:111], v7 offset:12288
    s_waitcnt lgkmcnt(3)
    v_mfma_f32_16x16x32_bf16 v[44:47], a[8:11], v[112:115], v[44:47]
    v_mfma_f32_16x16x32_bf16 v[80:83], a[12:15], v[112:115], v[80:83]
    ds_read_b128 v[112:115], v7 offset:14336
    s_waitcnt lgkmcnt(3)
    v_mfma_f32_16x16x32_bf16 v[48:51], a[8:11], v[116:119], v[48:51]
    v_mfma_f32_16x16x32_bf16 v[84:87], a[12:15], v[116:119], v[84:87]
    ds_read_b128 v[116:119], v7 offset:16384
    s_waitcnt lgkmcnt(3)
    v_mfma_f32_16x16x32_bf16 v[52:55], a[8:11], v[104:107], v[52:55]
    v_mfma_f32_16x16x32_bf16 v[88:91], a[12:15], v[104:107], v[88:91]
    ds_read_b128 a[0:3], v8 offset:0
    ds_read_b128 a[4:7], v8 offset:1024
    ds_read_b128 v[104:107], v6 offset:18432
    s_waitcnt lgkmcnt(5)
    v_mfma_f32_16x16x32_bf16 v[56:59], a[8:11], v[108:111], v[56:59]
    v_mfma_f32_16x16x32_bf16 v[92:95], a[12:15], v[108:111], v[92:95]
    ds_read_b128 v[108:111], v6 offset:20480
    s_waitcnt lgkmcnt(5)
    v_mfma_f32_16x16x32_bf16 v[60:63], a[8:11], v[112:115], v[60:63]
    v_mfma_f32_16x16x32_bf16 v[96:99], a[12:15], v[112:115], v[96:99]
    ds_read_b128 v[112:115], v6 offset:22528
    s_waitcnt lgkmcnt(5)
    v_mfma_f32_16x16x32_bf16 v[64:67], a[8:11], v[116:119], v[64:67]
    v_mfma_f32_16x16x32_bf16 v[100:103], a[12:15], v[116:119], v[100:103]
    s_barrier
    ds_read_b128 v[116:119], v6 offset:24576
    s_waitcnt lgkmcnt(3)
    v_mfma_f32_16x16x32_bf16 v[32:35], a[0:3], v[104:107], v[32:35]
    v_mfma_f32_16x16x32_bf16 v[68:71], a[4:7], v[104:107], v[68:71]
    ds_read_b128 v[104:107], v6 offset:26624
    s_waitcnt lgkmcnt(3)
    v_mfma_f32_16x16x32_bf16 v[36:39], a[0:3], v[108:111], v[36:39]
    v_mfma_f32_16x16x32_bf16 v[72:75], a[4:7], v[108:111], v[72:75]
    ds_read_b128 v[108:111], v6 offset:28672
    s_waitcnt lgkmcnt(3)
    v_mfma_f32_16x16x32_bf16 v[40:43], a[0:3], v[112:115], v[40:43]
    v_mfma_f32_16x16x32_bf16 v[76:79], a[4:7], v[112:115], v[76:79]
    ds_read_b128 v[112:115], v6 offset:30720
    s_waitcnt lgkmcnt(3)
    v_mfma_f32_16x16x32_bf16 v[44:47], a[0:3], v[116:119], v[44:47]
    v_mfma_f32_16x16x32_bf16 v[80:83], a[4:7], v[116:119], v[80:83]
    ds_read_b128 v[116:119], v6 offset:32768
    s_waitcnt lgkmcnt(3)
    v_mfma_f32_16x16x32_bf16 v[48:51], a[0:3], v[104:107], v[48:51]
    v_mfma_f32_16x16x32_bf16 v[84:87], a[4:7], v[104:107], v[84:87]
    ds_read_b128 v[104:107], v6 offset:34816
    s_waitcnt lgkmcnt(3)
    v_mfma_f32_16x16x32_bf16 v[52:55], a[0:3], v[108:111], v[52:55]
    v_mfma_f32_16x16x32_bf16 v[88:91], a[4:7], v[108:111], v[88:91]
    ds_read_b128 a[8:11], v8 offset:8192
    ds_read_b128 a[12:15], v8 offset:9216
    ds_read_b128 v[108:111], v7 offset:18432
    s_waitcnt lgkmcnt(5)
    v_mfma_f32_16x16x32_bf16 v[56:59], a[0:3], v[112:115], v[56:59]
    v_mfma_f32_16x16x32_bf16 v[92:95], a[4:7], v[112:115], v[92:95]
    ds_read_b128 v[112:115], v7 offset:20480
    s_waitcnt lgkmcnt(5)
    v_mfma_f32_16x16x32_bf16 v[60:63], a[0:3], v[116:119], v[60:63]
    v_mfma_f32_16x16x32_bf16 v[96:99], a[4:7], v[116:119], v[96:99]
    ds_read_b128 v[116:119], v7 offset:22528
    s_waitcnt lgkmcnt(5)
    v_mfma_f32_16x16x32_bf16 v[64:67], a[0:3], v[104:107], v[64:67]
    v_mfma_f32_16x16x32_bf16 v[100:103], a[4:7], v[104:107], v[100:103]
    s_barrier
    ds_read_b128 v[104:107], v7 offset:24576
    s_waitcnt lgkmcnt(3)
    v_mfma_f32_16x16x32_bf16 v[32:35], a[8:11], v[108:111], v[32:35]
    v_mfma_f32_16x16x32_bf16 v[68:71], a[12:15], v[108:111], v[68:71]
    ds_read_b128 v[108:111], v7 offset:26624
    s_waitcnt lgkmcnt(3)
    v_mfma_f32_16x16x32_bf16 v[36:39], a[8:11], v[112:115], v[36:39]
    v_mfma_f32_16x16x32_bf16 v[72:75], a[12:15], v[112:115], v[72:75]
    ds_read_b128 v[112:115], v7 offset:28672
    s_waitcnt lgkmcnt(3)
    v_mfma_f32_16x16x32_bf16 v[40:43], a[8:11], v[116:119], v[40:43]
    v_mfma_f32_16x16x32_bf16 v[76:79], a[12:15], v[116:119], v[76:79]
    ds_read_b128 v[116:119], v7 offset:30720
    s_waitcnt lgkmcnt(3)
    v_mfma_f32_16x16x32_bf16 v[44:47], a[8:11], v[104:107], v[44:47]
    v_mfma_f32_16x16x32_bf16 v[80:83], a[12:15], v[104:107], v[80:83]
    ds_read_b128 v[104:107], v7 offset:32768
    s_waitcnt lgkmcnt(3)
    v_mfma_f32_16x16x32_bf16 v[48:51], a[8:11], v[108:111], v[48:51]
    v_mfma_f32_16x16x32_bf16 v[84:87], a[12:15], v[108:111], v[84:87]
    ds_read_b128 v[108:111], v7 offset:34816
    s_waitcnt lgkmcnt(3)
    v_mfma_f32_16x16x32_bf16 v[52:55], a[8:11], v[112:115], v[52:55]
    v_mfma_f32_16x16x32_bf16 v[88:91], a[12:15], v[112:115], v[88:91]
    ds_read_b128 a[0:3], v8 offset:16384
    ds_read_b128 a[4:7], v8 offset:17408
    ds_read_b128 v[112:115], v4 offset:0
    s_waitcnt lgkmcnt(5)
    v_mfma_f32_16x16x32_bf16 v[56:59], a[8:11], v[116:119], v[56:59]
    v_mfma_f32_16x16x32_bf16 v[92:95], a[12:15], v[116:119], v[92:95]
    ds_read_b128 v[116:119], v4 offset:2048
    s_waitcnt lgkmcnt(5)
    v_mfma_f32_16x16x32_bf16 v[60:63], a[8:11], v[104:107], v[60:63]
    v_mfma_f32_16x16x32_bf16 v[96:99], a[12:15], v[104:107], v[96:99]
    ds_read_b128 v[104:107], v4 offset:4096
    s_waitcnt lgkmcnt(5)
    v_mfma_f32_16x16x32_bf16 v[64:67], a[8:11], v[108:111], v[64:67]
    v_mfma_f32_16x16x32_bf16 v[100:103], a[12:15], v[108:111], v[100:103]
    s_barrier
    ds_read_b128 v[108:111], v4 offset:6144
    s_waitcnt lgkmcnt(3)
    v_mfma_f32_16x16x32_bf16 v[32:35], a[0:3], v[112:115], v[32:35]
    v_mfma_f32_16x16x32_bf16 v[68:71], a[4:7], v[112:115], v[68:71]
    ds_read_b128 v[112:115], v4 offset:8192
    s_waitcnt lgkmcnt(3)
    v_mfma_f32_16x16x32_bf16 v[36:39], a[0:3], v[116:119], v[36:39]
    v_mfma_f32_16x16x32_bf16 v[72:75], a[4:7], v[116:119], v[72:75]
    ds_read_b128 v[116:119], v4 offset:10240
    s_waitcnt lgkmcnt(3)
    v_mfma_f32_16x16x32_bf16 v[40:43], a[0:3], v[104:107], v[40:43]
    v_mfma_f32_16x16x32_bf16 v[76:79], a[4:7], v[104:107], v[76:79]
    ds_read_b128 v[104:107], v4 offset:12288
    s_waitcnt lgkmcnt(3)
    v_mfma_f32_16x16x32_bf16 v[44:47], a[0:3], v[108:111], v[44:47]
    v_mfma_f32_16x16x32_bf16 v[80:83], a[4:7], v[108:111], v[80:83]
    ds_read_b128 v[108:111], v4 offset:14336
    s_waitcnt lgkmcnt(3)
    v_mfma_f32_16x16x32_bf16 v[48:51], a[0:3], v[112:115], v[48:51]
    v_mfma_f32_16x16x32_bf16 v[84:87], a[4:7], v[112:115], v[84:87]
    ds_read_b128 v[112:115], v4 offset:16384
    s_waitcnt lgkmcnt(3)
    v_mfma_f32_16x16x32_bf16 v[52:55], a[0:3], v[116:119], v[52:55]
    v_mfma_f32_16x16x32_bf16 v[88:91], a[4:7], v[116:119], v[88:91]
    ds_read_b128 a[8:11], v8 offset:24576
    ds_read_b128 a[12:15], v8 offset:25600
    ds_read_b128 v[116:119], v5 offset:0
    s_waitcnt lgkmcnt(5)
    v_mfma_f32_16x16x32_bf16 v[56:59], a[0:3], v[104:107], v[56:59]
    v_mfma_f32_16x16x32_bf16 v[92:95], a[4:7], v[104:107], v[92:95]
    ds_read_b128 v[104:107], v5 offset:2048
    s_waitcnt lgkmcnt(5)
    v_mfma_f32_16x16x32_bf16 v[60:63], a[0:3], v[108:111], v[60:63]
    v_mfma_f32_16x16x32_bf16 v[96:99], a[4:7], v[108:111], v[96:99]
    ds_read_b128 v[108:111], v5 offset:4096
    s_waitcnt lgkmcnt(5)
    v_mfma_f32_16x16x32_bf16 v[64:67], a[0:3], v[112:115], v[64:67]
    v_mfma_f32_16x16x32_bf16 v[100:103], a[4:7], v[112:115], v[100:103]
    s_barrier
    ds_read_b128 v[112:115], v5 offset:6144
    s_waitcnt lgkmcnt(3)
    v_mfma_f32_16x16x32_bf16 v[32:35], a[8:11], v[116:119], v[32:35]
    v_mfma_f32_16x16x32_bf16 v[68:71], a[12:15], v[116:119], v[68:71]
    ds_read_b128 v[116:119], v5 offset:8192
    s_waitcnt lgkmcnt(3)
    v_mfma_f32_16x16x32_bf16 v[36:39], a[8:11], v[104:107], v[36:39]
    v_mfma_f32_16x16x32_bf16 v[72:75], a[12:15], v[104:107], v[72:75]
    ds_read_b128 v[104:107], v5 offset:10240
    s_waitcnt lgkmcnt(3)
    v_mfma_f32_16x16x32_bf16 v[40:43], a[8:11], v[108:111], v[40:43]
    v_mfma_f32_16x16x32_bf16 v[76:79], a[12:15], v[108:111], v[76:79]
    ds_read_b128 v[108:111], v5 offset:12288
    s_waitcnt lgkmcnt(3)
    v_mfma_f32_16x16x32_bf16 v[44:47], a[8:11], v[112:115], v[44:47]
    v_mfma_f32_16x16x32_bf16 v[80:83], a[12:15], v[112:115], v[80:83]
    ds_read_b128 v[112:115], v5 offset:14336
    s_waitcnt lgkmcnt(3)
    v_mfma_f32_16x16x32_bf16 v[48:51], a[8:11], v[116:119], v[48:51]
    v_mfma_f32_16x16x32_bf16 v[84:87], a[12:15], v[116:119], v[84:87]
    ds_read_b128 v[116:119], v5 offset:16384
    s_waitcnt lgkmcnt(3)
    v_mfma_f32_16x16x32_bf16 v[52:55], a[8:11], v[104:107], v[52:55]
    v_mfma_f32_16x16x32_bf16 v[88:91], a[12:15], v[104:107], v[88:91]
    ds_read_b128 a[0:3], v8 offset:32768
    ds_read_b128 a[4:7], v8 offset:33792
    ds_read_b128 v[104:107], v4 offset:18432
    s_waitcnt lgkmcnt(5)
    v_mfma_f32_16x16x32_bf16 v[56:59], a[8:11], v[108:111], v[56:59]
    v_mfma_f32_16x16x32_bf16 v[92:95], a[12:15], v[108:111], v[92:95]
    ds_read_b128 v[108:111], v4 offset:20480
    s_waitcnt lgkmcnt(5)
    v_mfma_f32_16x16x32_bf16 v[60:63], a[8:11], v[112:115], v[60:63]
    v_mfma_f32_16x16x32_bf16 v[96:99], a[12:15], v[112:115], v[96:99]
    ds_read_b128 v[112:115], v4 offset:22528
    s_waitcnt lgkmcnt(5)
    v_mfma_f32_16x16x32_bf16 v[64:67], a[8:11], v[116:119], v[64:67]
    v_mfma_f32_16x16x32_bf16 v[100:103], a[12:15], v[116:119], v[100:103]
    s_barrier
    ds_read_b128 v[116:119], v4 offset:24576
    s_waitcnt lgkmcnt(3)
    v_mfma_f32_16x16x32_bf16 v[32:35], a[0:3], v[104:107], v[32:35]
    v_mfma_f32_16x16x32_bf16 v[68:71], a[4:7], v[104:107], v[68:71]
    ds_read_b128 v[104:107], v4 offset:26624
    s_waitcnt lgkmcnt(3)
    v_mfma_f32_16x16x32_bf16 v[36:39], a[0:3], v[108:111], v[36:39]
    v_mfma_f32_16x16x32_bf16 v[72:75], a[4:7], v[108:111], v[72:75]
    ds_read_b128 v[108:111], v4 offset:28672
    s_waitcnt lgkmcnt(3)
    v_mfma_f32_16x16x32_bf16 v[40:43], a[0:3], v[112:115], v[40:43]
    v_mfma_f32_16x16x32_bf16 v[76:79], a[4:7], v[112:115], v[76:79]
    ds_read_b128 v[112:115], v4 offset:30720
    s_waitcnt lgkmcnt(3)
    v_mfma_f32_16x16x32_bf16 v[44:47], a[0:3], v[116:119], v[44:47]
    v_mfma_f32_16x16x32_bf16 v[80:83], a[4:7], v[116:119], v[80:83]
    ds_read_b128 v[116:119], v4 offset:32768
    s_waitcnt lgkmcnt(3)
    v_mfma_f32_16x16x32_bf16 v[48:51], a[0:3], v[104:107], v[48:51]
    v_mfma_f32_16x16x32_bf16 v[84:87], a[4:7], v[104:107], v[84:87]
    ds_read_b128 v[104:107], v4 offset:34816
    s_waitcnt lgkmcnt(3)
    v_mfma_f32_16x16x32_bf16 v[52:55], a[0:3], v[108:111], v[52:55]
    v_mfma_f32_16x16x32_bf16 v[88:91], a[4:7], v[108:111], v[88:91]
    ds_read_b128 a[8:11], v8 offset:40960
    ds_read_b128 a[12:15], v8 offset:41984
    ds_read_b128 v[108:111], v5 offset:18432
    s_waitcnt lgkmcnt(5)
    v_mfma_f32_16x16x32_bf16 v[56:59], a[0:3], v[112:115], v[56:59]
    v_mfma_f32_16x16x32_bf16 v[92:95], a[4:7], v[112:115], v[92:95]
    ds_read_b128 v[112:115], v5 offset:20480
    s_waitcnt lgkmcnt(5)
    v_mfma_f32_16x16x32_bf16 v[60:63], a[0:3], v[116:119], v[60:63]
    v_mfma_f32_16x16x32_bf16 v[96:99], a[4:7], v[116:119], v[96:99]
    ds_read_b128 v[116:119], v5 offset:22528
    s_waitcnt lgkmcnt(5)
    v_mfma_f32_16x16x32_bf16 v[64:67], a[0:3], v[104:107], v[64:67]
    v_mfma_f32_16x16x32_bf16 v[100:103], a[4:7], v[104:107], v[100:103]
    s_barrier
    ds_read_b128 v[104:107], v5 offset:24576
    s_waitcnt lgkmcnt(3)
    v_mfma_f32_16x16x32_bf16 v[32:35], a[8:11], v[108:111], v[32:35]
    v_mfma_f32_16x16x32_bf16 v[68:71], a[12:15], v[108:111], v[68:71]
    ds_read_b128 v[108:111], v5 offset:26624
    s_waitcnt lgkmcnt(3)
    v_mfma_f32_16x16x32_bf16 v[36:39], a[8:11], v[112:115], v[36:39]
    v_mfma_f32_16x16x32_bf16 v[72:75], a[12:15], v[112:115], v[72:75]
    ds_read_b128 v[112:115], v5 offset:28672
    s_waitcnt lgkmcnt(3)
    v_mfma_f32_16x16x32_bf16 v[40:43], a[8:11], v[116:119], v[40:43]
    v_mfma_f32_16x16x32_bf16 v[76:79], a[12:15], v[116:119], v[76:79]
    ds_read_b128 v[116:119], v5 offset:30720
    s_waitcnt lgkmcnt(3)
    v_mfma_f32_16x16x32_bf16 v[44:47], a[8:11], v[104:107], v[44:47]
    v_mfma_f32_16x16x32_bf16 v[80:83], a[12:15], v[104:107], v[80:83]
    ds_read_b128 v[104:107], v5 offset:32768
    s_waitcnt lgkmcnt(3)
    v_mfma_f32_16x16x32_bf16 v[48:51], a[8:11], v[108:111], v[48:51]
    v_mfma_f32_16x16x32_bf16 v[84:87], a[12:15], v[108:111], v[84:87]
    ds_read_b128 v[108:111], v5 offset:34816
    s_waitcnt lgkmcnt(3)
    v_mfma_f32_16x16x32_bf16 v[52:55], a[8:11], v[112:115], v[52:55]
    v_mfma_f32_16x16x32_bf16 v[88:91], a[12:15], v[112:115], v[88:91]
    ds_read_b128 a[0:3], v8 offset:49152
    ds_read_b128 a[4:7], v8 offset:50176
    ds_read_b128 v[112:115], v4 offset:36864
    s_waitcnt lgkmcnt(5)
    v_mfma_f32_16x16x32_bf16 v[56:59], a[8:11], v[116:119], v[56:59]
    v_mfma_f32_16x16x32_bf16 v[92:95], a[12:15], v[116:119], v[92:95]
    ds_read_b128 v[116:119], v4 offset:38912
    s_waitcnt lgkmcnt(5)
    v_mfma_f32_16x16x32_bf16 v[60:63], a[8:11], v[104:107], v[60:63]
    v_mfma_f32_16x16x32_bf16 v[96:99], a[12:15], v[104:107], v[96:99]
    ds_read_b128 v[104:107], v4 offset:40960
    s_waitcnt lgkmcnt(5)
    v_mfma_f32_16x16x32_bf16 v[64:67], a[8:11], v[108:111], v[64:67]
    v_mfma_f32_16x16x32_bf16 v[100:103], a[12:15], v[108:111], v[100:103]
    s_barrier
    ds_read_b128 v[108:111], v4 offset:43008
    s_waitcnt lgkmcnt(3)
    v_mfma_f32_16x16x32_bf16 v[32:35], a[0:3], v[112:115], v[32:35]
    v_mfma_f32_16x16x32_bf16 v[68:71], a[4:7], v[112:115], v[68:71]
    ds_read_b128 v[112:115], v4 offset:45056
    s_waitcnt lgkmcnt(3)
    v_mfma_f32_16x16x32_bf16 v[36:39], a[0:3], v[116:119], v[36:39]
    v_mfma_f32_16x16x32_bf16 v[72:75], a[4:7], v[116:119], v[72:75]
    ds_read_b128 v[116:119], v4 offset:47104
    s_waitcnt lgkmcnt(3)
    v_mfma_f32_16x16x32_bf16 v[40:43], a[0:3], v[104:107], v[40:43]
    v_mfma_f32_16x16x32_bf16 v[76:79], a[4:7], v[104:107], v[76:79]
    ds_read_b128 v[104:107], v4 offset:49152
    s_waitcnt lgkmcnt(3)
    v_mfma_f32_16x16x32_bf16 v[44:47], a[0:3], v[108:111], v[44:47]
    v_mfma_f32_16x16x32_bf16 v[80:83], a[4:7], v[108:111], v[80:83]
    ds_read_b128 v[108:111], v4 offset:51200
    s_waitcnt lgkmcnt(3)
    v_mfma_f32_16x16x32_bf16 v[48:51], a[0:3], v[112:115], v[48:51]
    v_mfma_f32_16x16x32_bf16 v[84:87], a[4:7], v[112:115], v[84:87]
    ds_read_b128 v[112:115], v4 offset:53248
    s_waitcnt lgkmcnt(3)
    v_mfma_f32_16x16x32_bf16 v[52:55], a[0:3], v[116:119], v[52:55]
    v_mfma_f32_16x16x32_bf16 v[88:91], a[4:7], v[116:119], v[88:91]
    ds_read_b128 a[8:11], v8 offset:57344
    ds_read_b128 a[12:15], v8 offset:58368
    ds_read_b128 v[116:119], v5 offset:36864
    s_waitcnt lgkmcnt(5)
    v_mfma_f32_16x16x32_bf16 v[56:59], a[0:3], v[104:107], v[56:59]
    v_mfma_f32_16x16x32_bf16 v[92:95], a[4:7], v[104:107], v[92:95]
    ds_read_b128 v[104:107], v5 offset:38912
    s_waitcnt lgkmcnt(5)
    v_mfma_f32_16x16x32_bf16 v[60:63], a[0:3], v[108:111], v[60:63]
    v_mfma_f32_16x16x32_bf16 v[96:99], a[4:7], v[108:111], v[96:99]
    ds_read_b128 v[108:111], v5 offset:40960
    s_waitcnt lgkmcnt(5)
    v_mfma_f32_16x16x32_bf16 v[64:67], a[0:3], v[112:115], v[64:67]
    v_mfma_f32_16x16x32_bf16 v[100:103], a[4:7], v[112:115], v[100:103]
    s_barrier
    ds_read_b128 v[112:115], v5 offset:43008
    s_waitcnt lgkmcnt(3)
    v_mfma_f32_16x16x32_bf16 v[32:35], a[8:11], v[116:119], v[32:35]
    v_mfma_f32_16x16x32_bf16 v[68:71], a[12:15], v[116:119], v[68:71]
    ds_read_b128 v[116:119], v5 offset:45056
    s_waitcnt lgkmcnt(3)
    v_mfma_f32_16x16x32_bf16 v[36:39], a[8:11], v[104:107], v[36:39]
    v_mfma_f32_16x16x32_bf16 v[72:75], a[12:15], v[104:107], v[72:75]
    ds_read_b128 v[104:107], v5 offset:47104
    s_waitcnt lgkmcnt(3)
    v_mfma_f32_16x16x32_bf16 v[40:43], a[8:11], v[108:111], v[40:43]
    v_mfma_f32_16x16x32_bf16 v[76:79], a[12:15], v[108:111], v[76:79]
    ds_read_b128 v[108:111], v5 offset:49152
    s_waitcnt lgkmcnt(3)
    v_mfma_f32_16x16x32_bf16 v[44:47], a[8:11], v[112:115], v[44:47]
    v_mfma_f32_16x16x32_bf16 v[80:83], a[12:15], v[112:115], v[80:83]
    ds_read_b128 v[112:115], v5 offset:51200
    s_waitcnt lgkmcnt(3)
    v_mfma_f32_16x16x32_bf16 v[48:51], a[8:11], v[116:119], v[48:51]
    v_mfma_f32_16x16x32_bf16 v[84:87], a[12:15], v[116:119], v[84:87]
    ds_read_b128 v[116:119], v5 offset:53248
    s_waitcnt lgkmcnt(3)
    v_mfma_f32_16x16x32_bf16 v[52:55], a[8:11], v[104:107], v[52:55]
    v_mfma_f32_16x16x32_bf16 v[88:91], a[12:15], v[104:107], v[88:91]
    ds_read_b128 a[0:3], v8 offset:0
    ds_read_b128 a[4:7], v8 offset:1024
    ds_read_b128 v[104:107], v6 offset:0
    s_waitcnt lgkmcnt(5)
    v_mfma_f32_16x16x32_bf16 v[56:59], a[8:11], v[108:111], v[56:59]
    v_mfma_f32_16x16x32_bf16 v[92:95], a[12:15], v[108:111], v[92:95]
    ds_read_b128 v[108:111], v6 offset:2048
    s_waitcnt lgkmcnt(5)
    v_mfma_f32_16x16x32_bf16 v[60:63], a[8:11], v[112:115], v[60:63]
    v_mfma_f32_16x16x32_bf16 v[96:99], a[12:15], v[112:115], v[96:99]
    ds_read_b128 v[112:115], v6 offset:4096
    s_waitcnt lgkmcnt(5)
    v_mfma_f32_16x16x32_bf16 v[64:67], a[8:11], v[116:119], v[64:67]
    v_mfma_f32_16x16x32_bf16 v[100:103], a[12:15], v[116:119], v[100:103]
    s_barrier
    ds_read_b128 v[116:119], v6 offset:6144
    s_waitcnt lgkmcnt(3)
    v_mfma_f32_16x16x32_bf16 v[32:35], a[0:3], v[104:107], v[32:35]
    v_mfma_f32_16x16x32_bf16 v[68:71], a[4:7], v[104:107], v[68:71]
    ds_read_b128 v[104:107], v6 offset:8192
    s_waitcnt lgkmcnt(3)
    v_mfma_f32_16x16x32_bf16 v[36:39], a[0:3], v[108:111], v[36:39]
    v_mfma_f32_16x16x32_bf16 v[72:75], a[4:7], v[108:111], v[72:75]
    ds_read_b128 v[108:111], v6 offset:10240
    s_waitcnt lgkmcnt(3)
    v_mfma_f32_16x16x32_bf16 v[40:43], a[0:3], v[112:115], v[40:43]
    v_mfma_f32_16x16x32_bf16 v[76:79], a[4:7], v[112:115], v[76:79]
    ds_read_b128 v[112:115], v6 offset:12288
    s_waitcnt lgkmcnt(3)
    v_mfma_f32_16x16x32_bf16 v[44:47], a[0:3], v[116:119], v[44:47]
    v_mfma_f32_16x16x32_bf16 v[80:83], a[4:7], v[116:119], v[80:83]
    ds_read_b128 v[116:119], v6 offset:14336
    s_waitcnt lgkmcnt(3)
    v_mfma_f32_16x16x32_bf16 v[48:51], a[0:3], v[104:107], v[48:51]
    v_mfma_f32_16x16x32_bf16 v[84:87], a[4:7], v[104:107], v[84:87]
    ds_read_b128 v[104:107], v6 offset:16384
    s_waitcnt lgkmcnt(3)
    v_mfma_f32_16x16x32_bf16 v[52:55], a[0:3], v[108:111], v[52:55]
    v_mfma_f32_16x16x32_bf16 v[88:91], a[4:7], v[108:111], v[88:91]
    ds_read_b128 a[8:11], v8 offset:8192
    ds_read_b128 a[12:15], v8 offset:9216
    ds_read_b128 v[108:111], v7 offset:0
    s_waitcnt lgkmcnt(5)
    v_mfma_f32_16x16x32_bf16 v[56:59], a[0:3], v[112:115], v[56:59]
    v_mfma_f32_16x16x32_bf16 v[92:95], a[4:7], v[112:115], v[92:95]
    ds_read_b128 v[112:115], v7 offset:2048
    s_waitcnt lgkmcnt(5)
    v_mfma_f32_16x16x32_bf16 v[60:63], a[0:3], v[116:119], v[60:63]
    v_mfma_f32_16x16x32_bf16 v[96:99], a[4:7], v[116:119], v[96:99]
    ds_read_b128 v[116:119], v7 offset:4096
    s_waitcnt lgkmcnt(5)
    v_mfma_f32_16x16x32_bf16 v[64:67], a[0:3], v[104:107], v[64:67]
    v_mfma_f32_16x16x32_bf16 v[100:103], a[4:7], v[104:107], v[100:103]
    s_barrier
    ds_read_b128 v[104:107], v7 offset:6144
    s_waitcnt lgkmcnt(3)
    v_mfma_f32_16x16x32_bf16 v[32:35], a[8:11], v[108:111], v[32:35]
    v_mfma_f32_16x16x32_bf16 v[68:71], a[12:15], v[108:111], v[68:71]
    ds_read_b128 v[108:111], v7 offset:8192
    s_waitcnt lgkmcnt(3)
    v_mfma_f32_16x16x32_bf16 v[36:39], a[8:11], v[112:115], v[36:39]
    v_mfma_f32_16x16x32_bf16 v[72:75], a[12:15], v[112:115], v[72:75]
    ds_read_b128 v[112:115], v7 offset:10240
    s_waitcnt lgkmcnt(3)
    v_mfma_f32_16x16x32_bf16 v[40:43], a[8:11], v[116:119], v[40:43]
    v_mfma_f32_16x16x32_bf16 v[76:79], a[12:15], v[116:119], v[76:79]
    ds_read_b128 v[116:119], v7 offset:12288
    s_waitcnt lgkmcnt(3)
    v_mfma_f32_16x16x32_bf16 v[44:47], a[8:11], v[104:107], v[44:47]
    v_mfma_f32_16x16x32_bf16 v[80:83], a[12:15], v[104:107], v[80:83]
    ds_read_b128 v[104:107], v7 offset:14336
    s_waitcnt lgkmcnt(3)
    v_mfma_f32_16x16x32_bf16 v[48:51], a[8:11], v[108:111], v[48:51]
    v_mfma_f32_16x16x32_bf16 v[84:87], a[12:15], v[108:111], v[84:87]
    ds_read_b128 v[108:111], v7 offset:16384
    s_waitcnt lgkmcnt(3)
    v_mfma_f32_16x16x32_bf16 v[52:55], a[8:11], v[112:115], v[52:55]
    v_mfma_f32_16x16x32_bf16 v[88:91], a[12:15], v[112:115], v[88:91]
    ds_read_b128 a[0:3], v8 offset:16384
    ds_read_b128 a[4:7], v8 offset:17408
    ds_read_b128 v[112:115], v6 offset:18432
    s_waitcnt lgkmcnt(5)
    v_mfma_f32_16x16x32_bf16 v[56:59], a[8:11], v[116:119], v[56:59]
    v_mfma_f32_16x16x32_bf16 v[92:95], a[12:15], v[116:119], v[92:95]
    ds_read_b128 v[116:119], v6 offset:20480
    s_waitcnt lgkmcnt(5)
    v_mfma_f32_16x16x32_bf16 v[60:63], a[8:11], v[104:107], v[60:63]
    v_mfma_f32_16x16x32_bf16 v[96:99], a[12:15], v[104:107], v[96:99]
    ds_read_b128 v[104:107], v6 offset:22528
    s_waitcnt lgkmcnt(5)
    v_mfma_f32_16x16x32_bf16 v[64:67], a[8:11], v[108:111], v[64:67]
    v_mfma_f32_16x16x32_bf16 v[100:103], a[12:15], v[108:111], v[100:103]
    s_barrier
    ds_read_b128 v[108:111], v6 offset:24576
    s_waitcnt lgkmcnt(3)
    v_mfma_f32_16x16x32_bf16 v[32:35], a[0:3], v[112:115], v[32:35]
    v_mfma_f32_16x16x32_bf16 v[68:71], a[4:7], v[112:115], v[68:71]
    ds_read_b128 v[112:115], v6 offset:26624
    s_waitcnt lgkmcnt(3)
    v_mfma_f32_16x16x32_bf16 v[36:39], a[0:3], v[116:119], v[36:39]
    v_mfma_f32_16x16x32_bf16 v[72:75], a[4:7], v[116:119], v[72:75]
    ds_read_b128 v[116:119], v6 offset:28672
    s_waitcnt lgkmcnt(3)
    v_mfma_f32_16x16x32_bf16 v[40:43], a[0:3], v[104:107], v[40:43]
    v_mfma_f32_16x16x32_bf16 v[76:79], a[4:7], v[104:107], v[76:79]
    ds_read_b128 v[104:107], v6 offset:30720
    s_waitcnt lgkmcnt(3)
    v_mfma_f32_16x16x32_bf16 v[44:47], a[0:3], v[108:111], v[44:47]
    v_mfma_f32_16x16x32_bf16 v[80:83], a[4:7], v[108:111], v[80:83]
    ds_read_b128 v[108:111], v6 offset:32768
    s_waitcnt lgkmcnt(3)
    v_mfma_f32_16x16x32_bf16 v[48:51], a[0:3], v[112:115], v[48:51]
    v_mfma_f32_16x16x32_bf16 v[84:87], a[4:7], v[112:115], v[84:87]
    ds_read_b128 v[112:115], v6 offset:34816
    s_waitcnt lgkmcnt(3)
    v_mfma_f32_16x16x32_bf16 v[52:55], a[0:3], v[116:119], v[52:55]
    v_mfma_f32_16x16x32_bf16 v[88:91], a[4:7], v[116:119], v[88:91]
    ds_read_b128 a[8:11], v8 offset:24576
    ds_read_b128 a[12:15], v8 offset:25600
    ds_read_b128 v[116:119], v7 offset:18432
    s_waitcnt lgkmcnt(5)
    v_mfma_f32_16x16x32_bf16 v[56:59], a[0:3], v[104:107], v[56:59]
    v_mfma_f32_16x16x32_bf16 v[92:95], a[4:7], v[104:107], v[92:95]
    ds_read_b128 v[104:107], v7 offset:20480
    s_waitcnt lgkmcnt(5)
    v_mfma_f32_16x16x32_bf16 v[60:63], a[0:3], v[108:111], v[60:63]
    v_mfma_f32_16x16x32_bf16 v[96:99], a[4:7], v[108:111], v[96:99]
    ds_read_b128 v[108:111], v7 offset:22528
    s_waitcnt lgkmcnt(5)
    v_mfma_f32_16x16x32_bf16 v[64:67], a[0:3], v[112:115], v[64:67]
    v_mfma_f32_16x16x32_bf16 v[100:103], a[4:7], v[112:115], v[100:103]
    s_barrier
    ds_read_b128 v[112:115], v7 offset:24576
    s_waitcnt lgkmcnt(3)
    v_mfma_f32_16x16x32_bf16 v[32:35], a[8:11], v[116:119], v[32:35]
    v_mfma_f32_16x16x32_bf16 v[68:71], a[12:15], v[116:119], v[68:71]
    ds_read_b128 v[116:119], v7 offset:26624
    s_waitcnt lgkmcnt(3)
    v_mfma_f32_16x16x32_bf16 v[36:39], a[8:11], v[104:107], v[36:39]
    v_mfma_f32_16x16x32_bf16 v[72:75], a[12:15], v[104:107], v[72:75]
    ds_read_b128 v[104:107], v7 offset:28672
    s_waitcnt lgkmcnt(3)
    v_mfma_f32_16x16x32_bf16 v[40:43], a[8:11], v[108:111], v[40:43]
    v_mfma_f32_16x16x32_bf16 v[76:79], a[12:15], v[108:111], v[76:79]
    ds_read_b128 v[108:111], v7 offset:30720
    s_waitcnt lgkmcnt(3)
    v_mfma_f32_16x16x32_bf16 v[44:47], a[8:11], v[112:115], v[44:47]
    v_mfma_f32_16x16x32_bf16 v[80:83], a[12:15], v[112:115], v[80:83]
    ds_read_b128 v[112:115], v7 offset:32768
    s_waitcnt lgkmcnt(3)
    v_mfma_f32_16x16x32_bf16 v[48:51], a[8:11], v[116:119], v[48:51]
    v_mfma_f32_16x16x32_bf16 v[84:87], a[12:15], v[116:119], v[84:87]
    ds_read_b128 v[116:119], v7 offset:34816
    s_waitcnt lgkmcnt(3)
    v_mfma_f32_16x16x32_bf16 v[52:55], a[8:11], v[104:107], v[52:55]
    v_mfma_f32_16x16x32_bf16 v[88:91], a[12:15], v[104:107], v[88:91]
    s_waitcnt lgkmcnt(2)
    v_mfma_f32_16x16x32_bf16 v[56:59], a[8:11], v[108:111], v[56:59]
    v_mfma_f32_16x16x32_bf16 v[92:95], a[12:15], v[108:111], v[92:95]
    s_waitcnt lgkmcnt(1)
    v_mfma_f32_16x16x32_bf16 v[60:63], a[8:11], v[112:115], v[60:63]
    v_mfma_f32_16x16x32_bf16 v[96:99], a[12:15], v[112:115], v[96:99]
    s_waitcnt lgkmcnt(0)
    v_mfma_f32_16x16x32_bf16 v[64:67], a[8:11], v[116:119], v[64:67]
    v_mfma_f32_16x16x32_bf16 v[100:103], a[12:15], v[116:119], v[100:103]
    s_barrier
    v_and_b32 v9, 15, v1
    v_lshrrev_b32 v10, 4, v1
    v_lshlrev_b32 v11, 3, v9
    v_add_u32 v11, 157696, v11
    ds_read_b64 v[12:13], v11 offset:0
    ds_read_b64 v[14:15], v11 offset:128
    ds_read_b64 v[16:17], v11 offset:256
    ds_read_b64 v[18:19], v11 offset:384
    ds_read_b64 v[20:21], v11 offset:512
    ds_read_b64 v[22:23], v11 offset:640
    ds_read_b64 v[24:25], v11 offset:768
    ds_read_b64 v[26:27], v11 offset:896
    ds_read_b64 v[28:29], v11 offset:1024
    s_nop 4
    v_mov_b32_dpp v104, v32 row_newbcast:0 row_mask:0xf bank_mask:0xf
    v_mov_b32_dpp v105, v33 row_newbcast:0 row_mask:0xf bank_mask:0xf
    v_mov_b32_dpp v106, v34 row_newbcast:0 row_mask:0xf bank_mask:0xf
    v_mov_b32_dpp v107, v35 row_newbcast:0 row_mask:0xf bank_mask:0xf
    v_mov_b32_dpp v108, v68 row_newbcast:0 row_mask:0xf bank_mask:0xf
    v_mov_b32_dpp v109, v69 row_newbcast:0 row_mask:0xf bank_mask:0xf
    v_mov_b32_dpp v110, v70 row_newbcast:0 row_mask:0xf bank_mask:0xf
    v_mov_b32_dpp v111, v71 row_newbcast:0 row_mask:0xf bank_mask:0xf
    s_lshl_b32 s42, s3, 2
    v_add_u32 v30, s42, v10
    v_mul_u32_u24 v31, 240, v9
    v_lshl_add_u32 v113, v30, 4, v31
    v_mov_b32 v115, 34624
    v_lshl_add_u32 v115, v9, 4, v115
    v_cmp_eq_u32 vcc, 15, v30
    v_mov_b32 v116, 3840
    v_mov_b32 v117, 0
    v_cndmask_b32 v113, v113, v115, vcc
    v_cndmask_b32 v116, v116, v117, vcc
    s_waitcnt lgkmcnt(0)
    v_pk_mul_f32 v[118:119], v[104:105], v[12:13] op_sel_hi:[1,0]
    v_pk_mul_f32 v[120:121], v[106:107], v[12:13] op_sel_hi:[1,0]
    v_pk_fma_f32 v[118:119], v[32:33], v[12:13], v[118:119] op_sel:[0,1,0] op_sel_hi:[1,1,1]
    v_pk_fma_f32 v[120:121], v[34:35], v[12:13], v[120:121] op_sel:[0,1,0] op_sel_hi:[1,1,1]
    v_pk_mul_f32 v[122:123], v[108:109], v[12:13] op_sel_hi:[1,0]
    v_pk_mul_f32 v[124:125], v[110:111], v[12:13] op_sel_hi:[1,0]
    v_pk_fma_f32 v[122:123], v[68:69], v[12:13], v[122:123] op_sel:[0,1,0] op_sel_hi:[1,1,1]
    v_pk_fma_f32 v[124:125], v[70:71], v[12:13], v[124:125] op_sel:[0,1,0] op_sel_hi:[1,1,1]
    v_cvt_pk_bf16_f32 v4, v118, v122
    v_cvt_pk_bf16_f32 v5, v119, v123
    v_cvt_pk_bf16_f32 v6, v120, v124
    v_cvt_pk_bf16_f32 v7, v121, v125
    ds_write_b128 v113, v[4:7]
    v_add_u32 v113, v113, v116
    v_pk_mul_f32 v[118:119], v[104:105], v[14:15] op_sel_hi:[1,0]
    v_pk_mul_f32 v[120:121], v[106:107], v[14:15] op_sel_hi:[1,0]
    v_pk_fma_f32 v[118:119], v[36:37], v[14:15], v[118:119] op_sel:[0,1,0] op_sel_hi:[1,1,1]
    v_pk_fma_f32 v[120:121], v[38:39], v[14:15], v[120:121] op_sel:[0,1,0] op_sel_hi:[1,1,1]
    v_pk_mul_f32 v[122:123], v[108:109], v[14:15] op_sel_hi:[1,0]
    v_pk_mul_f32 v[124:125], v[110:111], v[14:15] op_sel_hi:[1,0]
    v_pk_fma_f32 v[122:123], v[72:73], v[14:15], v[122:123] op_sel:[0,1,0] op_sel_hi:[1,1,1]
    v_pk_fma_f32 v[124:125], v[74:75], v[14:15], v[124:125] op_sel:[0,1,0] op_sel_hi:[1,1,1]
    v_cvt_pk_bf16_f32 v4, v118, v122
    v_cvt_pk_bf16_f32 v5, v119, v123
    v_cvt_pk_bf16_f32 v6, v120, v124
    v_cvt_pk_bf16_f32 v7, v121, v125
    ds_write_b128 v113, v[4:7]
    v_add_u32 v113, v113, v116
    v_pk_mul_f32 v[118:119], v[104:105], v[16:17] op_sel_hi:[1,0]
    v_pk_mul_f32 v[120:121], v[106:107], v[16:17] op_sel_hi:[1,0]
    v_pk_fma_f32 v[118:119], v[40:41], v[16:17], v[118:119] op_sel:[0,1,0] op_sel_hi:[1,1,1]
    v_pk_fma_f32 v[120:121], v[42:43], v[16:17], v[120:121] op_sel:[0,1,0] op_sel_hi:[1,1,1]
    v_pk_mul_f32 v[122:123], v[108:109], v[16:17] op_sel_hi:[1,0]
    v_pk_mul_f32 v[124:125], v[110:111], v[16:17] op_sel_hi:[1,0]
    v_pk_fma_f32 v[122:123], v[76:77], v[16:17], v[122:123] op_sel:[0,1,0] op_sel_hi:[1,1,1]
    v_pk_fma_f32 v[124:125], v[78:79], v[16:17], v[124:125] op_sel:[0,1,0] op_sel_hi:[1,1,1]
    v_cvt_pk_bf16_f32 v4, v118, v122
    v_cvt_pk_bf16_f32 v5, v119, v123
    v_cvt_pk_bf16_f32 v6, v120, v124
    v_cvt_pk_bf16_f32 v7, v121, v125
    ds_write_b128 v113, v[4:7]
    v_add_u32 v113, v113, v116
    v_pk_mul_f32 v[118:119], v[104:105], v[18:19] op_sel_hi:[1,0]
    v_pk_mul_f32 v[120:121], v[106:107], v[18:19] op_sel_hi:[1,0]
    v_pk_fma_f32 v[118:119], v[44:45], v[18:19], v[118:119] op_sel:[0,1,0] op_sel_hi:[1,1,1]
    v_pk_fma_f32 v[120:121], v[46:47], v[18:19], v[120:121] op_sel:[0,1,0] op_sel_hi:[1,1,1]
    v_pk_mul_f32 v[122:123], v[108:109], v[18:19] op_sel_hi:[1,0]
    v_pk_mul_f32 v[124:125], v[110:111], v[18:19] op_sel_hi:[1,0]
    v_pk_fma_f32 v[122:123], v[80:81], v[18:19], v[122:123] op_sel:[0,1,0] op_sel_hi:[1,1,1]
    v_pk_fma_f32 v[124:125], v[82:83], v[18:19], v[124:125] op_sel:[0,1,0] op_sel_hi:[1,1,1]
    v_cvt_pk_bf16_f32 v4, v118, v122
    v_cvt_pk_bf16_f32 v5, v119, v123
    v_cvt_pk_bf16_f32 v6, v120, v124
    v_cvt_pk_bf16_f32 v7, v121, v125
    ds_write_b128 v113, v[4:7]
    v_add_u32 v113, v113, v116
    v_pk_mul_f32 v[118:119], v[104:105], v[20:21] op_sel_hi:[1,0]
    v_pk_mul_f32 v[120:121], v[106:107], v[20:21] op_sel_hi:[1,0]
    v_pk_fma_f32 v[118:119], v[48:49], v[20:21], v[118:119] op_sel:[0,1,0] op_sel_hi:[1,1,1]
    v_pk_fma_f32 v[120:121], v[50:51], v[20:21], v[120:121] op_sel:[0,1,0] op_sel_hi:[1,1,1]
    v_pk_mul_f32 v[122:123], v[108:109], v[20:21] op_sel_hi:[1,0]
    v_pk_mul_f32 v[124:125], v[110:111], v[20:21] op_sel_hi:[1,0]
    v_pk_fma_f32 v[122:123], v[84:85], v[20:21], v[122:123] op_sel:[0,1,0] op_sel_hi:[1,1,1]
    v_pk_fma_f32 v[124:125], v[86:87], v[20:21], v[124:125] op_sel:[0,1,0] op_sel_hi:[1,1,1]
    v_cvt_pk_bf16_f32 v4, v118, v122
    v_cvt_pk_bf16_f32 v5, v119, v123
    v_cvt_pk_bf16_f32 v6, v120, v124
    v_cvt_pk_bf16_f32 v7, v121, v125
    ds_write_b128 v113, v[4:7]
    v_add_u32 v113, v113, v116
    v_pk_mul_f32 v[118:119], v[104:105], v[22:23] op_sel_hi:[1,0]
    v_pk_mul_f32 v[120:121], v[106:107], v[22:23] op_sel_hi:[1,0]
    v_pk_fma_f32 v[118:119], v[52:53], v[22:23], v[118:119] op_sel:[0,1,0] op_sel_hi:[1,1,1]
    v_pk_fma_f32 v[120:121], v[54:55], v[22:23], v[120:121] op_sel:[0,1,0] op_sel_hi:[1,1,1]
    v_pk_mul_f32 v[122:123], v[108:109], v[22:23] op_sel_hi:[1,0]
    v_pk_mul_f32 v[124:125], v[110:111], v[22:23] op_sel_hi:[1,0]
    v_pk_fma_f32 v[122:123], v[88:89], v[22:23], v[122:123] op_sel:[0,1,0] op_sel_hi:[1,1,1]
    v_pk_fma_f32 v[124:125], v[90:91], v[22:23], v[124:125] op_sel:[0,1,0] op_sel_hi:[1,1,1]
    v_cvt_pk_bf16_f32 v4, v118, v122
    v_cvt_pk_bf16_f32 v5, v119, v123
    v_cvt_pk_bf16_f32 v6, v120, v124
    v_cvt_pk_bf16_f32 v7, v121, v125
    ds_write_b128 v113, v[4:7]
    v_add_u32 v113, v113, v116
    v_pk_mul_f32 v[118:119], v[104:105], v[24:25] op_sel_hi:[1,0]
    v_pk_mul_f32 v[120:121], v[106:107], v[24:25] op_sel_hi:[1,0]
    v_pk_fma_f32 v[118:119], v[56:57], v[24:25], v[118:119] op_sel:[0,1,0] op_sel_hi:[1,1,1]
    v_pk_fma_f32 v[120:121], v[58:59], v[24:25], v[120:121] op_sel:[0,1,0] op_sel_hi:[1,1,1]
    v_pk_mul_f32 v[122:123], v[108:109], v[24:25] op_sel_hi:[1,0]
    v_pk_mul_f32 v[124:125], v[110:111], v[24:25] op_sel_hi:[1,0]
    v_pk_fma_f32 v[122:123], v[92:93], v[24:25], v[122:123] op_sel:[0,1,0] op_sel_hi:[1,1,1]
    v_pk_fma_f32 v[124:125], v[94:95], v[24:25], v[124:125] op_sel:[0,1,0] op_sel_hi:[1,1,1]
    v_cvt_pk_bf16_f32 v4, v118, v122
    v_cvt_pk_bf16_f32 v5, v119, v123
    v_cvt_pk_bf16_f32 v6, v120, v124
    v_cvt_pk_bf16_f32 v7, v121, v125
    ds_write_b128 v113, v[4:7]
    v_add_u32 v113, v113, v116
    v_pk_mul_f32 v[118:119], v[104:105], v[26:27] op_sel_hi:[1,0]
    v_pk_mul_f32 v[120:121], v[106:107], v[26:27] op_sel_hi:[1,0]
    v_pk_fma_f32 v[118:119], v[60:61], v[26:27], v[118:119] op_sel:[0,1,0] op_sel_hi:[1,1,1]
    v_pk_fma_f32 v[120:121], v[62:63], v[26:27], v[120:121] op_sel:[0,1,0] op_sel_hi:[1,1,1]
    v_pk_mul_f32 v[122:123], v[108:109], v[26:27] op_sel_hi:[1,0]
    v_pk_mul_f32 v[124:125], v[110:111], v[26:27] op_sel_hi:[1,0]
    v_pk_fma_f32 v[122:123], v[96:97], v[26:27], v[122:123] op_sel:[0,1,0] op_sel_hi:[1,1,1]
    v_pk_fma_f32 v[124:125], v[98:99], v[26:27], v[124:125] op_sel:[0,1,0] op_sel_hi:[1,1,1]
    v_cvt_pk_bf16_f32 v4, v118, v122
    v_cvt_pk_bf16_f32 v5, v119, v123
    v_cvt_pk_bf16_f32 v6, v120, v124
    v_cvt_pk_bf16_f32 v7, v121, v125
    ds_write_b128 v113, v[4:7]
    v_add_u32 v113, v113, v116
    v_pk_mul_f32 v[118:119], v[104:105], v[28:29] op_sel_hi:[1,0]
    v_pk_mul_f32 v[120:121], v[106:107], v[28:29] op_sel_hi:[1,0]
    v_pk_fma_f32 v[118:119], v[64:65], v[28:29], v[118:119] op_sel:[0,1,0] op_sel_hi:[1,1,1]
    v_pk_fma_f32 v[120:121], v[66:67], v[28:29], v[120:121] op_sel:[0,1,0] op_sel_hi:[1,1,1]
    v_pk_mul_f32 v[122:123], v[108:109], v[28:29] op_sel_hi:[1,0]
    v_pk_mul_f32 v[124:125], v[110:111], v[28:29] op_sel_hi:[1,0]
    v_pk_fma_f32 v[122:123], v[100:101], v[28:29], v[122:123] op_sel:[0,1,0] op_sel_hi:[1,1,1]
    v_pk_fma_f32 v[124:125], v[102:103], v[28:29], v[124:125] op_sel:[0,1,0] op_sel_hi:[1,1,1]
    v_cvt_pk_bf16_f32 v4, v118, v122
    v_cvt_pk_bf16_f32 v5, v119, v123
    v_cvt_pk_bf16_f32 v6, v120, v124
    v_cvt_pk_bf16_f32 v7, v121, v125
    ds_write_b128 v113, v[4:7]
    s_waitcnt lgkmcnt(0)
    s_barrier
    v_and_b32 v9, 31, v1
    s_lshl_b32 s42, s3, 5
    v_add_u32 v9, s42, v9
    v_lshrrev_b32 v10, 5, v1
    v_add_u32 v11, 2, v9
    v_mul_u32_u24 v11, 240, v11
    v_mul_u32_u24 v12, 48, v10
    v_add_u32 v15, v11, v12
    v_lshl_add_u32 v14, v10, 3, v11
    ds_read_b128 v[16:19], v15 offset:3360
    ds_read_b128 v[20:23], v15 offset:3376
    ds_read_b64 v[24:25], v14 offset:3392
    ds_read_b128 v[38:41], v15 offset:3440
    ds_read_b128 v[42:45], v15 offset:3456
    ds_read_b64 v[46:47], v14 offset:3472
    ds_read_b128 v[48:51], v15 offset:2960
    ds_read_b128 v[52:55], v15 offset:2976
    ds_read_b64 v[56:57], v14 offset:2992
    ds_read_b128 v[58:61], v15 offset:2480
    ds_read_b128 v[62:65], v15 offset:2496
    ds_read_b64 v[66:67], v14 offset:2512
    ds_read_b128 v[68:71], v15 offset:2000
    ds_read_b128 v[72:75], v15 offset:2016
    ds_read_b64 v[76:77], v14 offset:2032
    s_lshl_b32 s42, s56, 7
    v_add_u32 v13, s42, v9
    v_lshrrev_b32 v2, 4, v13
    s_movk_i32 s42, 20480
    v_mul_lo_u32 v2, v2, s42
    v_and_b32 v3, 15, v13
    v_lshl_add_u32 v2, v3, 4, v2
    s_mul_i32 s42, s57, 5
    v_mul_u32_u24 v8, 3, v10
    v_add_u32 v8, s42, v8
    v_lshrrev_b32 v4, 2, v8
    v_lshl_add_u32 v5, v4, 10, v2
    v_and_b32 v4, 3, v8
    v_lshl_add_u32 v5, v4, 8, v5
    v_add_u32 v8, 1, v8
    v_lshrrev_b32 v4, 2, v8
    v_lshl_add_u32 v6, v4, 10, v2
    v_and_b32 v4, 3, v8
    v_lshl_add_u32 v6, v4, 8, v6
    s_add_u32 s42, s42, 2
    v_mov_b32 v8, s42
    v_lshrrev_b32 v4, 2, v8
    v_lshl_add_u32 v7, v4, 10, v2
    v_and_b32 v4, 3, v8
    v_lshl_add_u32 v7, v4, 8, v7
    v_lshl_add_u32 v7, v10, 3, v7
    v_mov_b32 v26, 0
    v_mov_b32 v27, 0
    v_mov_b32 v28, 0
    v_mov_b32 v29, 0
    v_mov_b32 v30, 0
    v_mov_b32 v31, 0
    v_mov_b32 v32, 0
    v_mov_b32 v33, 0
    s_waitcnt lgkmcnt(0)
    ds_read_b128 v[78:81], v15 offset:1520
    ds_read_b128 v[82:85], v15 offset:1536
    ds_read_b64 v[86:87], v14 offset:1552
    ds_read_b128 v[88:91], v15 offset:1040
    ds_read_b128 v[92:95], v15 offset:1056
    ds_read_b64 v[96:97], v14 offset:1072
    ds_read_b128 v[98:101], v15 offset:560
    ds_read_b128 v[102:105], v15 offset:576
    ds_read_b64 v[106:107], v14 offset:592
    ds_read_b128 v[108:111], v15 offset:80
    ds_read_b128 v[112:115], v15 offset:96
    ds_read_b64 v[116:117], v14 offset:112
    v_dot2c_f32_bf16 v26, v16, v38
    v_dot2c_f32_bf16 v27, v16, v48
    v_dot2c_f32_bf16 v28, v16, v58
    v_dot2c_f32_bf16 v29, v16, v68
    v_dot2c_f32_bf16 v26, v17, v39
    v_dot2c_f32_bf16 v27, v17, v49
    v_dot2c_f32_bf16 v28, v17, v59
    v_dot2c_f32_bf16 v29, v17, v69
    v_dot2c_f32_bf16 v26, v18, v40
    v_dot2c_f32_bf16 v27, v18, v50
    v_dot2c_f32_bf16 v28, v18, v60
    v_dot2c_f32_bf16 v29, v18, v70
    v_dot2c_f32_bf16 v26, v19, v41
    v_dot2c_f32_bf16 v27, v19, v51
    v_dot2c_f32_bf16 v28, v19, v61
    v_dot2c_f32_bf16 v29, v19, v71
    v_dot2c_f32_bf16 v26, v20, v42
    v_dot2c_f32_bf16 v27, v20, v52
    v_dot2c_f32_bf16 v28, v20, v62
    v_dot2c_f32_bf16 v29, v20, v72
    v_dot2c_f32_bf16 v26, v21, v43
    v_dot2c_f32_bf16 v27, v21, v53
    v_dot2c_f32_bf16 v28, v21, v63
    v_dot2c_f32_bf16 v29, v21, v73
    v_dot2c_f32_bf16 v26, v22, v44
    v_dot2c_f32_bf16 v27, v22, v54
    v_dot2c_f32_bf16 v28, v22, v64
    v_dot2c_f32_bf16 v29, v22, v74
    v_dot2c_f32_bf16 v26, v23, v45
    v_dot2c_f32_bf16 v27, v23, v55
    v_dot2c_f32_bf16 v28, v23, v65
    v_dot2c_f32_bf16 v29, v23, v75
    v_dot2c_f32_bf16 v26, v24, v46
    v_dot2c_f32_bf16 v27, v24, v56
    v_dot2c_f32_bf16 v28, v24, v66
    v_dot2c_f32_bf16 v29, v24, v76
    v_dot2c_f32_bf16 v26, v25, v47
    v_dot2c_f32_bf16 v27, v25, v57
    v_dot2c_f32_bf16 v28, v25, v67
    v_dot2c_f32_bf16 v29, v25, v77
    s_waitcnt lgkmcnt(0)
    ds_read_b128 v[38:41], v15 offset:3520
    ds_read_b128 v[42:45], v15 offset:3536
    ds_read_b64 v[46:47], v14 offset:3552
    ds_read_b128 v[48:51], v15 offset:3040
    ds_read_b128 v[52:55], v15 offset:3056
    ds_read_b64 v[56:57], v14 offset:3072
    ds_read_b128 v[58:61], v15 offset:2560
    ds_read_b128 v[62:65], v15 offset:2576
    ds_read_b64 v[66:67], v14 offset:2592
    ds_read_b128 v[68:71], v15 offset:2080
    ds_read_b128 v[72:75], v15 offset:2096
    ds_read_b64 v[76:77], v14 offset:2112
    v_dot2c_f32_bf16 v30, v16, v78
    v_dot2c_f32_bf16 v31, v16, v88
    v_dot2c_f32_bf16 v32, v16, v98
    v_dot2c_f32_bf16 v33, v16, v108
    v_dot2c_f32_bf16 v30, v17, v79
    v_dot2c_f32_bf16 v31, v17, v89
    v_dot2c_f32_bf16 v32, v17, v99
    v_dot2c_f32_bf16 v33, v17, v109
    v_dot2c_f32_bf16 v30, v18, v80
    v_dot2c_f32_bf16 v31, v18, v90
    v_dot2c_f32_bf16 v32, v18, v100
    v_dot2c_f32_bf16 v33, v18, v110
    v_dot2c_f32_bf16 v30, v19, v81
    v_dot2c_f32_bf16 v31, v19, v91
    v_dot2c_f32_bf16 v32, v19, v101
    v_dot2c_f32_bf16 v33, v19, v111
    v_dot2c_f32_bf16 v30, v20, v82
    v_dot2c_f32_bf16 v31, v20, v92
    v_dot2c_f32_bf16 v32, v20, v102
    v_dot2c_f32_bf16 v33, v20, v112
    v_dot2c_f32_bf16 v30, v21, v83
    v_dot2c_f32_bf16 v31, v21, v93
    v_dot2c_f32_bf16 v32, v21, v103
    v_dot2c_f32_bf16 v33, v21, v113
    v_dot2c_f32_bf16 v30, v22, v84
    v_dot2c_f32_bf16 v31, v22, v94
    v_dot2c_f32_bf16 v32, v22, v104
    v_dot2c_f32_bf16 v33, v22, v114
    v_dot2c_f32_bf16 v30, v23, v85
    v_dot2c_f32_bf16 v31, v23, v95
    v_dot2c_f32_bf16 v32, v23, v105
    v_dot2c_f32_bf16 v33, v23, v115
    v_dot2c_f32_bf16 v30, v24, v86
    v_dot2c_f32_bf16 v31, v24, v96
    v_dot2c_f32_bf16 v32, v24, v106
    v_dot2c_f32_bf16 v33, v24, v116
    v_dot2c_f32_bf16 v30, v25, v87
    v_dot2c_f32_bf16 v31, v25, v97
    v_dot2c_f32_bf16 v32, v25, v107
    v_dot2c_f32_bf16 v33, v25, v117
    s_waitcnt lgkmcnt(0)
    ds_read_b128 v[78:81], v15 offset:1600
    ds_read_b128 v[82:85], v15 offset:1616
    ds_read_b64 v[86:87], v14 offset:1632
    ds_read_b128 v[88:91], v15 offset:1120
    ds_read_b128 v[92:95], v15 offset:1136
    ds_read_b64 v[96:97], v14 offset:1152
    ds_read_b128 v[98:101], v15 offset:640
    ds_read_b128 v[102:105], v15 offset:656
    ds_read_b64 v[106:107], v14 offset:672
    ds_read_b128 v[108:111], v15 offset:160
    ds_read_b128 v[112:115], v15 offset:176
    ds_read_b64 v[116:117], v14 offset:192
    s_nop 1
    v_mul_f32 v26, 0.3225964182229561, v26
    v_mul_f32 v27, 0.3225964182229561, v27
    v_mul_f32 v28, 0.3225964182229561, v28
    v_mul_f32 v29, 0.3225964182229561, v29
    v_mul_f32 v30, 0.3225964182229561, v30
    v_mul_f32 v31, 0.3225964182229561, v31
    v_mul_f32 v32, 0.3225964182229561, v32
    v_mul_f32 v33, 0.3225964182229561, v33
    s_cmp_lg_u32 s56, 0
    s_cbranch_scc1 sequential_preLN__sliding_local_dilated__glu_gated_bilinear__prompt_kernel_nomask3
    v_mov_b32 v8, -1e9
    v_cmp_le_u32 vcc, 2, v13
    s_nop 1
    v_cndmask_b32 v27, v8, v27, vcc
    v_cmp_le_u32 vcc, 4, v13
    s_nop 1
    v_cndmask_b32 v28, v8, v28, vcc
    v_cmp_le_u32 vcc, 6, v13
    s_nop 1
    v_cndmask_b32 v29, v8, v29, vcc
    v_cmp_le_u32 vcc, 8, v13
    s_nop 1
    v_cndmask_b32 v30, v8, v30, vcc
    v_cmp_le_u32 vcc, 10, v13
    s_nop 1
    v_cndmask_b32 v31, v8, v31, vcc
    v_cmp_le_u32 vcc, 12, v13
    s_nop 1
    v_cndmask_b32 v32, v8, v32, vcc
    v_cmp_le_u32 vcc, 14, v13
    s_nop 1
    v_cndmask_b32 v33, v8, v33, vcc
sequential_preLN__sliding_local_dilated__glu_gated_bilinear__prompt_kernel_nomask3:
    v_max3_f32 v8, v26, v27, v28
    v_max3_f32 v4, v29, v30, v31
    v_max3_f32 v8, v8, v32, v33
    v_max_f32 v8, v8, v4
    v_sub_f32 v26, v26, v8
    v_sub_f32 v27, v27, v8
    v_sub_f32 v28, v28, v8
    v_sub_f32 v29, v29, v8
    v_sub_f32 v30, v30, v8
    v_sub_f32 v31, v31, v8
    v_sub_f32 v32, v32, v8
    v_sub_f32 v33, v33, v8
    v_exp_f32 v26, v26
    v_exp_f32 v27, v27
    v_exp_f32 v28, v28
    v_exp_f32 v29, v29
    v_exp_f32 v30, v30
    v_exp_f32 v31, v31
    v_exp_f32 v32, v32
    v_exp_f32 v33, v33
    v_mov_b32 v16, 0
    v_mov_b32 v17, 0
    v_mov_b32 v18, 0
    v_mov_b32 v19, 0
    v_mov_b32 v20, 0
    v_mov_b32 v21, 0
    v_mov_b32 v22, 0
    v_mov_b32 v23, 0
    v_mov_b32 v24, 0
    v_mov_b32 v25, 0
    v_mov_b32 v118, 0
    v_mov_b32 v119, 0
    v_mov_b32 v120, 0
    v_mov_b32 v121, 0
    v_mov_b32 v122, 0
    v_mov_b32 v123, 0
    v_mov_b32 v124, 0
    v_mov_b32 v125, 0
    v_mov_b32 v126, 0
    v_mov_b32 v127, 0
    v_add_f32 v8, v26, v27
    v_add_f32 v4, v28, v29
    v_add_f32 v3, v30, v31
    v_add_f32 v2, v32, v33
    v_add_f32 v8, v8, v4
    v_add_f32 v3, v3, v2
    v_add_f32 v8, v8, v3
    v_rcp_f32 v8, v8
    s_mov_b32 s42, 0x05040100
    s_mov_b32 s43, 0x07060302
    v_mul_f32 v26, v26, v8
    v_mul_f32 v27, v27, v8
    v_mul_f32 v28, v28, v8
    v_mul_f32 v29, v29, v8
    v_mul_f32 v30, v30, v8
    v_mul_f32 v31, v31, v8
    v_mul_f32 v32, v32, v8
    v_mul_f32 v33, v33, v8
    v_cvt_pk_bf16_f32 v34, v26, v27
    v_cvt_pk_bf16_f32 v35, v28, v29
    v_cvt_pk_bf16_f32 v36, v30, v31
    v_cvt_pk_bf16_f32 v37, v32, v33
    v_perm_b32 v26, v48, v38, s42
    v_perm_b32 v27, v48, v38, s43
    v_perm_b32 v28, v49, v39, s42
    v_perm_b32 v29, v49, v39, s43
    v_perm_b32 v30, v50, v40, s42
    v_dot2c_f32_bf16 v16, v34, v26
    v_perm_b32 v31, v50, v40, s43
    v_dot2c_f32_bf16 v17, v34, v27
    v_perm_b32 v32, v51, v41, s42
    v_dot2c_f32_bf16 v18, v34, v28
    v_perm_b32 v33, v51, v41, s43
    v_dot2c_f32_bf16 v19, v34, v29
    v_perm_b32 v26, v52, v42, s42
    v_dot2c_f32_bf16 v20, v34, v30
    v_perm_b32 v27, v52, v42, s43
    v_dot2c_f32_bf16 v21, v34, v31
    v_perm_b32 v28, v53, v43, s42
    v_dot2c_f32_bf16 v22, v34, v32
    v_perm_b32 v29, v53, v43, s43
    v_dot2c_f32_bf16 v23, v34, v33
    v_perm_b32 v30, v54, v44, s42
    v_dot2c_f32_bf16 v24, v34, v26
    v_perm_b32 v31, v54, v44, s43
    v_dot2c_f32_bf16 v25, v34, v27
    v_perm_b32 v32, v55, v45, s42
    v_dot2c_f32_bf16 v118, v34, v28
    v_perm_b32 v33, v55, v45, s43
    v_dot2c_f32_bf16 v119, v34, v29
    v_perm_b32 v26, v56, v46, s42
    v_dot2c_f32_bf16 v120, v34, v30
    v_perm_b32 v27, v56, v46, s43
    v_dot2c_f32_bf16 v121, v34, v31
    v_perm_b32 v28, v57, v47, s42
    v_dot2c_f32_bf16 v122, v34, v32
    v_perm_b32 v29, v57, v47, s43
    v_dot2c_f32_bf16 v123, v34, v33
    v_dot2c_f32_bf16 v124, v34, v26
    v_dot2c_f32_bf16 v125, v34, v27
    v_dot2c_f32_bf16 v126, v34, v28
    v_dot2c_f32_bf16 v127, v34, v29
    v_perm_b32 v26, v68, v58, s42
    v_perm_b32 v27, v68, v58, s43
    v_perm_b32 v28, v69, v59, s42
    v_perm_b32 v29, v69, v59, s43
    v_perm_b32 v30, v70, v60, s42
    v_dot2c_f32_bf16 v16, v35, v26
    v_perm_b32 v31, v70, v60, s43
    v_dot2c_f32_bf16 v17, v35, v27
    v_perm_b32 v32, v71, v61, s42
    v_dot2c_f32_bf16 v18, v35, v28
    v_perm_b32 v33, v71, v61, s43
    v_dot2c_f32_bf16 v19, v35, v29
    v_perm_b32 v26, v72, v62, s42
    v_dot2c_f32_bf16 v20, v35, v30
    v_perm_b32 v27, v72, v62, s43
    v_dot2c_f32_bf16 v21, v35, v31
    v_perm_b32 v28, v73, v63, s42
    v_dot2c_f32_bf16 v22, v35, v32
    v_perm_b32 v29, v73, v63, s43
    v_dot2c_f32_bf16 v23, v35, v33
    v_perm_b32 v30, v74, v64, s42
    v_dot2c_f32_bf16 v24, v35, v26
    v_perm_b32 v31, v74, v64, s43
    v_dot2c_f32_bf16 v25, v35, v27
    v_perm_b32 v32, v75, v65, s42
    v_dot2c_f32_bf16 v118, v35, v28
    v_perm_b32 v33, v75, v65, s43
    v_dot2c_f32_bf16 v119, v35, v29
    v_perm_b32 v26, v76, v66, s42
    v_dot2c_f32_bf16 v120, v35, v30
    v_perm_b32 v27, v76, v66, s43
    v_dot2c_f32_bf16 v121, v35, v31
    v_perm_b32 v28, v77, v67, s42
    v_dot2c_f32_bf16 v122, v35, v32
    v_perm_b32 v29, v77, v67, s43
    v_dot2c_f32_bf16 v123, v35, v33
    v_dot2c_f32_bf16 v124, v35, v26
    v_dot2c_f32_bf16 v125, v35, v27
    v_dot2c_f32_bf16 v126, v35, v28
    v_dot2c_f32_bf16 v127, v35, v29
    s_waitcnt lgkmcnt(6)
    v_perm_b32 v26, v88, v78, s42
    v_perm_b32 v27, v88, v78, s43
    v_perm_b32 v28, v89, v79, s42
    v_perm_b32 v29, v89, v79, s43
    v_perm_b32 v30, v90, v80, s42
    v_dot2c_f32_bf16 v16, v36, v26
    v_perm_b32 v31, v90, v80, s43
    v_dot2c_f32_bf16 v17, v36, v27
    v_perm_b32 v32, v91, v81, s42
    v_dot2c_f32_bf16 v18, v36, v28
    v_perm_b32 v33, v91, v81, s43
    v_dot2c_f32_bf16 v19, v36, v29
    v_perm_b32 v26, v92, v82, s42
    v_dot2c_f32_bf16 v20, v36, v30
    v_perm_b32 v27, v92, v82, s43
    v_dot2c_f32_bf16 v21, v36, v31
    v_perm_b32 v28, v93, v83, s42
    v_dot2c_f32_bf16 v22, v36, v32
    v_perm_b32 v29, v93, v83, s43
    v_dot2c_f32_bf16 v23, v36, v33
    v_perm_b32 v30, v94, v84, s42
    v_dot2c_f32_bf16 v24, v36, v26
    v_perm_b32 v31, v94, v84, s43
    v_dot2c_f32_bf16 v25, v36, v27
    v_perm_b32 v32, v95, v85, s42
    v_dot2c_f32_bf16 v118, v36, v28
    v_perm_b32 v33, v95, v85, s43
    v_dot2c_f32_bf16 v119, v36, v29
    v_perm_b32 v26, v96, v86, s42
    v_dot2c_f32_bf16 v120, v36, v30
    v_perm_b32 v27, v96, v86, s43
    v_dot2c_f32_bf16 v121, v36, v31
    v_perm_b32 v28, v97, v87, s42
    v_dot2c_f32_bf16 v122, v36, v32
    v_perm_b32 v29, v97, v87, s43
    v_dot2c_f32_bf16 v123, v36, v33
    v_dot2c_f32_bf16 v124, v36, v26
    v_dot2c_f32_bf16 v125, v36, v27
    v_dot2c_f32_bf16 v126, v36, v28
    v_dot2c_f32_bf16 v127, v36, v29
    s_waitcnt lgkmcnt(0)
    v_perm_b32 v26, v108, v98, s42
    v_perm_b32 v27, v108, v98, s43
    v_perm_b32 v28, v109, v99, s42
    v_perm_b32 v29, v109, v99, s43
    v_perm_b32 v30, v110, v100, s42
    v_dot2c_f32_bf16 v16, v37, v26
    v_perm_b32 v31, v110, v100, s43
    v_dot2c_f32_bf16 v17, v37, v27
    v_perm_b32 v32, v111, v101, s42
    v_dot2c_f32_bf16 v18, v37, v28
    v_perm_b32 v33, v111, v101, s43
    v_dot2c_f32_bf16 v19, v37, v29
    v_perm_b32 v26, v112, v102, s42
    v_dot2c_f32_bf16 v20, v37, v30
    v_perm_b32 v27, v112, v102, s43
    v_dot2c_f32_bf16 v21, v37, v31
    v_perm_b32 v28, v113, v103, s42
    v_dot2c_f32_bf16 v22, v37, v32
    v_perm_b32 v29, v113, v103, s43
    v_dot2c_f32_bf16 v23, v37, v33
    v_perm_b32 v30, v114, v104, s42
    v_dot2c_f32_bf16 v24, v37, v26
    v_perm_b32 v31, v114, v104, s43
    v_dot2c_f32_bf16 v25, v37, v27
    v_perm_b32 v32, v115, v105, s42
    v_dot2c_f32_bf16 v118, v37, v28
    v_perm_b32 v33, v115, v105, s43
    v_dot2c_f32_bf16 v119, v37, v29
    v_perm_b32 v26, v116, v106, s42
    v_dot2c_f32_bf16 v120, v37, v30
    v_perm_b32 v27, v116, v106, s43
    v_dot2c_f32_bf16 v121, v37, v31
    v_perm_b32 v28, v117, v107, s42
    v_dot2c_f32_bf16 v122, v37, v32
    v_perm_b32 v29, v117, v107, s43
    v_dot2c_f32_bf16 v123, v37, v33
    v_dot2c_f32_bf16 v124, v37, v26
    v_dot2c_f32_bf16 v125, v37, v27
    v_dot2c_f32_bf16 v126, v37, v28
    v_dot2c_f32_bf16 v127, v37, v29
    s_nop 2
    v_cvt_pk_bf16_f32 v38, v16, v17
    v_cvt_pk_bf16_f32 v39, v18, v19
    v_cvt_pk_bf16_f32 v40, v20, v21
    v_cvt_pk_bf16_f32 v41, v22, v23
    v_cvt_pk_bf16_f32 v42, v24, v25
    v_cvt_pk_bf16_f32 v43, v118, v119
    v_cvt_pk_bf16_f32 v44, v120, v121
    v_cvt_pk_bf16_f32 v45, v122, v123
    v_cvt_pk_bf16_f32 v46, v124, v125
    v_cvt_pk_bf16_f32 v47, v126, v127
    s_mov_b32 s42, 22020096
    buffer_store_dwordx4 v[38:41], v5, s[8:11], s42 offen sc1
    buffer_store_dwordx4 v[42:45], v6, s[8:11], s42 offen sc1
    buffer_store_dwordx2 v[46:47], v7, s[8:11], s42 offen sc1
    s_setprio 0
    s_waitcnt vmcnt(0)
    s_lshl_b32 s36, s56, 2
    s_add_u32 s36, s36, s3
    s_lshl_b32 s36, s36, 7
    s_lshl_b32 s37, s57, 2
    s_add_u32 s36, s36, s37
    s_add_u32 s36, s36, 38338560
    v_mov_b32 v3, s60
    v_mov_b32 v4, 0
    s_mov_b64 exec, 1
    buffer_atomic_swap v3, v4, s[8:11], s36 offen sc1
    s_mov_b64 exec, -1
    s_barrier
    v_lshlrev_b32 v2, 4, v1
    s_mul_i32 s42, s57, 7
    s_sub_u32 s43, s57, 12
    s_cmp_gt_u32 s57, 12
    s_cselect_b32 s43, s43, 0
    s_sub_u32 s42, s42, s43
    s_cmp_lt_u32 s57, 12
    s_cselect_b32 s43, 7, 6
    s_barrier
    v_min_u32 v4, 59, v1
    v_cmp_le_u32 vcc, 30, v4
    v_mov_b32 v5, 0
    v_mov_b32 v6, 30
    v_cndmask_b32 v5, v5, v6, vcc
    v_sub_u32 v6, v4, v5
    s_lshr_b32 s36, s42, 2
    s_mul_i32 s36, s36, 10
    v_add_u32 v6, s36, v6
    v_min_u32 v6, 0x10d, v6
    v_mul_u32_u24 v5, 9, v5
    v_add_u32 v4, v6, v5
    v_lshlrev_b32 v4, 3, v4
    v_add_u32 v4, 38141952, v4
    s_mov_b32 s51, 0
sequential_preLN__sliding_local_dilated__glu_gated_bilinear__prompt_kernel_poll4:
    buffer_load_dword v3, v4, s[8:11], 0 offen sc1
    s_add_u32 s51, s51, 1
    s_cmp_gt_u32 s51, 200000
    s_cbranch_scc1 sequential_preLN__sliding_local_dilated__glu_gated_bilinear__prompt_kernel_pollx5
    s_waitcnt vmcnt(0)
    v_cmp_ne_u32 vcc, s60, v3
    s_nop 1
    s_cbranch_vccz sequential_preLN__sliding_local_dilated__glu_gated_bilinear__prompt_kernel_pollx5
    s_sleep 2
    s_branch sequential_preLN__sliding_local_dilated__glu_gated_bilinear__prompt_kernel_poll4
sequential_preLN__sliding_local_dilated__glu_gated_bilinear__prompt_kernel_pollx5:
    s_waitcnt vmcnt(0)
    s_mul_i32 s47, s42, 40960
    s_mul_i32 s48, s3, 5120
    s_add_u32 s47, s47, s48
    s_add_u32 s47, s47, 10485760
    s_add_u32 m0, s48, 0
    s_add_u32 s50, s47, 0
    buffer_load_dwordx4 v2, s[8:11], s50 offen sc1 lds
    s_add_u32 m0, s48, 1024
    s_add_u32 s50, s47, 1024
    buffer_load_dwordx4 v2, s[8:11], s50 offen sc1 lds
    s_add_u32 m0, s48, 2048
    s_add_u32 s50, s47, 2048
    buffer_load_dwordx4 v2, s[8:11], s50 offen sc1 lds
    s_add_u32 m0, s48, 3072
    s_add_u32 s50, s47, 3072
    buffer_load_dwordx4 v2, s[8:11], s50 offen sc1 lds
    s_add_u32 m0, s48, 4096
    s_add_u32 s50, s47, 4096
    buffer_load_dwordx4 v2, s[8:11], s50 offen sc1 lds
    s_add_u32 m0, s48, 20480
    s_add_u32 s50, s47, 20480
    buffer_load_dwordx4 v2, s[8:11], s50 offen sc1 lds
    s_add_u32 m0, s48, 21504
    s_add_u32 s50, s47, 21504
    buffer_load_dwordx4 v2, s[8:11], s50 offen sc1 lds
    s_add_u32 m0, s48, 22528
    s_add_u32 s50, s47, 22528
    buffer_load_dwordx4 v2, s[8:11], s50 offen sc1 lds
    s_add_u32 m0, s48, 23552
    s_add_u32 s50, s47, 23552
    buffer_load_dwordx4 v2, s[8:11], s50 offen sc1 lds
    s_add_u32 m0, s48, 24576
    s_add_u32 s50, s47, 24576
    buffer_load_dwordx4 v2, s[8:11], s50 offen sc1 lds
    s_add_u32 m0, s48, 40960
    s_add_u32 s50, s47, 40960
    buffer_load_dwordx4 v2, s[8:11], s50 offen sc1 lds
    s_add_u32 m0, s48, 41984
    s_add_u32 s50, s47, 41984
    buffer_load_dwordx4 v2, s[8:11], s50 offen sc1 lds
    s_add_u32 m0, s48, 43008
    s_add_u32 s50, s47, 43008
    buffer_load_dwordx4 v2, s[8:11], s50 offen sc1 lds
    s_add_u32 m0, s48, 44032
    s_add_u32 s50, s47, 44032
    buffer_load_dwordx4 v2, s[8:11], s50 offen sc1 lds
    s_add_u32 m0, s48, 45056
    s_add_u32 s50, s47, 45056
    buffer_load_dwordx4 v2, s[8:11], s50 offen sc1 lds
    s_lshl_b32 s45, s3, 6
    v_add_u32 v3, s45, v1
    v_lshlrev_b32 v4, 2, v3
    s_lshl_b32 s45, s42, 7
    s_add_u32 s45, s45, 20971520
    s_lshl_b32 s46, s43, 5
    v_mov_b32 v5, 0x80000000
    v_cmp_gt_u32 vcc, s46, v3
    s_nop 1
    v_cndmask_b32 v5, v5, v4, vcc
    s_add_u32 s46, s45, 0
    buffer_load_dword v16, v5, s[8:11], s46 offen sc1
    s_add_u32 s46, s45, 13824
    buffer_load_dword v17, v5, s[8:11], s46 offen sc1
    s_add_u32 s46, s45, 27648
    buffer_load_dword v18, v5, s[8:11], s46 offen sc1
    s_add_u32 s46, s45, 41472
    buffer_load_dword v19, v5, s[8:11], s46 offen sc1
    s_add_u32 s46, s45, 55296
    buffer_load_dword v20, v5, s[8:11], s46 offen sc1
    s_add_u32 s46, s45, 69120
    buffer_load_dword v21, v5, s[8:11], s46 offen sc1
    s_add_u32 s46, s45, 82944
    buffer_load_dword v22, v5, s[8:11], s46 offen sc1
    s_add_u32 s46, s45, 96768
    buffer_load_dword v23, v5, s[8:11], s46 offen sc1
    s_add_u32 s46, s45, 110592
    buffer_load_dword v24, v5, s[8:11], s46 offen sc1
    s_add_u32 s46, s45, 124416
    buffer_load_dword v25, v5, s[8:11], s46 offen sc1
    s_waitcnt vmcnt(0)
    v_add_f32 v16, v16, v21
    v_add_f32 v17, v17, v22
    v_add_f32 v18, v18, v23
    v_add_f32 v19, v19, v24
    v_add_f32 v20, v20, v25
    v_add_f32 v16, v16, v17
    v_add_f32 v18, v18, v19
    v_add_f32 v16, v16, v20
    v_add_f32 v16, v16, v18
    v_add_u32 v124, 143360, v4
    v_mov_b32 v125, v16
    v_mov_b32 v126, v3
    s_barrier
    v_cmp_gt_u32 vcc, 224, v126
    s_and_saveexec_b64 s[54:55], vcc
    ds_write_b32 v124, v125
    s_mov_b64 exec, s[54:55]
    s_lshr_b32 s36, s3, 1
    s_lshl_b32 s37, s56, 1
    s_add_u32 s36, s36, s37
    s_lshl_b32 s36, s36, 2
    s_and_b32 s37, s3, 1
    s_lshl_b32 s37, s37, 1
    s_add_u32 s36, s36, s37
    s_lshl_b32 s36, s36, 7
    s_add_u32 s36, s36, 38273024
    v_and_b32 v4, 7, v1
    v_lshlrev_b32 v4, 2, v4
    v_bfe_u32 v5, v1, 3, 1
    v_lshl_add_u32 v4, v5, 7, v4
    v_add_u32 v4, s36, v4
    s_mov_b32 s51, 0
sequential_preLN__sliding_local_dilated__glu_gated_bilinear__prompt_kernel_poll6:
    buffer_load_dword v3, v4, s[8:11], 0 offen sc1
    s_add_u32 s51, s51, 1
    s_cmp_gt_u32 s51, 200000
    s_cbranch_scc1 sequential_preLN__sliding_local_dilated__glu_gated_bilinear__prompt_kernel_pollx7
    s_waitcnt vmcnt(0)
    v_cmp_ne_u32 vcc, s60, v3
    s_nop 1
    s_cbranch_vccz sequential_preLN__sliding_local_dilated__glu_gated_bilinear__prompt_kernel_pollx7
    s_sleep 2
    s_branch sequential_preLN__sliding_local_dilated__glu_gated_bilinear__prompt_kernel_poll6
sequential_preLN__sliding_local_dilated__glu_gated_bilinear__prompt_kernel_pollx7:
    s_waitcnt vmcnt(0)
    v_and_b32 v3, 31, v1
    v_lshrrev_b32 v4, 5, v1
    s_lshl_b32 s44, s56, 7
    s_lshl_b32 s45, s3, 5
    s_add_u32 s44, s44, s45
    v_add_u32 v5, s44, v3
    v_lshrrev_b32 v6, 4, v5
    s_movk_i32 s44, 20480
    v_mul_lo_u32 v6, v6, s44
    v_and_b32 v7, 15, v5
    v_lshl_add_u32 v6, v7, 4, v6
    v_lshl_add_u32 v6, v4, 8, v6
    v_lshlrev_b32 v7, 6, v5
    v_lshl_add_u32 v7, v4, 5, v7
    s_mov_b32 s44, 28311552
    buffer_load_dwordx4 v[60:63], v7, s[8:11], s44 offen sc1
    buffer_load_dwordx4 v[64:67], v7, s[8:11], s44 offen offset:16 sc1
    s_mov_b32 s44, 25165824
    buffer_load_dwordx4 a[0:3], v6, s[8:11], s44 offen offset:0 sc1
    s_mov_b32 s44, 25165824
    buffer_load_dwordx4 a[4:7], v6, s[8:11], s44 offen offset:512 sc1
    s_mov_b32 s44, 25165824
    buffer_load_dwordx4 a[8:11], v6, s[8:11], s44 offen offset:1024 sc1
    s_mov_b32 s44, 25165824
    buffer_load_dwordx4 a[12:15], v6, s[8:11], s44 offen offset:1536 sc1
    s_mov_b32 s44, 25165824
    buffer_load_dwordx4 a[16:19], v6, s[8:11], s44 offen offset:2048 sc1
    s_mov_b32 s44, 25165824
    buffer_load_dwordx4 a[20:23], v6, s[8:11], s44 offen offset:2560 sc1
    s_mov_b32 s44, 25165824
    buffer_load_dwordx4 a[24:27], v6, s[8:11], s44 offen offset:3072 sc1
    s_mov_b32 s44, 25165824
    buffer_load_dwordx4 a[28:31], v6, s[8:11], s44 offen offset:3584 sc1
    s_mov_b32 s44, 25169920
    buffer_load_dwordx4 a[32:35], v6, s[8:11], s44 offen offset:0 sc1
    s_mov_b32 s44, 25169920
    buffer_load_dwordx4 a[36:39], v6, s[8:11], s44 offen offset:512 sc1
    s_mov_b32 s44, 25169920
    buffer_load_dwordx4 a[40:43], v6, s[8:11], s44 offen offset:1024 sc1
    s_mov_b32 s44, 25169920
    buffer_load_dwordx4 a[44:47], v6, s[8:11], s44 offen offset:1536 sc1
    s_mov_b32 s44, 25169920
    buffer_load_dwordx4 a[48:51], v6, s[8:11], s44 offen offset:2048 sc1
    s_mov_b32 s44, 25169920
    buffer_load_dwordx4 a[52:55], v6, s[8:11], s44 offen offset:2560 sc1
    s_mov_b32 s44, 25169920
    buffer_load_dwordx4 a[56:59], v6, s[8:11], s44 offen offset:3072 sc1
    s_mov_b32 s44, 25169920
    buffer_load_dwordx4 a[60:63], v6, s[8:11], s44 offen offset:3584 sc1
    s_mov_b32 s44, 25174016
    buffer_load_dwordx4 a[64:67], v6, s[8:11], s44 offen offset:0 sc1
    s_mov_b32 s44, 25174016
    buffer_load_dwordx4 a[68:71], v6, s[8:11], s44 offen offset:512 sc1
    s_mov_b32 s44, 25174016
    buffer_load_dwordx4 a[72:75], v6, s[8:11], s44 offen offset:1024 sc1
    s_mov_b32 s44, 25174016
    buffer_load_dwordx4 a[76:79], v6, s[8:11], s44 offen offset:1536 sc1
    s_mov_b32 s44, 25174016
    buffer_load_dwordx4 a[80:83], v6, s[8:11], s44 offen offset:2048 sc1
    s_mov_b32 s44, 25174016
    buffer_load_dwordx4 a[84:87], v6, s[8:11], s44 offen offset:2560 sc1
    s_mov_b32 s44, 25174016
    buffer_load_dwordx4 a[88:91], v6, s[8:11], s44 offen offset:3072 sc1
    s_mov_b32 s44, 25174016
    buffer_load_dwordx4 a[92:95], v6, s[8:11], s44 offen offset:3584 sc1
    s_mov_b32 s44, 25178112
    buffer_load_dwordx4 a[96:99], v6, s[8:11], s44 offen offset:0 sc1
    s_mov_b32 s44, 25178112
    buffer_load_dwordx4 a[100:103], v6, s[8:11], s44 offen offset:512 sc1
    s_mov_b32 s44, 25178112
    buffer_load_dwordx4 a[104:107], v6, s[8:11], s44 offen offset:1024 sc1
    s_mov_b32 s44, 25178112
    buffer_load_dwordx4 a[108:111], v6, s[8:11], s44 offen offset:1536 sc1
    v_lshrrev_b32 v10, 4, v5
    s_mov_b32 s44, 55296
    v_mul_lo_u32 v10, v10, s44
    v_and_b32 v7, 15, v5
    v_lshl_add_u32 v10, v7, 4, v10
    v_lshl_add_u32 v10, v4, 8, v10
    v_lshlrev_b32 v11, 4, v4
    v_add_u32 v11, 143360, v11
    v_mov_b32 v12, v2
    v_add_u32 v13, 61440, v2
    v_add_u32 v14, 122880, v2
    s_waitcnt lgkmcnt(0)
    s_barrier
    s_setprio 2
    ds_read_b128 v[48:51], v12 offset:0
    ds_read_b128 v[52:55], v12 offset:1024
    ds_read_b128 v[56:59], v12 offset:2048
    s_waitcnt lgkmcnt(2)
    s_mov_b32 s44, 25178112
    buffer_load_dwordx4 a[112:115], v6, s[8:11], s44 offen offset:2048 sc1
    s_waitcnt vmcnt(28)
    v_mfma_f32_32x32x16_bf16 v[16:31], v[48:51], a[0:3], 0
    ds_read_b128 v[48:51], v12 offset:3072
    s_waitcnt lgkmcnt(2)
    s_mov_b32 s44, 25178112
    buffer_load_dwordx4 a[116:119], v6, s[8:11], s44 offen offset:2560 sc1
    s_waitcnt vmcnt(28)
    v_mfma_f32_32x32x16_bf16 v[16:31], v[52:55], a[4:7], v[16:31]
    ds_read_b128 v[52:55], v12 offset:4096
    s_waitcnt lgkmcnt(2)
    s_mov_b32 s44, 25178112
    buffer_load_dwordx4 a[120:123], v6, s[8:11], s44 offen offset:3072 sc1
    s_waitcnt vmcnt(28)
    v_mfma_f32_32x32x16_bf16 v[16:31], v[56:59], a[8:11], v[16:31]
    ds_read_b128 v[56:59], v12 offset:5120
    s_waitcnt lgkmcnt(2)
    s_mov_b32 s44, 25178112
    buffer_load_dwordx4 a[124:127], v6, s[8:11], s44 offen offset:3584 sc1
    s_waitcnt vmcnt(28)
    v_mfma_f32_32x32x16_bf16 v[16:31], v[48:51], a[12:15], v[16:31]
    ds_read_b128 v[48:51], v12 offset:6144
    s_waitcnt lgkmcnt(2)
    s_mov_b32 s44, 25182208
    buffer_load_dwordx4 v[96:99], v6, s[8:11], s44 offen offset:0 sc1
    s_waitcnt vmcnt(28)
    v_mfma_f32_32x32x16_bf16 v[16:31], v[52:55], a[16:19], v[16:31]
    ds_read_b128 v[52:55], v12 offset:7168
    s_waitcnt lgkmcnt(2)
    s_mov_b32 s44, 25182208
    buffer_load_dwordx4 v[100:103], v6, s[8:11], s44 offen offset:512 sc1
    s_waitcnt vmcnt(28)
    v_mfma_f32_32x32x16_bf16 v[16:31], v[56:59], a[20:23], v[16:31]
    ds_read_b128 v[56:59], v12 offset:8192
    s_waitcnt lgkmcnt(2)
    s_mov_b32 s44, 25182208
    buffer_load_dwordx4 v[104:107], v6, s[8:11], s44 offen offset:1024 sc1
    s_waitcnt vmcnt(28)
    v_mfma_f32_32x32x16_bf16 v[16:31], v[48:51], a[24:27], v[16:31]
    ds_read_b128 v[48:51], v12 offset:9216
    s_waitcnt lgkmcnt(2)
    s_mov_b32 s44, 25182208
    buffer_load_dwordx4 v[108:111], v6, s[8:11], s44 offen offset:1536 sc1
    s_waitcnt vmcnt(28)
    v_mfma_f32_32x32x16_bf16 v[16:31], v[52:55], a[28:31], v[16:31]
    ds_read_b128 v[52:55], v12 offset:10240
    s_waitcnt lgkmcnt(2)
    s_mov_b32 s44, 25182208
    buffer_load_dwordx4 v[112:115], v6, s[8:11], s44 offen offset:2048 sc1
    s_waitcnt vmcnt(28)
    v_mfma_f32_32x32x16_bf16 v[16:31], v[56:59], a[32:35], v[16:31]
    ds_read_b128 v[56:59], v12 offset:11264
    s_waitcnt lgkmcnt(2)
    s_mov_b32 s44, 25182208
    buffer_load_dwordx4 v[116:119], v6, s[8:11], s44 offen offset:2560 sc1
    s_waitcnt vmcnt(28)
    v_mfma_f32_32x32x16_bf16 v[16:31], v[48:51], a[36:39], v[16:31]
    ds_read_b128 v[48:51], v12 offset:12288
    s_waitcnt lgkmcnt(2)
    s_mov_b32 s44, 25182208
    buffer_load_dwordx4 v[120:123], v6, s[8:11], s44 offen offset:3072 sc1
    s_waitcnt vmcnt(28)
    v_mfma_f32_32x32x16_bf16 v[16:31], v[52:55], a[40:43], v[16:31]
    ds_read_b128 v[52:55], v12 offset:13312
    s_waitcnt lgkmcnt(2)
    s_mov_b32 s44, 25182208
    buffer_load_dwordx4 v[124:127], v6, s[8:11], s44 offen offset:3584 sc1
    s_waitcnt vmcnt(28)
    v_mfma_f32_32x32x16_bf16 v[16:31], v[56:59], a[44:47], v[16:31]
    ds_read_b128 v[56:59], v12 offset:14336
    s_waitcnt lgkmcnt(2)
    s_waitcnt vmcnt(27)
    v_mfma_f32_32x32x16_bf16 v[16:31], v[48:51], a[48:51], v[16:31]
    ds_read_b128 v[48:51], v12 offset:15360
    s_waitcnt lgkmcnt(2)
    s_waitcnt vmcnt(26)
    v_mfma_f32_32x32x16_bf16 v[16:31], v[52:55], a[52:55], v[16:31]
    ds_read_b128 v[52:55], v12 offset:16384
    s_waitcnt lgkmcnt(2)
    s_waitcnt vmcnt(25)
    v_mfma_f32_32x32x16_bf16 v[16:31], v[56:59], a[56:59], v[16:31]
    ds_read_b128 v[56:59], v12 offset:17408
    s_waitcnt lgkmcnt(2)
    s_waitcnt vmcnt(24)
    v_mfma_f32_32x32x16_bf16 v[16:31], v[48:51], a[60:63], v[16:31]
    ds_read_b128 v[48:51], v12 offset:18432
    s_waitcnt lgkmcnt(2)
    s_waitcnt vmcnt(23)
    v_mfma_f32_32x32x16_bf16 v[16:31], v[52:55], a[64:67], v[16:31]
    ds_read_b128 v[52:55], v12 offset:19456
    s_waitcnt lgkmcnt(2)
    s_waitcnt vmcnt(22)
    v_mfma_f32_32x32x16_bf16 v[16:31], v[56:59], a[68:71], v[16:31]
    ds_read_b128 v[56:59], v12 offset:20480
    s_waitcnt lgkmcnt(2)
    s_waitcnt vmcnt(21)
    v_mfma_f32_32x32x16_bf16 v[16:31], v[48:51], a[72:75], v[16:31]
    ds_read_b128 v[48:51], v12 offset:21504
    s_waitcnt lgkmcnt(2)
    s_waitcnt vmcnt(20)
    v_mfma_f32_32x32x16_bf16 v[16:31], v[52:55], a[76:79], v[16:31]
    s_barrier
    ds_read_b128 v[52:55], v12 offset:22528
    s_waitcnt lgkmcnt(2)
    s_waitcnt vmcnt(19)
    v_mfma_f32_32x32x16_bf16 v[16:31], v[56:59], a[80:83], v[16:31]
    ds_read_b128 v[56:59], v12 offset:23552
    s_waitcnt lgkmcnt(2)
    s_waitcnt vmcnt(18)
    v_mfma_f32_32x32x16_bf16 v[16:31], v[48:51], a[84:87], v[16:31]
    ds_read_b128 v[48:51], v12 offset:24576
    s_waitcnt lgkmcnt(2)
    s_waitcnt vmcnt(17)
    v_mfma_f32_32x32x16_bf16 v[16:31], v[52:55], a[88:91], v[16:31]
    ds_read_b128 v[52:55], v12 offset:25600
    s_waitcnt lgkmcnt(2)
    s_waitcnt vmcnt(16)
    v_mfma_f32_32x32x16_bf16 v[16:31], v[56:59], a[92:95], v[16:31]
    ds_read_b128 v[56:59], v12 offset:26624
    s_waitcnt lgkmcnt(2)
    s_waitcnt vmcnt(15)
    v_mfma_f32_32x32x16_bf16 v[16:31], v[48:51], a[96:99], v[16:31]
    ds_read_b128 v[48:51], v12 offset:27648
    s_waitcnt lgkmcnt(2)
    s_waitcnt vmcnt(14)
    v_mfma_f32_32x32x16_bf16 v[16:31], v[52:55], a[100:103], v[16:31]
    ds_read_b128 v[52:55], v12 offset:28672
    s_waitcnt lgkmcnt(2)
    s_waitcnt vmcnt(13)
    v_mfma_f32_32x32x16_bf16 v[16:31], v[56:59], a[104:107], v[16:31]
    ds_read_b128 v[56:59], v12 offset:29696
    s_waitcnt lgkmcnt(2)
    s_waitcnt vmcnt(12)
    v_mfma_f32_32x32x16_bf16 v[16:31], v[48:51], a[108:111], v[16:31]
    ds_read_b128 v[48:51], v12 offset:30720
    s_waitcnt lgkmcnt(2)
    s_waitcnt vmcnt(11)
    v_mfma_f32_32x32x16_bf16 v[16:31], v[52:55], a[112:115], v[16:31]
    ds_read_b128 v[52:55], v12 offset:31744
    s_waitcnt lgkmcnt(2)
    s_waitcnt vmcnt(10)
    v_mfma_f32_32x32x16_bf16 v[16:31], v[56:59], a[116:119], v[16:31]
    ds_read_b128 v[56:59], v12 offset:32768
    s_waitcnt lgkmcnt(2)
    s_waitcnt vmcnt(9)
    v_mfma_f32_32x32x16_bf16 v[16:31], v[48:51], a[120:123], v[16:31]
    ds_read_b128 v[48:51], v12 offset:33792
    s_waitcnt lgkmcnt(2)
    s_waitcnt vmcnt(8)
    v_mfma_f32_32x32x16_bf16 v[16:31], v[52:55], a[124:127], v[16:31]
    ds_read_b128 v[52:55], v12 offset:34816
    s_waitcnt lgkmcnt(2)
    s_waitcnt vmcnt(7)
    v_mfma_f32_32x32x16_bf16 v[16:31], v[56:59], v[96:99], v[16:31]
    ds_read_b128 v[56:59], v12 offset:35840
    s_waitcnt lgkmcnt(2)
    s_waitcnt vmcnt(6)
    v_mfma_f32_32x32x16_bf16 v[16:31], v[48:51], v[100:103], v[16:31]
    ds_read_b128 v[48:51], v12 offset:36864
    s_waitcnt lgkmcnt(2)
    s_waitcnt vmcnt(5)
    v_mfma_f32_32x32x16_bf16 v[16:31], v[52:55], v[104:107], v[16:31]
    ds_read_b128 v[52:55], v12 offset:37888
    s_waitcnt lgkmcnt(2)
    s_waitcnt vmcnt(4)
    v_mfma_f32_32x32x16_bf16 v[16:31], v[56:59], v[108:111], v[16:31]
    ds_read_b128 v[56:59], v12 offset:38912
    s_waitcnt lgkmcnt(2)
    s_waitcnt vmcnt(3)
    v_mfma_f32_32x32x16_bf16 v[16:31], v[48:51], v[112:115], v[16:31]
    ds_read_b128 v[48:51], v12 offset:39936
    s_waitcnt lgkmcnt(2)
    s_waitcnt vmcnt(2)
    v_mfma_f32_32x32x16_bf16 v[16:31], v[52:55], v[116:119], v[16:31]
    ds_read_b128 v[52:55], v12 offset:40960
    s_waitcnt lgkmcnt(2)
    s_waitcnt vmcnt(1)
    v_mfma_f32_32x32x16_bf16 v[16:31], v[56:59], v[120:123], v[16:31]
    ds_read_b128 v[56:59], v12 offset:41984
    s_waitcnt lgkmcnt(2)
    s_waitcnt vmcnt(0)
    v_mfma_f32_32x32x16_bf16 v[16:31], v[48:51], v[124:127], v[16:31]
    s_barrier
    ds_read_b128 v[48:51], v12 offset:43008
    s_waitcnt lgkmcnt(2)
    v_mfma_f32_32x32x16_bf16 v[32:47], v[52:55], a[0:3], 0
    ds_read_b128 v[52:55], v12 offset:44032
    s_waitcnt lgkmcnt(2)
    v_mfma_f32_32x32x16_bf16 v[32:47], v[56:59], a[4:7], v[32:47]
    ds_read_b128 v[56:59], v12 offset:45056
    s_waitcnt lgkmcnt(2)
    v_mfma_f32_32x32x16_bf16 v[32:47], v[48:51], a[8:11], v[32:47]
    v_add_f32 v60, v60, v62
    v_add_f32 v61, v61, v63
    ds_read_b128 v[48:51], v12 offset:46080
    s_waitcnt lgkmcnt(2)
    v_mfma_f32_32x32x16_bf16 v[32:47], v[52:55], a[12:15], v[32:47]
    v_add_f32 v64, v64, v66
    v_add_f32 v65, v65, v67
    ds_read_b128 v[52:55], v12 offset:47104
    s_waitcnt lgkmcnt(2)
    v_mfma_f32_32x32x16_bf16 v[32:47], v[56:59], a[16:19], v[32:47]
    v_add_f32 v60, v60, v64
    v_add_f32 v61, v61, v65
    ds_read_b128 v[56:59], v12 offset:48128
    s_waitcnt lgkmcnt(2)
    v_mfma_f32_32x32x16_bf16 v[32:47], v[48:51], a[20:23], v[32:47]
    v_mov_b32 v62, v60
    v_mov_b32 v63, v61
    ds_read_b128 v[48:51], v12 offset:49152
    s_waitcnt lgkmcnt(2)
    v_mfma_f32_32x32x16_bf16 v[32:47], v[52:55], a[24:27], v[32:47]
    s_nop 1
    v_permlane32_swap_b32 v62, v60
    ds_read_b128 v[52:55], v12 offset:50176
    s_waitcnt lgkmcnt(2)
    v_mfma_f32_32x32x16_bf16 v[32:47], v[56:59], a[28:31], v[32:47]
    v_permlane32_swap_b32 v63, v61
    s_nop 1
    ds_read_b128 v[56:59], v12 offset:51200
    s_waitcnt lgkmcnt(2)
    v_mfma_f32_32x32x16_bf16 v[32:47], v[48:51], a[32:35], v[32:47]
    v_add_f32 v60, v60, v62
    v_add_f32 v61, v61, v63
    ds_read_b128 v[48:51], v12 offset:52224
    s_waitcnt lgkmcnt(2)
    v_mfma_f32_32x32x16_bf16 v[32:47], v[52:55], a[36:39], v[32:47]
    v_mul_f32 v60, 0.0015625, v60
    v_mul_f32 v61, 0.0015625, v61
    ds_read_b128 v[52:55], v12 offset:53248
    s_waitcnt lgkmcnt(2)
    v_mfma_f32_32x32x16_bf16 v[32:47], v[56:59], a[40:43], v[32:47]
    v_fma_f32 v61, -v60, v60, v61
    v_max_f32 v61, 0, v61
    ds_read_b128 v[56:59], v12 offset:54272
    s_waitcnt lgkmcnt(2)
    v_mfma_f32_32x32x16_bf16 v[32:47], v[48:51], a[44:47], v[32:47]
    v_add_f32 v61, 1e-5, v61
    v_rcp_f32 v9, v61
    ds_read_b128 v[48:51], v12 offset:55296
    s_waitcnt lgkmcnt(2)
    v_mfma_f32_32x32x16_bf16 v[32:47], v[52:55], a[48:51], v[32:47]
    v_sub_f32 v8, 0, v60
    ds_read_b128 v[60:63], v11 offset:0
    ds_read_b128 v[52:55], v12 offset:56320
    s_waitcnt lgkmcnt(3)
    v_mfma_f32_32x32x16_bf16 v[32:47], v[56:59], a[52:55], v[32:47]
    ds_read_b128 v[64:67], v11 offset:32
    ds_read_b128 v[68:71], v11 offset:64
    ds_read_b128 v[56:59], v12 offset:57344
    s_waitcnt lgkmcnt(5)
    v_mfma_f32_32x32x16_bf16 v[32:47], v[48:51], a[56:59], v[32:47]
    ds_read_b128 v[72:75], v11 offset:96
    s_waitcnt lgkmcnt(0)
    ds_read_b128 v[48:51], v12 offset:58368
    v_mfma_f32_32x32x16_bf16 v[32:47], v[52:55], a[60:63], v[32:47]
    v_fma_f32 v60, v8, v60, v16
    v_fma_f32 v61, v8, v61, v17
    ds_read_b128 v[52:55], v12 offset:59392
    v_mfma_f32_32x32x16_bf16 v[32:47], v[56:59], a[64:67], v[32:47]
    v_fma_f32 v62, v8, v62, v18
    v_fma_f32 v63, v8, v63, v19
    ds_read_b128 v[56:59], v12 offset:60416
    s_waitcnt lgkmcnt(2)
    v_mfma_f32_32x32x16_bf16 v[32:47], v[48:51], a[68:71], v[32:47]
    v_fma_f32 v64, v8, v64, v20
    v_fma_f32 v65, v8, v65, v21
    ds_read_b128 v[48:51], v13 offset:0
    s_waitcnt lgkmcnt(2)
    v_mfma_f32_32x32x16_bf16 v[32:47], v[52:55], a[72:75], v[32:47]
    v_fma_f32 v66, v8, v66, v22
    v_fma_f32 v67, v8, v67, v23
    ds_read_b128 v[52:55], v13 offset:1024
    s_waitcnt lgkmcnt(2)
    v_mfma_f32_32x32x16_bf16 v[32:47], v[56:59], a[76:79], v[32:47]
    v_fma_f32 v68, v8, v68, v24
    v_fma_f32 v69, v8, v69, v25
    s_barrier
    ds_read_b128 v[56:59], v13 offset:2048
    s_waitcnt lgkmcnt(2)
    v_mfma_f32_32x32x16_bf16 v[32:47], v[48:51], a[80:83], v[32:47]
    v_fma_f32 v70, v8, v70, v26
    v_fma_f32 v71, v8, v71, v27
    ds_read_b128 v[48:51], v13 offset:3072
    s_waitcnt lgkmcnt(2)
    v_mfma_f32_32x32x16_bf16 v[32:47], v[52:55], a[84:87], v[32:47]
    v_fma_f32 v72, v8, v72, v28
    v_fma_f32 v73, v8, v73, v29
    ds_read_b128 v[52:55], v13 offset:4096
    s_waitcnt lgkmcnt(2)
    v_mfma_f32_32x32x16_bf16 v[32:47], v[56:59], a[88:91], v[32:47]
    v_fma_f32 v74, v8, v74, v30
    v_fma_f32 v75, v8, v75, v31
    ds_read_b128 v[56:59], v13 offset:5120
    s_waitcnt lgkmcnt(2)
    v_mfma_f32_32x32x16_bf16 v[32:47], v[48:51], a[92:95], v[32:47]
    v_mul_f32 v60, v60, v68
    v_mul_f32 v61, v61, v69
    ds_read_b128 v[48:51], v13 offset:6144
    s_waitcnt lgkmcnt(2)
    v_mfma_f32_32x32x16_bf16 v[32:47], v[52:55], a[96:99], v[32:47]
    v_mul_f32 v62, v62, v70
    v_mul_f32 v63, v63, v71
    ds_read_b128 v[52:55], v13 offset:7168
    s_waitcnt lgkmcnt(2)
    v_mfma_f32_32x32x16_bf16 v[32:47], v[56:59], a[100:103], v[32:47]
    v_mul_f32 v64, v64, v72
    v_mul_f32 v65, v65, v73
    ds_read_b128 v[56:59], v13 offset:8192
    s_waitcnt lgkmcnt(2)
    v_mfma_f32_32x32x16_bf16 v[32:47], v[48:51], a[104:107], v[32:47]
    v_mul_f32 v66, v66, v74
    v_mul_f32 v67, v67, v75
    ds_read_b128 v[48:51], v13 offset:9216
    s_waitcnt lgkmcnt(2)
    v_mfma_f32_32x32x16_bf16 v[32:47], v[52:55], a[108:111], v[32:47]
    v_mul_f32 v60, v60, v9
    v_mul_f32 v61, v61, v9
    ds_read_b128 v[52:55], v13 offset:10240
    s_waitcnt lgkmcnt(2)
    v_mfma_f32_32x32x16_bf16 v[32:47], v[56:59], a[112:115], v[32:47]
    v_mul_f32 v62, v62, v9
    v_mul_f32 v63, v63, v9
    ds_read_b128 v[56:59], v13 offset:11264
    s_waitcnt lgkmcnt(2)
    v_mfma_f32_32x32x16_bf16 v[32:47], v[48:51], a[116:119], v[32:47]
    v_mul_f32 v64, v64, v9
    v_mul_f32 v65, v65, v9
    ds_read_b128 v[48:51], v13 offset:12288
    s_waitcnt lgkmcnt(2)
    v_mfma_f32_32x32x16_bf16 v[32:47], v[52:55], a[120:123], v[32:47]
    v_mul_f32 v66, v66, v9
    v_mul_f32 v67, v67, v9
    ds_read_b128 v[52:55], v13 offset:13312
    s_waitcnt lgkmcnt(2)
    v_mfma_f32_32x32x16_bf16 v[32:47], v[56:59], a[124:127], v[32:47]
    v_cvt_pk_bf16_f32 v68, v60, v61
    v_cvt_pk_bf16_f32 v69, v62, v63
    ds_read_b128 v[56:59], v13 offset:14336
    s_waitcnt lgkmcnt(2)
    v_mfma_f32_32x32x16_bf16 v[32:47], v[48:51], v[96:99], v[32:47]
    v_cvt_pk_bf16_f32 v70, v64, v65
    v_cvt_pk_bf16_f32 v71, v66, v67
    ds_read_b128 v[48:51], v13 offset:15360
    s_waitcnt lgkmcnt(2)
    v_mfma_f32_32x32x16_bf16 v[32:47], v[52:55], v[100:103], v[32:47]
    s_lshl_b32 s46, s57, 11
    s_add_u32 s46, s46, 29360128
    buffer_store_dwordx4 v[68:71], v10, s[8:11], s46 offen sc1
    ds_read_b128 v[52:55], v13 offset:16384
    s_waitcnt lgkmcnt(2)
    v_mfma_f32_32x32x16_bf16 v[32:47], v[56:59], v[104:107], v[32:47]
    ds_read_b128 v[56:59], v13 offset:17408
    s_waitcnt lgkmcnt(2)
    v_mfma_f32_32x32x16_bf16 v[32:47], v[48:51], v[108:111], v[32:47]
    ds_read_b128 v[48:51], v13 offset:18432
    s_waitcnt lgkmcnt(2)
    v_mfma_f32_32x32x16_bf16 v[32:47], v[52:55], v[112:115], v[32:47]
    ds_read_b128 v[52:55], v13 offset:19456
    s_waitcnt lgkmcnt(2)
    v_mfma_f32_32x32x16_bf16 v[32:47], v[56:59], v[116:119], v[32:47]
    ds_read_b128 v[56:59], v13 offset:20480
    s_waitcnt lgkmcnt(2)
    v_mfma_f32_32x32x16_bf16 v[32:47], v[48:51], v[120:123], v[32:47]
    ds_read_b128 v[48:51], v13 offset:21504
    s_waitcnt lgkmcnt(2)
    v_mfma_f32_32x32x16_bf16 v[32:47], v[52:55], v[124:127], v[32:47]
    s_barrier
    ds_read_b128 v[52:55], v13 offset:22528
    s_waitcnt lgkmcnt(2)
    v_mfma_f32_32x32x16_bf16 v[16:31], v[56:59], a[0:3], 0
    ds_read_b128 v[56:59], v13 offset:23552
    s_waitcnt lgkmcnt(2)
    v_mfma_f32_32x32x16_bf16 v[16:31], v[48:51], a[4:7], v[16:31]
    ds_read_b128 v[48:51], v13 offset:24576
    s_waitcnt lgkmcnt(2)
    v_mfma_f32_32x32x16_bf16 v[16:31], v[52:55], a[8:11], v[16:31]
    ds_read_b128 v[60:63], v11 offset:128
    ds_read_b128 v[64:67], v11 offset:160
    ds_read_b128 v[52:55], v13 offset:25600
    s_waitcnt lgkmcnt(4)
    v_mfma_f32_32x32x16_bf16 v[16:31], v[56:59], a[12:15], v[16:31]
    ds_read_b128 v[68:71], v11 offset:192
    ds_read_b128 v[72:75], v11 offset:224
    ds_read_b128 v[56:59], v13 offset:26624
    s_waitcnt lgkmcnt(6)
    v_mfma_f32_32x32x16_bf16 v[16:31], v[48:51], a[16:19], v[16:31]
    s_waitcnt lgkmcnt(1)
    v_fma_f32 v60, v8, v60, v32
    ds_read_b128 v[48:51], v13 offset:27648
    v_mfma_f32_32x32x16_bf16 v[16:31], v[52:55], a[20:23], v[16:31]
    v_fma_f32 v61, v8, v61, v33
    v_fma_f32 v62, v8, v62, v34
    ds_read_b128 v[52:55], v13 offset:28672
    s_waitcnt lgkmcnt(2)
    v_mfma_f32_32x32x16_bf16 v[16:31], v[56:59], a[24:27], v[16:31]
    v_fma_f32 v63, v8, v63, v35
    v_fma_f32 v64, v8, v64, v36
    ds_read_b128 v[56:59], v13 offset:29696
    s_waitcnt lgkmcnt(2)
    v_mfma_f32_32x32x16_bf16 v[16:31], v[48:51], a[28:31], v[16:31]
    v_fma_f32 v65, v8, v65, v37
    v_fma_f32 v66, v8, v66, v38
    ds_read_b128 v[48:51], v13 offset:30720
    s_waitcnt lgkmcnt(2)
    v_mfma_f32_32x32x16_bf16 v[16:31], v[52:55], a[32:35], v[16:31]
    v_fma_f32 v67, v8, v67, v39
    v_fma_f32 v68, v8, v68, v40
    ds_read_b128 v[52:55], v13 offset:31744
    s_waitcnt lgkmcnt(2)
    v_mfma_f32_32x32x16_bf16 v[16:31], v[56:59], a[36:39], v[16:31]
    v_fma_f32 v69, v8, v69, v41
    v_fma_f32 v70, v8, v70, v42
    ds_read_b128 v[56:59], v13 offset:32768
    s_waitcnt lgkmcnt(2)
    v_mfma_f32_32x32x16_bf16 v[16:31], v[48:51], a[40:43], v[16:31]
    v_fma_f32 v71, v8, v71, v43
    v_fma_f32 v72, v8, v72, v44
    ds_read_b128 v[48:51], v13 offset:33792
    s_waitcnt lgkmcnt(2)
    v_mfma_f32_32x32x16_bf16 v[16:31], v[52:55], a[44:47], v[16:31]
    v_fma_f32 v73, v8, v73, v45
    v_fma_f32 v74, v8, v74, v46
    ds_read_b128 v[52:55], v13 offset:34816
    s_waitcnt lgkmcnt(2)
    v_mfma_f32_32x32x16_bf16 v[16:31], v[56:59], a[48:51], v[16:31]
    v_fma_f32 v75, v8, v75, v47
    v_mul_f32 v60, v60, v68
    ds_read_b128 v[56:59], v13 offset:35840
    s_waitcnt lgkmcnt(2)
    v_mfma_f32_32x32x16_bf16 v[16:31], v[48:51], a[52:55], v[16:31]
    v_mul_f32 v61, v61, v69
    v_mul_f32 v62, v62, v70
    ds_read_b128 v[48:51], v13 offset:36864
    s_waitcnt lgkmcnt(2)
    v_mfma_f32_32x32x16_bf16 v[16:31], v[52:55], a[56:59], v[16:31]
    v_mul_f32 v63, v63, v71
    v_mul_f32 v64, v64, v72
    ds_read_b128 v[52:55], v13 offset:37888
    s_waitcnt lgkmcnt(2)
    v_mfma_f32_32x32x16_bf16 v[16:31], v[56:59], a[60:63], v[16:31]
    v_mul_f32 v65, v65, v73
    v_mul_f32 v66, v66, v74
    ds_read_b128 v[56:59], v13 offset:38912
    s_waitcnt lgkmcnt(2)
    v_mfma_f32_32x32x16_bf16 v[16:31], v[48:51], a[64:67], v[16:31]
    v_mul_f32 v67, v67, v75
    v_mul_f32 v60, v60, v9
    ds_read_b128 v[48:51], v13 offset:39936
    s_waitcnt lgkmcnt(2)
    v_mfma_f32_32x32x16_bf16 v[16:31], v[52:55], a[68:71], v[16:31]
    v_mul_f32 v61, v61, v9
    v_mul_f32 v62, v62, v9
    ds_read_b128 v[52:55], v13 offset:40960
    s_waitcnt lgkmcnt(2)
    v_mfma_f32_32x32x16_bf16 v[16:31], v[56:59], a[72:75], v[16:31]
    v_mul_f32 v63, v63, v9
    v_mul_f32 v64, v64, v9
    ds_read_b128 v[56:59], v13 offset:41984
    s_waitcnt lgkmcnt(2)
    v_mfma_f32_32x32x16_bf16 v[16:31], v[48:51], a[76:79], v[16:31]
    v_mul_f32 v65, v65, v9
    v_mul_f32 v66, v66, v9
    s_barrier
    ds_read_b128 v[48:51], v13 offset:43008
    s_waitcnt lgkmcnt(2)
    v_mfma_f32_32x32x16_bf16 v[16:31], v[52:55], a[80:83], v[16:31]
    v_mul_f32 v67, v67, v9
    v_cvt_pk_bf16_f32 v68, v60, v61
    ds_read_b128 v[52:55], v13 offset:44032
    s_waitcnt lgkmcnt(2)
    v_mfma_f32_32x32x16_bf16 v[16:31], v[56:59], a[84:87], v[16:31]
    v_cvt_pk_bf16_f32 v69, v62, v63
    v_cvt_pk_bf16_f32 v70, v64, v65
    ds_read_b128 v[56:59], v13 offset:45056
    s_waitcnt lgkmcnt(2)
    v_mfma_f32_32x32x16_bf16 v[16:31], v[48:51], a[88:91], v[16:31]
    v_cvt_pk_bf16_f32 v71, v66, v67
    s_lshl_b32 s46, s57, 11
    s_add_u32 s46, s46, 29360640
    ds_read_b128 v[48:51], v13 offset:46080
    s_waitcnt lgkmcnt(2)
    v_mfma_f32_32x32x16_bf16 v[16:31], v[52:55], a[92:95], v[16:31]
    buffer_store_dwordx4 v[68:71], v10, s[8:11], s46 offen sc1
    ds_read_b128 v[52:55], v13 offset:47104
    s_waitcnt lgkmcnt(2)
    v_mfma_f32_32x32x16_bf16 v[16:31], v[56:59], a[96:99], v[16:31]
    ds_read_b128 v[56:59], v13 offset:48128
    s_waitcnt lgkmcnt(2)
    v_mfma_f32_32x32x16_bf16 v[16:31], v[48:51], a[100:103], v[16:31]
    ds_read_b128 v[48:51], v13 offset:49152
    s_waitcnt lgkmcnt(2)
    v_mfma_f32_32x32x16_bf16 v[16:31], v[52:55], a[104:107], v[16:31]
    ds_read_b128 v[52:55], v13 offset:50176
    s_waitcnt lgkmcnt(2)
    v_mfma_f32_32x32x16_bf16 v[16:31], v[56:59], a[108:111], v[16:31]
    ds_read_b128 v[56:59], v13 offset:51200
    s_waitcnt lgkmcnt(2)
    v_mfma_f32_32x32x16_bf16 v[16:31], v[48:51], a[112:115], v[16:31]
    ds_read_b128 v[48:51], v13 offset:52224
    s_waitcnt lgkmcnt(2)
    v_mfma_f32_32x32x16_bf16 v[16:31], v[52:55], a[116:119], v[16:31]
    ds_read_b128 v[52:55], v13 offset:53248
    s_waitcnt lgkmcnt(2)
    v_mfma_f32_32x32x16_bf16 v[16:31], v[56:59], a[120:123], v[16:31]
    ds_read_b128 v[56:59], v13 offset:54272
    s_waitcnt lgkmcnt(2)
    v_mfma_f32_32x32x16_bf16 v[16:31], v[48:51], a[124:127], v[16:31]
    ds_read_b128 v[48:51], v13 offset:55296
    s_waitcnt lgkmcnt(2)
    v_mfma_f32_32x32x16_bf16 v[16:31], v[52:55], v[96:99], v[16:31]
    ds_read_b128 v[52:55], v13 offset:56320
    s_waitcnt lgkmcnt(2)
    v_mfma_f32_32x32x16_bf16 v[16:31], v[56:59], v[100:103], v[16:31]
    ds_read_b128 v[56:59], v13 offset:57344
    s_waitcnt lgkmcnt(2)
    v_mfma_f32_32x32x16_bf16 v[16:31], v[48:51], v[104:107], v[16:31]
    ds_read_b128 v[48:51], v13 offset:58368
    s_waitcnt lgkmcnt(2)
    v_mfma_f32_32x32x16_bf16 v[16:31], v[52:55], v[108:111], v[16:31]
    ds_read_b128 v[52:55], v13 offset:59392
    s_waitcnt lgkmcnt(2)
    v_mfma_f32_32x32x16_bf16 v[16:31], v[56:59], v[112:115], v[16:31]
    ds_read_b128 v[56:59], v13 offset:60416
    s_waitcnt lgkmcnt(2)
    v_mfma_f32_32x32x16_bf16 v[16:31], v[48:51], v[116:119], v[16:31]
    ds_read_b128 v[48:51], v14 offset:0
    s_waitcnt lgkmcnt(2)
    v_mfma_f32_32x32x16_bf16 v[16:31], v[52:55], v[120:123], v[16:31]
    ds_read_b128 v[52:55], v14 offset:1024
    s_waitcnt lgkmcnt(2)
    v_mfma_f32_32x32x16_bf16 v[16:31], v[56:59], v[124:127], v[16:31]
    s_barrier
    ds_read_b128 v[56:59], v14 offset:2048
    s_waitcnt lgkmcnt(2)
    v_mfma_f32_32x32x16_bf16 v[32:47], v[48:51], a[0:3], 0
    ds_read_b128 v[48:51], v14 offset:3072
    s_waitcnt lgkmcnt(2)
    v_mfma_f32_32x32x16_bf16 v[32:47], v[52:55], a[4:7], v[32:47]
    ds_read_b128 v[52:55], v14 offset:4096
    s_waitcnt lgkmcnt(2)
    v_mfma_f32_32x32x16_bf16 v[32:47], v[56:59], a[8:11], v[32:47]
    ds_read_b128 v[60:63], v11 offset:256
    ds_read_b128 v[64:67], v11 offset:288
    ds_read_b128 v[56:59], v14 offset:5120
    s_waitcnt lgkmcnt(4)
    v_mfma_f32_32x32x16_bf16 v[32:47], v[48:51], a[12:15], v[32:47]
    ds_read_b128 v[68:71], v11 offset:320
    ds_read_b128 v[72:75], v11 offset:352
    ds_read_b128 v[48:51], v14 offset:6144
    s_waitcnt lgkmcnt(6)
    v_mfma_f32_32x32x16_bf16 v[32:47], v[52:55], a[16:19], v[32:47]
    s_waitcnt lgkmcnt(1)
    v_fma_f32 v60, v8, v60, v16
    ds_read_b128 v[52:55], v14 offset:7168
    v_mfma_f32_32x32x16_bf16 v[32:47], v[56:59], a[20:23], v[32:47]
    v_fma_f32 v61, v8, v61, v17
    v_fma_f32 v62, v8, v62, v18
    ds_read_b128 v[56:59], v14 offset:8192
    s_waitcnt lgkmcnt(2)
    v_mfma_f32_32x32x16_bf16 v[32:47], v[48:51], a[24:27], v[32:47]
    v_fma_f32 v63, v8, v63, v19
    v_fma_f32 v64, v8, v64, v20
    ds_read_b128 v[48:51], v14 offset:9216
    s_waitcnt lgkmcnt(2)
    v_mfma_f32_32x32x16_bf16 v[32:47], v[52:55], a[28:31], v[32:47]
    v_fma_f32 v65, v8, v65, v21
    v_fma_f32 v66, v8, v66, v22
    ds_read_b128 v[52:55], v14 offset:10240
    s_waitcnt lgkmcnt(2)
    v_mfma_f32_32x32x16_bf16 v[32:47], v[56:59], a[32:35], v[32:47]
    v_fma_f32 v67, v8, v67, v23
    v_fma_f32 v68, v8, v68, v24
    ds_read_b128 v[56:59], v14 offset:11264
    s_waitcnt lgkmcnt(2)
    v_mfma_f32_32x32x16_bf16 v[32:47], v[48:51], a[36:39], v[32:47]
    v_fma_f32 v69, v8, v69, v25
    v_fma_f32 v70, v8, v70, v26
    ds_read_b128 v[48:51], v14 offset:12288
    s_waitcnt lgkmcnt(2)
    v_mfma_f32_32x32x16_bf16 v[32:47], v[52:55], a[40:43], v[32:47]
    v_fma_f32 v71, v8, v71, v27
    v_fma_f32 v72, v8, v72, v28
    ds_read_b128 v[52:55], v14 offset:13312
    s_waitcnt lgkmcnt(2)
    v_mfma_f32_32x32x16_bf16 v[32:47], v[56:59], a[44:47], v[32:47]
    v_fma_f32 v73, v8, v73, v29
    v_fma_f32 v74, v8, v74, v30
    ds_read_b128 v[56:59], v14 offset:14336
    s_waitcnt lgkmcnt(2)
    v_mfma_f32_32x32x16_bf16 v[32:47], v[48:51], a[48:51], v[32:47]
    v_fma_f32 v75, v8, v75, v31
    v_mul_f32 v60, v60, v68
    ds_read_b128 v[48:51], v14 offset:15360
    s_waitcnt lgkmcnt(2)
    v_mfma_f32_32x32x16_bf16 v[32:47], v[52:55], a[52:55], v[32:47]
    v_mul_f32 v61, v61, v69
    v_mul_f32 v62, v62, v70
    ds_read_b128 v[52:55], v14 offset:16384
    s_waitcnt lgkmcnt(2)
    v_mfma_f32_32x32x16_bf16 v[32:47], v[56:59], a[56:59], v[32:47]
    v_mul_f32 v63, v63, v71
    v_mul_f32 v64, v64, v72
    ds_read_b128 v[56:59], v14 offset:17408
    s_waitcnt lgkmcnt(2)
    v_mfma_f32_32x32x16_bf16 v[32:47], v[48:51], a[60:63], v[32:47]
    v_mul_f32 v65, v65, v73
    v_mul_f32 v66, v66, v74
    ds_read_b128 v[48:51], v14 offset:18432
    s_waitcnt lgkmcnt(2)
    v_mfma_f32_32x32x16_bf16 v[32:47], v[52:55], a[64:67], v[32:47]
    v_mul_f32 v67, v67, v75
    v_mul_f32 v60, v60, v9
    ds_read_b128 v[52:55], v14 offset:19456
    s_waitcnt lgkmcnt(2)
    v_mfma_f32_32x32x16_bf16 v[32:47], v[56:59], a[68:71], v[32:47]
    v_mul_f32 v61, v61, v9
    v_mul_f32 v62, v62, v9
    ds_read_b128 v[56:59], v12 offset:0
    s_waitcnt lgkmcnt(2)
    v_mfma_f32_32x32x16_bf16 v[32:47], v[48:51], a[72:75], v[32:47]
    v_mul_f32 v63, v63, v9
    v_mul_f32 v64, v64, v9
    ds_read_b128 v[48:51], v12 offset:1024
    s_waitcnt lgkmcnt(2)
    v_mfma_f32_32x32x16_bf16 v[32:47], v[52:55], a[76:79], v[32:47]
    v_mul_f32 v65, v65, v9
    v_mul_f32 v66, v66, v9
    s_barrier
    ds_read_b128 v[52:55], v12 offset:2048
    s_waitcnt lgkmcnt(2)
    v_mfma_f32_32x32x16_bf16 v[32:47], v[56:59], a[80:83], v[32:47]
    v_mul_f32 v67, v67, v9
    v_cvt_pk_bf16_f32 v68, v60, v61
    ds_read_b128 v[56:59], v12 offset:3072
    s_waitcnt lgkmcnt(2)
    v_mfma_f32_32x32x16_bf16 v[32:47], v[48:51], a[84:87], v[32:47]
    v_cvt_pk_bf16_f32 v69, v62, v63
    v_cvt_pk_bf16_f32 v70, v64, v65
    ds_read_b128 v[48:51], v12 offset:4096
    s_waitcnt lgkmcnt(2)
    v_mfma_f32_32x32x16_bf16 v[32:47], v[52:55], a[88:91], v[32:47]
    v_cvt_pk_bf16_f32 v71, v66, v67
    s_lshl_b32 s46, s57, 11
    s_add_u32 s46, s46, 29361152
    ds_read_b128 v[52:55], v12 offset:5120
    s_waitcnt lgkmcnt(2)
    v_mfma_f32_32x32x16_bf16 v[32:47], v[56:59], a[92:95], v[32:47]
    buffer_store_dwordx4 v[68:71], v10, s[8:11], s46 offen sc1
    ds_read_b128 v[56:59], v12 offset:6144
    s_waitcnt lgkmcnt(2)
    v_mfma_f32_32x32x16_bf16 v[32:47], v[48:51], a[96:99], v[32:47]
    ds_read_b128 v[48:51], v12 offset:7168
    s_waitcnt lgkmcnt(2)
    v_mfma_f32_32x32x16_bf16 v[32:47], v[52:55], a[100:103], v[32:47]
    ds_read_b128 v[52:55], v12 offset:8192
    s_waitcnt lgkmcnt(2)
    v_mfma_f32_32x32x16_bf16 v[32:47], v[56:59], a[104:107], v[32:47]
    ds_read_b128 v[56:59], v12 offset:9216
    s_waitcnt lgkmcnt(2)
    v_mfma_f32_32x32x16_bf16 v[32:47], v[48:51], a[108:111], v[32:47]
    ds_read_b128 v[48:51], v12 offset:10240
    s_waitcnt lgkmcnt(2)
    v_mfma_f32_32x32x16_bf16 v[32:47], v[52:55], a[112:115], v[32:47]
    ds_read_b128 v[52:55], v12 offset:11264
    s_waitcnt lgkmcnt(2)
    v_mfma_f32_32x32x16_bf16 v[32:47], v[56:59], a[116:119], v[32:47]
    ds_read_b128 v[56:59], v12 offset:12288
    s_waitcnt lgkmcnt(2)
    v_mfma_f32_32x32x16_bf16 v[32:47], v[48:51], a[120:123], v[32:47]
    ds_read_b128 v[48:51], v12 offset:13312
    s_waitcnt lgkmcnt(2)
    v_mfma_f32_32x32x16_bf16 v[32:47], v[52:55], a[124:127], v[32:47]
    ds_read_b128 v[52:55], v12 offset:14336
    s_waitcnt lgkmcnt(2)
    v_mfma_f32_32x32x16_bf16 v[32:47], v[56:59], v[96:99], v[32:47]
    ds_read_b128 v[56:59], v12 offset:15360
    s_waitcnt lgkmcnt(2)
    v_mfma_f32_32x32x16_bf16 v[32:47], v[48:51], v[100:103], v[32:47]
    ds_read_b128 v[48:51], v12 offset:16384
    s_waitcnt lgkmcnt(2)
    v_mfma_f32_32x32x16_bf16 v[32:47], v[52:55], v[104:107], v[32:47]
    ds_read_b128 v[52:55], v12 offset:17408
    s_waitcnt lgkmcnt(2)
    v_mfma_f32_32x32x16_bf16 v[32:47], v[56:59], v[108:111], v[32:47]
    ds_read_b128 v[56:59], v12 offset:18432
    s_waitcnt lgkmcnt(2)
    v_mfma_f32_32x32x16_bf16 v[32:47], v[48:51], v[112:115], v[32:47]
    ds_read_b128 v[48:51], v12 offset:19456
    s_waitcnt lgkmcnt(2)
    v_mfma_f32_32x32x16_bf16 v[32:47], v[52:55], v[116:119], v[32:47]
    ds_read_b128 v[52:55], v12 offset:20480
    s_waitcnt lgkmcnt(2)
    v_mfma_f32_32x32x16_bf16 v[32:47], v[56:59], v[120:123], v[32:47]
    ds_read_b128 v[56:59], v12 offset:21504
    s_waitcnt lgkmcnt(2)
    v_mfma_f32_32x32x16_bf16 v[32:47], v[48:51], v[124:127], v[32:47]
    s_barrier
    ds_read_b128 v[48:51], v12 offset:22528
    s_waitcnt lgkmcnt(2)
    v_mfma_f32_32x32x16_bf16 v[16:31], v[52:55], a[0:3], 0
    ds_read_b128 v[52:55], v12 offset:23552
    s_waitcnt lgkmcnt(2)
    v_mfma_f32_32x32x16_bf16 v[16:31], v[56:59], a[4:7], v[16:31]
    ds_read_b128 v[56:59], v12 offset:24576
    s_waitcnt lgkmcnt(2)
    v_mfma_f32_32x32x16_bf16 v[16:31], v[48:51], a[8:11], v[16:31]
    ds_read_b128 v[60:63], v11 offset:384
    ds_read_b128 v[64:67], v11 offset:416
    ds_read_b128 v[48:51], v12 offset:25600
    s_waitcnt lgkmcnt(4)
    v_mfma_f32_32x32x16_bf16 v[16:31], v[52:55], a[12:15], v[16:31]
    ds_read_b128 v[68:71], v11 offset:448
    ds_read_b128 v[72:75], v11 offset:480
    ds_read_b128 v[52:55], v12 offset:26624
    s_waitcnt lgkmcnt(6)
    v_mfma_f32_32x32x16_bf16 v[16:31], v[56:59], a[16:19], v[16:31]
    s_waitcnt lgkmcnt(1)
    v_fma_f32 v60, v8, v60, v32
    ds_read_b128 v[56:59], v12 offset:27648
    v_mfma_f32_32x32x16_bf16 v[16:31], v[48:51], a[20:23], v[16:31]
    v_fma_f32 v61, v8, v61, v33
    v_fma_f32 v62, v8, v62, v34
    ds_read_b128 v[48:51], v12 offset:28672
    s_waitcnt lgkmcnt(2)
    v_mfma_f32_32x32x16_bf16 v[16:31], v[52:55], a[24:27], v[16:31]
    v_fma_f32 v63, v8, v63, v35
    v_fma_f32 v64, v8, v64, v36
    ds_read_b128 v[52:55], v12 offset:29696
    s_waitcnt lgkmcnt(2)
    v_mfma_f32_32x32x16_bf16 v[16:31], v[56:59], a[28:31], v[16:31]
    v_fma_f32 v65, v8, v65, v37
    v_fma_f32 v66, v8, v66, v38
    ds_read_b128 v[56:59], v12 offset:30720
    s_waitcnt lgkmcnt(2)
    v_mfma_f32_32x32x16_bf16 v[16:31], v[48:51], a[32:35], v[16:31]
    v_fma_f32 v67, v8, v67, v39
    v_fma_f32 v68, v8, v68, v40
    ds_read_b128 v[48:51], v12 offset:31744
    s_waitcnt lgkmcnt(2)
    v_mfma_f32_32x32x16_bf16 v[16:31], v[52:55], a[36:39], v[16:31]
    v_fma_f32 v69, v8, v69, v41
    v_fma_f32 v70, v8, v70, v42
    ds_read_b128 v[52:55], v12 offset:32768
    s_waitcnt lgkmcnt(2)
    v_mfma_f32_32x32x16_bf16 v[16:31], v[56:59], a[40:43], v[16:31]
    v_fma_f32 v71, v8, v71, v43
    v_fma_f32 v72, v8, v72, v44
    ds_read_b128 v[56:59], v12 offset:33792
    s_waitcnt lgkmcnt(2)
    v_mfma_f32_32x32x16_bf16 v[16:31], v[48:51], a[44:47], v[16:31]
    v_fma_f32 v73, v8, v73, v45
    v_fma_f32 v74, v8, v74, v46
    ds_read_b128 v[48:51], v12 offset:34816
    s_waitcnt lgkmcnt(2)
    v_mfma_f32_32x32x16_bf16 v[16:31], v[52:55], a[48:51], v[16:31]
    v_fma_f32 v75, v8, v75, v47
    v_mul_f32 v60, v60, v68
    ds_read_b128 v[52:55], v12 offset:35840
    s_waitcnt lgkmcnt(2)
    v_mfma_f32_32x32x16_bf16 v[16:31], v[56:59], a[52:55], v[16:31]
    v_mul_f32 v61, v61, v69
    v_mul_f32 v62, v62, v70
    ds_read_b128 v[56:59], v12 offset:36864
    s_waitcnt lgkmcnt(2)
    v_mfma_f32_32x32x16_bf16 v[16:31], v[48:51], a[56:59], v[16:31]
    v_mul_f32 v63, v63, v71
    v_mul_f32 v64, v64, v72
    ds_read_b128 v[48:51], v12 offset:37888
    s_waitcnt lgkmcnt(2)
    v_mfma_f32_32x32x16_bf16 v[16:31], v[52:55], a[60:63], v[16:31]
    v_mul_f32 v65, v65, v73
    v_mul_f32 v66, v66, v74
    ds_read_b128 v[52:55], v12 offset:38912
    s_waitcnt lgkmcnt(2)
    v_mfma_f32_32x32x16_bf16 v[16:31], v[56:59], a[64:67], v[16:31]
    v_mul_f32 v67, v67, v75
    v_mul_f32 v60, v60, v9
    ds_read_b128 v[56:59], v12 offset:39936
    s_waitcnt lgkmcnt(2)
    v_mfma_f32_32x32x16_bf16 v[16:31], v[48:51], a[68:71], v[16:31]
    v_mul_f32 v61, v61, v9
    v_mul_f32 v62, v62, v9
    ds_read_b128 v[48:51], v12 offset:40960
    s_waitcnt lgkmcnt(2)
    v_mfma_f32_32x32x16_bf16 v[16:31], v[52:55], a[72:75], v[16:31]
    v_mul_f32 v63, v63, v9
    v_mul_f32 v64, v64, v9
    ds_read_b128 v[52:55], v12 offset:41984
    s_waitcnt lgkmcnt(2)
    v_mfma_f32_32x32x16_bf16 v[16:31], v[56:59], a[76:79], v[16:31]
    v_mul_f32 v65, v65, v9
    v_mul_f32 v66, v66, v9
    s_barrier
    ds_read_b128 v[56:59], v12 offset:43008
    s_waitcnt lgkmcnt(2)
    v_mfma_f32_32x32x16_bf16 v[16:31], v[48:51], a[80:83], v[16:31]
    v_mul_f32 v67, v67, v9
    v_cvt_pk_bf16_f32 v68, v60, v61
    ds_read_b128 v[48:51], v12 offset:44032
    s_waitcnt lgkmcnt(2)
    v_mfma_f32_32x32x16_bf16 v[16:31], v[52:55], a[84:87], v[16:31]
    v_cvt_pk_bf16_f32 v69, v62, v63
    v_cvt_pk_bf16_f32 v70, v64, v65
    ds_read_b128 v[52:55], v12 offset:45056
    s_waitcnt lgkmcnt(2)
    v_mfma_f32_32x32x16_bf16 v[16:31], v[56:59], a[88:91], v[16:31]
    v_cvt_pk_bf16_f32 v71, v66, v67
    s_lshl_b32 s46, s57, 11
    s_add_u32 s46, s46, 29361664
    ds_read_b128 v[56:59], v12 offset:46080
    s_waitcnt lgkmcnt(2)
    v_mfma_f32_32x32x16_bf16 v[16:31], v[48:51], a[92:95], v[16:31]
    buffer_store_dwordx4 v[68:71], v10, s[8:11], s46 offen sc1
    ds_read_b128 v[48:51], v12 offset:47104
    s_waitcnt lgkmcnt(2)
    v_mfma_f32_32x32x16_bf16 v[16:31], v[52:55], a[96:99], v[16:31]
    ds_read_b128 v[52:55], v12 offset:48128
    s_waitcnt lgkmcnt(2)
    v_mfma_f32_32x32x16_bf16 v[16:31], v[56:59], a[100:103], v[16:31]
    ds_read_b128 v[56:59], v12 offset:49152
    s_waitcnt lgkmcnt(2)
    v_mfma_f32_32x32x16_bf16 v[16:31], v[48:51], a[104:107], v[16:31]
    ds_read_b128 v[48:51], v12 offset:50176
    s_waitcnt lgkmcnt(2)
    v_mfma_f32_32x32x16_bf16 v[16:31], v[52:55], a[108:111], v[16:31]
    ds_read_b128 v[52:55], v12 offset:51200
    s_waitcnt lgkmcnt(2)
    v_mfma_f32_32x32x16_bf16 v[16:31], v[56:59], a[112:115], v[16:31]
    ds_read_b128 v[56:59], v12 offset:52224
    s_waitcnt lgkmcnt(2)
    v_mfma_f32_32x32x16_bf16 v[16:31], v[48:51], a[116:119], v[16:31]
    ds_read_b128 v[48:51], v12 offset:53248
    s_waitcnt lgkmcnt(2)
    v_mfma_f32_32x32x16_bf16 v[16:31], v[52:55], a[120:123], v[16:31]
    ds_read_b128 v[52:55], v12 offset:54272
    s_waitcnt lgkmcnt(2)
    v_mfma_f32_32x32x16_bf16 v[16:31], v[56:59], a[124:127], v[16:31]
    ds_read_b128 v[56:59], v12 offset:55296
    s_waitcnt lgkmcnt(2)
    v_mfma_f32_32x32x16_bf16 v[16:31], v[48:51], v[96:99], v[16:31]
    ds_read_b128 v[48:51], v12 offset:56320
    s_waitcnt lgkmcnt(2)
    v_mfma_f32_32x32x16_bf16 v[16:31], v[52:55], v[100:103], v[16:31]
    ds_read_b128 v[52:55], v12 offset:57344
    s_waitcnt lgkmcnt(2)
    v_mfma_f32_32x32x16_bf16 v[16:31], v[56:59], v[104:107], v[16:31]
    ds_read_b128 v[56:59], v12 offset:58368
    s_waitcnt lgkmcnt(2)
    v_mfma_f32_32x32x16_bf16 v[16:31], v[48:51], v[108:111], v[16:31]
    ds_read_b128 v[48:51], v12 offset:59392
    s_waitcnt lgkmcnt(2)
    v_mfma_f32_32x32x16_bf16 v[16:31], v[52:55], v[112:115], v[16:31]
    ds_read_b128 v[52:55], v12 offset:60416
    s_waitcnt lgkmcnt(2)
    v_mfma_f32_32x32x16_bf16 v[16:31], v[56:59], v[116:119], v[16:31]
    ds_read_b128 v[56:59], v13 offset:0
    s_waitcnt lgkmcnt(2)
    v_mfma_f32_32x32x16_bf16 v[16:31], v[48:51], v[120:123], v[16:31]
    ds_read_b128 v[48:51], v13 offset:1024
    s_waitcnt lgkmcnt(2)
    v_mfma_f32_32x32x16_bf16 v[16:31], v[52:55], v[124:127], v[16:31]
    s_barrier
    ds_read_b128 v[52:55], v13 offset:2048
    s_waitcnt lgkmcnt(2)
    v_mfma_f32_32x32x16_bf16 v[32:47], v[56:59], a[0:3], 0
    ds_read_b128 v[56:59], v13 offset:3072
    s_waitcnt lgkmcnt(2)
    v_mfma_f32_32x32x16_bf16 v[32:47], v[48:51], a[4:7], v[32:47]
    ds_read_b128 v[48:51], v13 offset:4096
    s_waitcnt lgkmcnt(2)
    v_mfma_f32_32x32x16_bf16 v[32:47], v[52:55], a[8:11], v[32:47]
    ds_read_b128 v[60:63], v11 offset:512
    ds_read_b128 v[64:67], v11 offset:544
    ds_read_b128 v[52:55], v13 offset:5120
    s_waitcnt lgkmcnt(4)
    v_mfma_f32_32x32x16_bf16 v[32:47], v[56:59], a[12:15], v[32:47]
    ds_read_b128 v[68:71], v11 offset:576
    ds_read_b128 v[72:75], v11 offset:608
    ds_read_b128 v[56:59], v13 offset:6144
    s_waitcnt lgkmcnt(6)
    v_mfma_f32_32x32x16_bf16 v[32:47], v[48:51], a[16:19], v[32:47]
    s_waitcnt lgkmcnt(1)
    v_fma_f32 v60, v8, v60, v16
    ds_read_b128 v[48:51], v13 offset:7168
    v_mfma_f32_32x32x16_bf16 v[32:47], v[52:55], a[20:23], v[32:47]
    v_fma_f32 v61, v8, v61, v17
    v_fma_f32 v62, v8, v62, v18
    ds_read_b128 v[52:55], v13 offset:8192
    s_waitcnt lgkmcnt(2)
    v_mfma_f32_32x32x16_bf16 v[32:47], v[56:59], a[24:27], v[32:47]
    v_fma_f32 v63, v8, v63, v19
    v_fma_f32 v64, v8, v64, v20
    ds_read_b128 v[56:59], v13 offset:9216
    s_waitcnt lgkmcnt(2)
    v_mfma_f32_32x32x16_bf16 v[32:47], v[48:51], a[28:31], v[32:47]
    v_fma_f32 v65, v8, v65, v21
    v_fma_f32 v66, v8, v66, v22
    ds_read_b128 v[48:51], v13 offset:10240
    s_waitcnt lgkmcnt(2)
    v_mfma_f32_32x32x16_bf16 v[32:47], v[52:55], a[32:35], v[32:47]
    v_fma_f32 v67, v8, v67, v23
    v_fma_f32 v68, v8, v68, v24
    ds_read_b128 v[52:55], v13 offset:11264
    s_waitcnt lgkmcnt(2)
    v_mfma_f32_32x32x16_bf16 v[32:47], v[56:59], a[36:39], v[32:47]
    v_fma_f32 v69, v8, v69, v25
    v_fma_f32 v70, v8, v70, v26
    ds_read_b128 v[56:59], v13 offset:12288
    s_waitcnt lgkmcnt(2)
    v_mfma_f32_32x32x16_bf16 v[32:47], v[48:51], a[40:43], v[32:47]
    v_fma_f32 v71, v8, v71, v27
    v_fma_f32 v72, v8, v72, v28
    ds_read_b128 v[48:51], v13 offset:13312
    s_waitcnt lgkmcnt(2)
    v_mfma_f32_32x32x16_bf16 v[32:47], v[52:55], a[44:47], v[32:47]
    v_fma_f32 v73, v8, v73, v29
    v_fma_f32 v74, v8, v74, v30
    ds_read_b128 v[52:55], v13 offset:14336
    s_waitcnt lgkmcnt(2)
    v_mfma_f32_32x32x16_bf16 v[32:47], v[56:59], a[48:51], v[32:47]
    v_fma_f32 v75, v8, v75, v31
    v_mul_f32 v60, v60, v68
    ds_read_b128 v[56:59], v13 offset:15360
    s_waitcnt lgkmcnt(2)
    v_mfma_f32_32x32x16_bf16 v[32:47], v[48:51], a[52:55], v[32:47]
    v_mul_f32 v61, v61, v69
    v_mul_f32 v62, v62, v70
    ds_read_b128 v[48:51], v13 offset:16384
    s_waitcnt lgkmcnt(2)
    v_mfma_f32_32x32x16_bf16 v[32:47], v[52:55], a[56:59], v[32:47]
    v_mul_f32 v63, v63, v71
    v_mul_f32 v64, v64, v72
    ds_read_b128 v[52:55], v13 offset:17408
    s_waitcnt lgkmcnt(2)
    v_mfma_f32_32x32x16_bf16 v[32:47], v[56:59], a[60:63], v[32:47]
    v_mul_f32 v65, v65, v73
    v_mul_f32 v66, v66, v74
    ds_read_b128 v[56:59], v13 offset:18432
    s_waitcnt lgkmcnt(2)
    v_mfma_f32_32x32x16_bf16 v[32:47], v[48:51], a[64:67], v[32:47]
    v_mul_f32 v67, v67, v75
    v_mul_f32 v60, v60, v9
    ds_read_b128 v[48:51], v13 offset:19456
    s_waitcnt lgkmcnt(2)
    v_mfma_f32_32x32x16_bf16 v[32:47], v[52:55], a[68:71], v[32:47]
    v_mul_f32 v61, v61, v9
    v_mul_f32 v62, v62, v9
    ds_read_b128 v[52:55], v13 offset:20480
    s_waitcnt lgkmcnt(2)
    v_mfma_f32_32x32x16_bf16 v[32:47], v[56:59], a[72:75], v[32:47]
    v_mul_f32 v63, v63, v9
    v_mul_f32 v64, v64, v9
    ds_read_b128 v[56:59], v13 offset:21504
    s_waitcnt lgkmcnt(2)
    v_mfma_f32_32x32x16_bf16 v[32:47], v[48:51], a[76:79], v[32:47]
    v_mul_f32 v65, v65, v9
    v_mul_f32 v66, v66, v9
    s_barrier
    ds_read_b128 v[48:51], v13 offset:22528
    s_waitcnt lgkmcnt(2)
    v_mfma_f32_32x32x16_bf16 v[32:47], v[52:55], a[80:83], v[32:47]
    v_mul_f32 v67, v67, v9
    v_cvt_pk_bf16_f32 v68, v60, v61
    ds_read_b128 v[52:55], v13 offset:23552
    s_waitcnt lgkmcnt(2)
    v_mfma_f32_32x32x16_bf16 v[32:47], v[56:59], a[84:87], v[32:47]
    v_cvt_pk_bf16_f32 v69, v62, v63
    v_cvt_pk_bf16_f32 v70, v64, v65
    ds_read_b128 v[56:59], v13 offset:24576
    s_waitcnt lgkmcnt(2)
    v_mfma_f32_32x32x16_bf16 v[32:47], v[48:51], a[88:91], v[32:47]
    v_cvt_pk_bf16_f32 v71, v66, v67
    s_waitcnt vmcnt(0)
    s_lshl_b32 s36, s56, 2
    s_add_u32 s36, s36, s3
    s_lshl_b32 s36, s36, 7
    s_lshl_b32 s37, s57, 2
    s_add_u32 s36, s36, s37
    s_add_u32 s36, s36, 37888000
    v_mov_b32 v3, s60
    v_mov_b32 v4, 0
    s_mov_b64 exec, 1
    buffer_atomic_swap v3, v4, s[8:11], s36 offen sc1
    s_mov_b64 exec, -1
    ds_read_b128 v[48:51], v13 offset:25600
    s_waitcnt lgkmcnt(2)
    v_mfma_f32_32x32x16_bf16 v[32:47], v[52:55], a[92:95], v[32:47]
    s_lshr_b32 s45, s57, 1
    s_lshl_b32 s46, s45, 10
    s_and_b32 s45, s57, 1
    s_lshl_b32 s45, s45, 9
    s_add_u32 s46, s46, s45
    s_add_u32 s46, s46, 29399040
    s_lshl_b32 s45, s57, 10
    s_add_u32 s45, s45, 29392896
    s_cmp_lt_u32 s57, 12
    s_cselect_b32 s46, s45, s46
    buffer_store_dwordx4 v[68:71], v10, s[8:11], s46 offen sc1
    ds_read_b128 v[52:55], v13 offset:26624
    s_waitcnt lgkmcnt(2)
    v_mfma_f32_32x32x16_bf16 v[32:47], v[56:59], a[96:99], v[32:47]
    ds_read_b128 v[56:59], v13 offset:27648
    s_waitcnt lgkmcnt(2)
    v_mfma_f32_32x32x16_bf16 v[32:47], v[48:51], a[100:103], v[32:47]
    ds_read_b128 v[48:51], v13 offset:28672
    s_waitcnt lgkmcnt(2)
    v_mfma_f32_32x32x16_bf16 v[32:47], v[52:55], a[104:107], v[32:47]
    ds_read_b128 v[52:55], v13 offset:29696
    s_waitcnt lgkmcnt(2)
    v_mfma_f32_32x32x16_bf16 v[32:47], v[56:59], a[108:111], v[32:47]
    ds_read_b128 v[56:59], v13 offset:30720
    s_waitcnt lgkmcnt(2)
    v_mfma_f32_32x32x16_bf16 v[32:47], v[48:51], a[112:115], v[32:47]
    ds_read_b128 v[48:51], v13 offset:31744
    s_waitcnt lgkmcnt(2)
    v_mfma_f32_32x32x16_bf16 v[32:47], v[52:55], a[116:119], v[32:47]
    ds_read_b128 v[52:55], v13 offset:32768
    s_waitcnt lgkmcnt(2)
    v_mfma_f32_32x32x16_bf16 v[32:47], v[56:59], a[120:123], v[32:47]
    ds_read_b128 v[56:59], v13 offset:33792
    s_waitcnt lgkmcnt(2)
    v_mfma_f32_32x32x16_bf16 v[32:47], v[48:51], a[124:127], v[32:47]
    ds_read_b128 v[48:51], v13 offset:34816
    s_waitcnt lgkmcnt(2)
    v_mfma_f32_32x32x16_bf16 v[32:47], v[52:55], v[96:99], v[32:47]
    ds_read_b128 v[52:55], v13 offset:35840
    s_waitcnt lgkmcnt(2)
    v_mfma_f32_32x32x16_bf16 v[32:47], v[56:59], v[100:103], v[32:47]
    ds_read_b128 v[56:59], v13 offset:36864
    s_waitcnt lgkmcnt(2)
    v_mfma_f32_32x32x16_bf16 v[32:47], v[48:51], v[104:107], v[32:47]
    ds_read_b128 v[48:51], v13 offset:37888
    s_waitcnt lgkmcnt(2)
    v_mfma_f32_32x32x16_bf16 v[32:47], v[52:55], v[108:111], v[32:47]
    ds_read_b128 v[52:55], v13 offset:38912
    s_waitcnt lgkmcnt(2)
    v_mfma_f32_32x32x16_bf16 v[32:47], v[56:59], v[112:115], v[32:47]
    ds_read_b128 v[56:59], v13 offset:39936
    s_waitcnt lgkmcnt(2)
    v_mfma_f32_32x32x16_bf16 v[32:47], v[48:51], v[116:119], v[32:47]
    ds_read_b128 v[48:51], v13 offset:40960
    s_waitcnt lgkmcnt(2)
    v_mfma_f32_32x32x16_bf16 v[32:47], v[52:55], v[120:123], v[32:47]
    ds_read_b128 v[52:55], v13 offset:41984
    s_waitcnt lgkmcnt(2)
    v_mfma_f32_32x32x16_bf16 v[32:47], v[56:59], v[124:127], v[32:47]
    s_barrier
    s_cmp_eq_u32 s43, 6
    s_cbranch_scc1 P_tail6
    ds_read_b128 v[56:59], v13 offset:43008
    s_waitcnt lgkmcnt(2)
    v_mfma_f32_32x32x16_bf16 v[16:31], v[48:51], a[0:3], 0
    ds_read_b128 v[48:51], v13 offset:44032
    s_waitcnt lgkmcnt(2)
    v_mfma_f32_32x32x16_bf16 v[16:31], v[52:55], a[4:7], v[16:31]
    ds_read_b128 v[52:55], v13 offset:45056
    s_waitcnt lgkmcnt(2)
    v_mfma_f32_32x32x16_bf16 v[16:31], v[56:59], a[8:11], v[16:31]
    ds_read_b128 v[60:63], v11 offset:640
    ds_read_b128 v[64:67], v11 offset:672
    ds_read_b128 v[56:59], v13 offset:46080
    s_waitcnt lgkmcnt(4)
    v_mfma_f32_32x32x16_bf16 v[16:31], v[48:51], a[12:15], v[16:31]
    ds_read_b128 v[68:71], v11 offset:704
    ds_read_b128 v[72:75], v11 offset:736
    ds_read_b128 v[48:51], v13 offset:47104
    s_waitcnt lgkmcnt(6)
    v_mfma_f32_32x32x16_bf16 v[16:31], v[52:55], a[16:19], v[16:31]
    s_waitcnt lgkmcnt(1)
    v_fma_f32 v60, v8, v60, v32
    ds_read_b128 v[52:55], v13 offset:48128
    v_mfma_f32_32x32x16_bf16 v[16:31], v[56:59], a[20:23], v[16:31]
    v_fma_f32 v61, v8, v61, v33
    v_fma_f32 v62, v8, v62, v34
    ds_read_b128 v[56:59], v13 offset:49152
    s_waitcnt lgkmcnt(2)
    v_mfma_f32_32x32x16_bf16 v[16:31], v[48:51], a[24:27], v[16:31]
    v_fma_f32 v63, v8, v63, v35
    v_fma_f32 v64, v8, v64, v36
    ds_read_b128 v[48:51], v13 offset:50176
    s_waitcnt lgkmcnt(2)
    v_mfma_f32_32x32x16_bf16 v[16:31], v[52:55], a[28:31], v[16:31]
    v_fma_f32 v65, v8, v65, v37
    v_fma_f32 v66, v8, v66, v38
    ds_read_b128 v[52:55], v13 offset:51200
    s_waitcnt lgkmcnt(2)
    v_mfma_f32_32x32x16_bf16 v[16:31], v[56:59], a[32:35], v[16:31]
    v_fma_f32 v67, v8, v67, v39
    v_fma_f32 v68, v8, v68, v40
    ds_read_b128 v[56:59], v13 offset:52224
    s_waitcnt lgkmcnt(2)
    v_mfma_f32_32x32x16_bf16 v[16:31], v[48:51], a[36:39], v[16:31]
    v_fma_f32 v69, v8, v69, v41
    v_fma_f32 v70, v8, v70, v42
    ds_read_b128 v[48:51], v13 offset:53248
    s_waitcnt lgkmcnt(2)
    v_mfma_f32_32x32x16_bf16 v[16:31], v[52:55], a[40:43], v[16:31]
    v_fma_f32 v71, v8, v71, v43
    v_fma_f32 v72, v8, v72, v44
    ds_read_b128 v[52:55], v13 offset:54272
    s_waitcnt lgkmcnt(2)
    v_mfma_f32_32x32x16_bf16 v[16:31], v[56:59], a[44:47], v[16:31]
    v_fma_f32 v73, v8, v73, v45
    v_fma_f32 v74, v8, v74, v46
    ds_read_b128 v[56:59], v13 offset:55296
    s_waitcnt lgkmcnt(2)
    v_mfma_f32_32x32x16_bf16 v[16:31], v[48:51], a[48:51], v[16:31]
    v_fma_f32 v75, v8, v75, v47
    v_mul_f32 v60, v60, v68
    ds_read_b128 v[48:51], v13 offset:56320
    s_waitcnt lgkmcnt(2)
    v_mfma_f32_32x32x16_bf16 v[16:31], v[52:55], a[52:55], v[16:31]
    v_mul_f32 v61, v61, v69
    v_mul_f32 v62, v62, v70
    ds_read_b128 v[52:55], v13 offset:57344
    s_waitcnt lgkmcnt(2)
    v_mfma_f32_32x32x16_bf16 v[16:31], v[56:59], a[56:59], v[16:31]
    v_mul_f32 v63, v63, v71
    v_mul_f32 v64, v64, v72
    ds_read_b128 v[56:59], v13 offset:58368
    s_waitcnt lgkmcnt(2)
    v_mfma_f32_32x32x16_bf16 v[16:31], v[48:51], a[60:63], v[16:31]
    v_mul_f32 v65, v65, v73
    v_mul_f32 v66, v66, v74
    ds_read_b128 v[48:51], v13 offset:59392
    s_waitcnt lgkmcnt(2)
    v_mfma_f32_32x32x16_bf16 v[16:31], v[52:55], a[64:67], v[16:31]
    v_mul_f32 v67, v67, v75
    v_mul_f32 v60, v60, v9
    ds_read_b128 v[52:55], v13 offset:60416
    s_waitcnt lgkmcnt(2)
    v_mfma_f32_32x32x16_bf16 v[16:31], v[56:59], a[68:71], v[16:31]
    v_mul_f32 v61, v61, v9
    v_mul_f32 v62, v62, v9
    ds_read_b128 v[56:59], v14 offset:0
    s_waitcnt lgkmcnt(2)
    v_mfma_f32_32x32x16_bf16 v[16:31], v[48:51], a[72:75], v[16:31]
    v_mul_f32 v63, v63, v9
    v_mul_f32 v64, v64, v9
    ds_read_b128 v[48:51], v14 offset:1024
    s_waitcnt lgkmcnt(2)
    v_mfma_f32_32x32x16_bf16 v[16:31], v[52:55], a[76:79], v[16:31]
    v_mul_f32 v65, v65, v9
    v_mul_f32 v66, v66, v9
    s_barrier
    ds_read_b128 v[52:55], v14 offset:2048
    s_waitcnt lgkmcnt(2)
    v_mfma_f32_32x32x16_bf16 v[16:31], v[56:59], a[80:83], v[16:31]
    v_mul_f32 v67, v67, v9
    v_cvt_pk_bf16_f32 v68, v60, v61
    ds_read_b128 v[56:59], v14 offset:3072
    s_waitcnt lgkmcnt(2)
    v_mfma_f32_32x32x16_bf16 v[16:31], v[48:51], a[84:87], v[16:31]
    v_cvt_pk_bf16_f32 v69, v62, v63
    v_cvt_pk_bf16_f32 v70, v64, v65
    ds_read_b128 v[48:51], v14 offset:4096
    s_waitcnt lgkmcnt(2)
    v_mfma_f32_32x32x16_bf16 v[16:31], v[52:55], a[88:91], v[16:31]
    v_cvt_pk_bf16_f32 v71, v66, v67
    s_lshr_b32 s45, s57, 1
    s_lshl_b32 s46, s45, 10
    s_and_b32 s45, s57, 1
    s_lshl_b32 s45, s45, 9
    s_add_u32 s46, s46, s45
    s_add_u32 s46, s46, 29407232
    s_lshl_b32 s45, s57, 10
    s_add_u32 s45, s45, 29393408
    s_cmp_lt_u32 s57, 12
    s_cselect_b32 s46, s45, s46
    ds_read_b128 v[52:55], v14 offset:5120
    s_waitcnt lgkmcnt(2)
    v_mfma_f32_32x32x16_bf16 v[16:31], v[56:59], a[92:95], v[16:31]
    buffer_store_dwordx4 v[68:71], v10, s[8:11], s46 offen sc1
    ds_read_b128 v[56:59], v14 offset:6144
    s_waitcnt lgkmcnt(2)
    v_mfma_f32_32x32x16_bf16 v[16:31], v[48:51], a[96:99], v[16:31]
    ds_read_b128 v[48:51], v14 offset:7168
    s_waitcnt lgkmcnt(2)
    v_mfma_f32_32x32x16_bf16 v[16:31], v[52:55], a[100:103], v[16:31]
    ds_read_b128 v[52:55], v14 offset:8192
    s_waitcnt lgkmcnt(2)
    v_mfma_f32_32x32x16_bf16 v[16:31], v[56:59], a[104:107], v[16:31]
    ds_read_b128 v[56:59], v14 offset:9216
    s_waitcnt lgkmcnt(2)
    v_mfma_f32_32x32x16_bf16 v[16:31], v[48:51], a[108:111], v[16:31]
    ds_read_b128 v[48:51], v14 offset:10240
    s_waitcnt lgkmcnt(2)
    v_mfma_f32_32x32x16_bf16 v[16:31], v[52:55], a[112:115], v[16:31]
    ds_read_b128 v[52:55], v14 offset:11264
    s_waitcnt lgkmcnt(2)
    v_mfma_f32_32x32x16_bf16 v[16:31], v[56:59], a[116:119], v[16:31]
    ds_read_b128 v[56:59], v14 offset:12288
    s_waitcnt lgkmcnt(2)
    v_mfma_f32_32x32x16_bf16 v[16:31], v[48:51], a[120:123], v[16:31]
    ds_read_b128 v[48:51], v14 offset:13312
    s_waitcnt lgkmcnt(2)
    v_mfma_f32_32x32x16_bf16 v[16:31], v[52:55], a[124:127], v[16:31]
    ds_read_b128 v[52:55], v14 offset:14336
    s_waitcnt lgkmcnt(2)
    v_mfma_f32_32x32x16_bf16 v[16:31], v[56:59], v[96:99], v[16:31]
    ds_read_b128 v[56:59], v14 offset:15360
    s_waitcnt lgkmcnt(2)
    v_mfma_f32_32x32x16_bf16 v[16:31], v[48:51], v[100:103], v[16:31]
    ds_read_b128 v[48:51], v14 offset:16384
    s_waitcnt lgkmcnt(2)
    v_mfma_f32_32x32x16_bf16 v[16:31], v[52:55], v[104:107], v[16:31]
    ds_read_b128 v[52:55], v14 offset:17408
    s_waitcnt lgkmcnt(2)
    v_mfma_f32_32x32x16_bf16 v[16:31], v[56:59], v[108:111], v[16:31]
    ds_read_b128 v[56:59], v14 offset:18432
    s_waitcnt lgkmcnt(2)
    v_mfma_f32_32x32x16_bf16 v[16:31], v[48:51], v[112:115], v[16:31]
    ds_read_b128 v[48:51], v14 offset:19456
    s_waitcnt lgkmcnt(2)
    v_mfma_f32_32x32x16_bf16 v[16:31], v[52:55], v[116:119], v[16:31]
    s_waitcnt lgkmcnt(1)
    v_mfma_f32_32x32x16_bf16 v[16:31], v[56:59], v[120:123], v[16:31]
    s_waitcnt lgkmcnt(0)
    v_mfma_f32_32x32x16_bf16 v[16:31], v[48:51], v[124:127], v[16:31]
    s_barrier
    s_waitcnt vmcnt(0)
    s_lshl_b32 s36, s56, 2
    s_add_u32 s36, s36, s3
    s_lshl_b32 s36, s36, 7
    s_lshl_b32 s37, s57, 2
    s_add_u32 s36, s36, s37
    s_add_u32 s36, s36, 37896192
    v_mov_b32 v3, s60
    v_mov_b32 v4, 0
    s_mov_b64 exec, 1
    buffer_atomic_swap v3, v4, s[8:11], s36 offen sc1
    s_mov_b64 exec, -1
    s_nop 7
    s_nop 7
    ds_read_b128 v[60:63], v11 offset:768
    ds_read_b128 v[64:67], v11 offset:800
    ds_read_b128 v[68:71], v11 offset:832
    ds_read_b128 v[72:75], v11 offset:864
    s_waitcnt lgkmcnt(0)
    v_fma_f32 v60, v8, v60, v16
    v_fma_f32 v61, v8, v61, v17
    v_fma_f32 v62, v8, v62, v18
    v_fma_f32 v63, v8, v63, v19
    v_fma_f32 v64, v8, v64, v20
    v_fma_f32 v65, v8, v65, v21
    v_fma_f32 v66, v8, v66, v22
    v_fma_f32 v67, v8, v67, v23
    v_fma_f32 v68, v8, v68, v24
    v_fma_f32 v69, v8, v69, v25
    v_fma_f32 v70, v8, v70, v26
    v_fma_f32 v71, v8, v71, v27
    v_fma_f32 v72, v8, v72, v28
    v_fma_f32 v73, v8, v73, v29
    v_fma_f32 v74, v8, v74, v30
    v_fma_f32 v75, v8, v75, v31
    v_mul_f32 v60, v60, v68
    v_mul_f32 v61, v61, v69
    v_mul_f32 v62, v62, v70
    v_mul_f32 v63, v63, v71
    v_mul_f32 v64, v64, v72
    v_mul_f32 v65, v65, v73
    v_mul_f32 v66, v66, v74
    v_mul_f32 v67, v67, v75
    v_mul_f32 v60, v60, v9
    v_mul_f32 v61, v61, v9
    v_mul_f32 v62, v62, v9
    v_mul_f32 v63, v63, v9
    v_mul_f32 v64, v64, v9
    v_mul_f32 v65, v65, v9
    v_mul_f32 v66, v66, v9
    v_mul_f32 v67, v67, v9
    v_cvt_pk_bf16_f32 v68, v60, v61
    v_cvt_pk_bf16_f32 v69, v62, v63
    v_cvt_pk_bf16_f32 v70, v64, v65
    v_cvt_pk_bf16_f32 v71, v66, v67
    s_lshr_b32 s45, s57, 1
    s_lshl_b32 s46, s45, 10
    s_and_b32 s45, s57, 1
    s_lshl_b32 s45, s45, 9
    s_add_u32 s46, s46, s45
    s_add_u32 s46, s46, 29407232
    buffer_store_dwordx4 v[68:71], v10, s[8:11], s46 offen sc1
    s_branch P_p3end
P_tail6:
    s_waitcnt vmcnt(0)
    s_lshl_b32 s36, s56, 2
    s_add_u32 s36, s36, s3
    s_lshl_b32 s36, s36, 7
    s_lshl_b32 s37, s57, 2
    s_add_u32 s36, s36, s37
    s_add_u32 s36, s36, 37896192
    v_mov_b32 v3, s60
    v_mov_b32 v4, 0
    s_mov_b64 exec, 1
    buffer_atomic_swap v3, v4, s[8:11], s36 offen sc1
    s_mov_b64 exec, -1
    s_nop 7
    s_nop 7
    ds_read_b128 v[60:63], v11 offset:640
    ds_read_b128 v[64:67], v11 offset:672
    ds_read_b128 v[68:71], v11 offset:704
    ds_read_b128 v[72:75], v11 offset:736
    s_waitcnt lgkmcnt(0)
    v_fma_f32 v60, v8, v60, v32
    v_fma_f32 v61, v8, v61, v33
    v_fma_f32 v62, v8, v62, v34
    v_fma_f32 v63, v8, v63, v35
    v_fma_f32 v64, v8, v64, v36
    v_fma_f32 v65, v8, v65, v37
    v_fma_f32 v66, v8, v66, v38
    v_fma_f32 v67, v8, v67, v39
    v_fma_f32 v68, v8, v68, v40
    v_fma_f32 v69, v8, v69, v41
    v_fma_f32 v70, v8, v70, v42
    v_fma_f32 v71, v8, v71, v43
    v_fma_f32 v72, v8, v72, v44
    v_fma_f32 v73, v8, v73, v45
    v_fma_f32 v74, v8, v74, v46
    v_fma_f32 v75, v8, v75, v47
    v_mul_f32 v60, v60, v68
    v_mul_f32 v61, v61, v69
    v_mul_f32 v62, v62, v70
    v_mul_f32 v63, v63, v71
    v_mul_f32 v64, v64, v72
    v_mul_f32 v65, v65, v73
    v_mul_f32 v66, v66, v74
    v_mul_f32 v67, v67, v75
    v_mul_f32 v60, v60, v9
    v_mul_f32 v61, v61, v9
    v_mul_f32 v62, v62, v9
    v_mul_f32 v63, v63, v9
    v_mul_f32 v64, v64, v9
    v_mul_f32 v65, v65, v9
    v_mul_f32 v66, v66, v9
    v_mul_f32 v67, v67, v9
    v_cvt_pk_bf16_f32 v68, v60, v61
    v_cvt_pk_bf16_f32 v69, v62, v63
    v_cvt_pk_bf16_f32 v70, v64, v65
    v_cvt_pk_bf16_f32 v71, v66, v67
    s_lshr_b32 s45, s57, 1
    s_lshl_b32 s46, s45, 10
    s_and_b32 s45, s57, 1
    s_lshl_b32 s45, s45, 9
    s_add_u32 s46, s46, s45
    s_add_u32 s46, s46, 29407232
    s_lshl_b32 s45, s57, 10
    s_add_u32 s45, s45, 29393408
    s_cmp_lt_u32 s57, 12
    s_cselect_b32 s46, s45, s46
    buffer_store_dwordx4 v[68:71], v10, s[8:11], s46 offen sc1
    s_waitcnt lgkmcnt(0)
    s_barrier
    s_barrier
P_p3end:
    s_waitcnt vmcnt(0)
    s_lshl_b32 s36, s56, 2
    s_add_u32 s36, s36, s3
    s_lshl_b32 s36, s36, 7
    s_lshl_b32 s37, s57, 2
    s_add_u32 s36, s36, s37
    s_add_u32 s36, s36, 37904384
    v_mov_b32 v3, s60
    v_mov_b32 v4, 0
    s_mov_b64 exec, 1
    buffer_atomic_swap v3, v4, s[8:11], s36 offen sc1
    s_mov_b64 exec, -1
P_p3done:
    s_or_b32 s36, s2, s3
    s_cmp_lg_u32 s36, 0
    s_cbranch_scc1 sequential_preLN__sliding_local_dilated__glu_gated_bilinear__prompt_kernel_ep8
    v_mov_b32 v3, s60
    v_mov_b32 v4, 0
    s_mov_b32 s36, 37748736
    s_mov_b64 exec, 1
    buffer_atomic_swap v3, v4, s[8:11], s36 offen sc1
    s_mov_b64 exec, -1
sequential_preLN__sliding_local_dilated__glu_gated_bilinear__prompt_kernel_ep8:
    s_setprio 0
    v_lshlrev_b32 v2, 4, v1
    v_mov_b32 v122, v2
    s_mul_i32 s54, s59, 276480
    s_add_u32 s54, s54, 16777216
    s_mul_i32 s55, s3, 5120
    s_mov_b32 s50, 122880
    s_cmp_eq_u32 s3, 1
    s_cselect_b32 s50, 128000, s50
    s_cmp_eq_u32 s3, 2
    s_cselect_b32 s50, 133120, s50
    s_cmp_eq_u32 s3, 3
    s_cselect_b32 s50, 138240, s50
    s_add_u32 s50, s50, s54
    s_add_u32 m0, s55, 122880
    s_add_u32 s51, s50, 0
    buffer_load_dwordx4 v122, s[8:11], s51 offen sc1 lds
    s_add_u32 m0, s55, 123904
    s_add_u32 s51, s50, 1024
    buffer_load_dwordx4 v122, s[8:11], s51 offen sc1 lds
    s_add_u32 m0, s55, 124928
    s_add_u32 s51, s50, 2048
    buffer_load_dwordx4 v122, s[8:11], s51 offen sc1 lds
    s_add_u32 m0, s55, 125952
    s_add_u32 s51, s50, 3072
    buffer_load_dwordx4 v122, s[8:11], s51 offen sc1 lds
    s_add_u32 m0, s55, 126976
    s_add_u32 s51, s50, 4096
    buffer_load_dwordx4 v122, s[8:11], s51 offen sc1 lds
    s_barrier
    s_mov_b32 s50, 143360
    s_cmp_eq_u32 s3, 1
    s_cselect_b32 s50, 148480, s50
    s_cmp_eq_u32 s3, 2
    s_cselect_b32 s50, 153600, s50
    s_cmp_eq_u32 s3, 3
    s_cselect_b32 s50, 158720, s50
    s_add_u32 s50, s50, s54
    s_add_u32 m0, s55, 0
    s_add_u32 s51, s50, 0
    buffer_load_dwordx4 v122, s[8:11], s51 offen sc1 lds
    s_add_u32 m0, s55, 1024
    s_add_u32 s51, s50, 1024
    buffer_load_dwordx4 v122, s[8:11], s51 offen sc1 lds
    s_add_u32 m0, s55, 2048
    s_add_u32 s51, s50, 2048
    buffer_load_dwordx4 v122, s[8:11], s51 offen sc1 lds
    s_add_u32 m0, s55, 3072
    s_add_u32 s51, s50, 3072
    buffer_load_dwordx4 v122, s[8:11], s51 offen sc1 lds
    s_add_u32 m0, s55, 4096
    s_add_u32 s51, s50, 4096
    buffer_load_dwordx4 v122, s[8:11], s51 offen sc1 lds
    s_mov_b32 s50, 163840
    s_cmp_eq_u32 s3, 1
    s_cselect_b32 s50, 168960, s50
    s_cmp_eq_u32 s3, 2
    s_cselect_b32 s50, 174080, s50
    s_cmp_eq_u32 s3, 3
    s_cselect_b32 s50, 179200, s50
    s_add_u32 s50, s50, s54
    s_add_u32 m0, s55, 20480
    s_add_u32 s51, s50, 0
    buffer_load_dwordx4 v122, s[8:11], s51 offen sc1 lds
    s_add_u32 m0, s55, 21504
    s_add_u32 s51, s50, 1024
    buffer_load_dwordx4 v122, s[8:11], s51 offen sc1 lds
    s_add_u32 m0, s55, 22528
    s_add_u32 s51, s50, 2048
    buffer_load_dwordx4 v122, s[8:11], s51 offen sc1 lds
    s_add_u32 m0, s55, 23552
    s_add_u32 s51, s50, 3072
    buffer_load_dwordx4 v122, s[8:11], s51 offen sc1 lds
    s_add_u32 m0, s55, 24576
    s_add_u32 s51, s50, 4096
    buffer_load_dwordx4 v122, s[8:11], s51 offen sc1 lds
    s_waitcnt vmcnt(5)
    s_barrier
    s_mov_b32 s50, 184320
    s_cmp_eq_u32 s3, 1
    s_cselect_b32 s50, 189440, s50
    s_cmp_eq_u32 s3, 2
    s_cselect_b32 s50, 194560, s50
    s_cmp_eq_u32 s3, 3
    s_cselect_b32 s50, 199680, s50
    s_add_u32 s50, s50, s54
    s_add_u32 m0, s55, 40960
    s_add_u32 s51, s50, 0
    buffer_load_dwordx4 v122, s[8:11], s51 offen sc1 lds
    s_add_u32 m0, s55, 41984
    s_add_u32 s51, s50, 1024
    buffer_load_dwordx4 v122, s[8:11], s51 offen sc1 lds
    s_add_u32 m0, s55, 43008
    s_add_u32 s51, s50, 2048
    buffer_load_dwordx4 v122, s[8:11], s51 offen sc1 lds
    s_add_u32 m0, s55, 44032
    s_add_u32 s51, s50, 3072
    buffer_load_dwordx4 v122, s[8:11], s51 offen sc1 lds
    s_add_u32 m0, s55, 45056
    s_add_u32 s51, s50, 4096
    buffer_load_dwordx4 v122, s[8:11], s51 offen sc1 lds
    s_mov_b32 s50, 204800
    s_cmp_eq_u32 s3, 1
    s_cselect_b32 s50, 209920, s50
    s_cmp_eq_u32 s3, 2
    s_cselect_b32 s50, 215040, s50
    s_cmp_eq_u32 s3, 3
    s_cselect_b32 s50, 220160, s50
    s_add_u32 s50, s50, s54
    s_add_u32 m0, s55, 61440
    s_add_u32 s51, s50, 0
    buffer_load_dwordx4 v122, s[8:11], s51 offen sc1 lds
    s_add_u32 m0, s55, 62464
    s_add_u32 s51, s50, 1024
    buffer_load_dwordx4 v122, s[8:11], s51 offen sc1 lds
    s_add_u32 m0, s55, 63488
    s_add_u32 s51, s50, 2048
    buffer_load_dwordx4 v122, s[8:11], s51 offen sc1 lds
    s_add_u32 m0, s55, 64512
    s_add_u32 s51, s50, 3072
    buffer_load_dwordx4 v122, s[8:11], s51 offen sc1 lds
    s_add_u32 m0, s55, 65536
    s_add_u32 s51, s50, 4096
    buffer_load_dwordx4 v122, s[8:11], s51 offen sc1 lds
    s_mov_b32 s50, 225280
    s_cmp_eq_u32 s3, 1
    s_cselect_b32 s50, 230400, s50
    s_cmp_eq_u32 s3, 2
    s_cselect_b32 s50, 235520, s50
    s_cmp_eq_u32 s3, 3
    s_cselect_b32 s50, 240640, s50
    s_add_u32 s50, s50, s54
    s_add_u32 m0, s55, 81920
    s_add_u32 s51, s50, 0
    buffer_load_dwordx4 v122, s[8:11], s51 offen sc1 lds
    s_add_u32 m0, s55, 82944
    s_add_u32 s51, s50, 1024
    buffer_load_dwordx4 v122, s[8:11], s51 offen sc1 lds
    s_add_u32 m0, s55, 83968
    s_add_u32 s51, s50, 2048
    buffer_load_dwordx4 v122, s[8:11], s51 offen sc1 lds
    s_add_u32 m0, s55, 84992
    s_add_u32 s51, s50, 3072
    buffer_load_dwordx4 v122, s[8:11], s51 offen sc1 lds
    s_add_u32 m0, s55, 86016
    s_add_u32 s51, s50, 4096
    buffer_load_dwordx4 v122, s[8:11], s51 offen sc1 lds
    s_waitcnt vmcnt(5)
    s_barrier
    s_mov_b32 s50, 245760
    s_cmp_eq_u32 s3, 1
    s_cselect_b32 s50, 250880, s50
    s_cmp_eq_u32 s3, 2
    s_cselect_b32 s50, 256000, s50
    s_cmp_eq_u32 s3, 3
    s_cselect_b32 s50, 261120, s50
    s_add_u32 s50, s50, s54
    s_add_u32 m0, s55, 102400
    s_add_u32 s51, s50, 0
    buffer_load_dwordx4 v122, s[8:11], s51 offen sc1 lds
    s_add_u32 m0, s55, 103424
    s_add_u32 s51, s50, 1024
    buffer_load_dwordx4 v122, s[8:11], s51 offen sc1 lds
    s_add_u32 m0, s55, 104448
    s_add_u32 s51, s50, 2048
    buffer_load_dwordx4 v122, s[8:11], s51 offen sc1 lds
    s_add_u32 m0, s55, 105472
    s_add_u32 s51, s50, 3072
    buffer_load_dwordx4 v122, s[8:11], s51 offen sc1 lds
    s_add_u32 m0, s55, 106496
    s_add_u32 s51, s50, 4096
    buffer_load_dwordx4 v122, s[8:11], s51 offen sc1 lds
    s_mov_b32 s50, 266240
    s_cmp_eq_u32 s3, 1
    s_cselect_b32 s50, 271360, s50
    s_cmp_eq_u32 s3, 2
    s_cselect_b32 s50, 0, s50
    s_cmp_eq_u32 s3, 3
    s_cselect_b32 s50, 0, s50
    s_add_u32 s50, s50, s54
    s_cmp_ge_u32 s3, 2
    s_cselect_b32 s36, 0x80000000, 0
    v_or_b32 v123, s36, v122
    s_add_u32 m0, s55, 122880
    s_add_u32 s51, s50, 0
    buffer_load_dwordx4 v123, s[8:11], s51 offen sc1 lds
    s_add_u32 m0, s55, 123904
    s_add_u32 s51, s50, 1024
    buffer_load_dwordx4 v123, s[8:11], s51 offen sc1 lds
    s_add_u32 m0, s55, 124928
    s_add_u32 s51, s50, 2048
    buffer_load_dwordx4 v123, s[8:11], s51 offen sc1 lds
    s_add_u32 m0, s55, 125952
    s_add_u32 s51, s50, 3072
    buffer_load_dwordx4 v123, s[8:11], s51 offen sc1 lds
    s_add_u32 m0, s55, 126976
    s_add_u32 s51, s50, 4096
    buffer_load_dwordx4 v123, s[8:11], s51 offen sc1 lds
    s_waitcnt vmcnt(0)
    s_barrier
    s_endpgm
P_B:
    s_mov_b32 s12, s16
    s_mov_b32 s13, s17
    s_mov_b32 s14, 2621440
    s_mov_b32 s15, 0x00020000
    s_sub_u32 s63, s3, 4
    v_lshrrev_b32 v2, 3, v1
    v_and_b32 v3, 7, v1
    v_xor_b32 v3, v3, v2
    v_lshlrev_b32 v3, 4, v3
    v_mul_u32_u24 v2, 0x500, v2
    v_add_u32 v120, v2, v3
    s_lshl_b32 s22, s56, 7
    s_sub_u32 s22, s22, 16
    s_lshl_b32 s36, s63, 3
    s_add_u32 s22, s22, s36
    s_mul_i32 s22, s22, 1280
    s_cmp_eq_u32 s56, 0
    s_cselect_b32 s36, 1, 0
    s_cmp_lt_u32 s63, 2
    s_cselect_b32 s36, s36, 0
    s_cmp_eq_u32 s36, 1
    s_cselect_b32 s23, 0, s22
    s_cselect_b32 s36, 0x80000000, 0
    v_or_b32 v121, s36, v120
    s_cmp_eq_u32 s63, 0
    s_cselect_b32 s32, 0xffffff00, -1
    s_mov_b32 s33, -1
    v_lshlrev_b32 v122, 4, v1
    s_mul_i32 s62, s57, 163840
    s_lshl_b32 s36, s63, 11
    s_add_u32 s62, s62, s36
    s_add_u32 s62, s62, 4194304
    s_lshl_b32 s63, s63, 10
    v_mov_b32 v123, 0x80000000
    s_cmp_ge_u32 s63, 2048
    s_cbranch_scc1 P_p1ld_b
    s_barrier
    s_cmp_ge_u32 s3, 6
    s_cbranch_scc1 Pa_bsW
    s_mov_b32 s4, s16
    s_mov_b32 s5, s17
    s_mov_b32 s6, 2621440
    s_mov_b32 s7, 0x00020000
    v_and_b32 v2, 3, v1
    v_lshrrev_b32 v3, 2, v1
    s_lshl_b32 s37, s56, 7
    s_lshl_b32 s38, s57, 3
    s_add_u32 s37, s37, s38
    s_sub_u32 s38, s3, 4
    s_lshl_b32 s38, s38, 2
    s_add_u32 s37, s37, s38
    v_add_u32 v13, s37, v2
    s_movk_i32 s38, 1280
    v_mul_lo_u32 v5, v13, s38
    v_lshl_add_u32 v5, v3, 4, v5
    buffer_load_dwordx4 v[48:51], v5, s[4:7], 0 offen offset:0
    buffer_load_dwordx4 v[52:55], v5, s[4:7], 0 offen offset:256
    buffer_load_dwordx4 v[56:59], v5, s[4:7], 0 offen offset:512
    buffer_load_dwordx4 v[60:63], v5, s[4:7], 0 offen offset:768
    buffer_load_dwordx4 v[64:67], v5, s[4:7], 0 offen offset:1024
    v_mov_b32 v10, 0
    v_mov_b32 v11, 0
    s_waitcnt vmcnt(0)
    v_lshlrev_b32 v68, 16, v48
    v_and_b32 v69, 0xffff0000, v48
    v_lshlrev_b32 v70, 16, v49
    v_and_b32 v71, 0xffff0000, v49
    v_lshlrev_b32 v72, 16, v50
    v_and_b32 v73, 0xffff0000, v50
    v_lshlrev_b32 v74, 16, v51
    v_and_b32 v75, 0xffff0000, v51
    v_lshlrev_b32 v76, 16, v52
    v_and_b32 v77, 0xffff0000, v52
    v_lshlrev_b32 v78, 16, v53
    v_and_b32 v79, 0xffff0000, v53
    v_lshlrev_b32 v80, 16, v54
    v_and_b32 v81, 0xffff0000, v54
    v_lshlrev_b32 v82, 16, v55
    v_and_b32 v83, 0xffff0000, v55
    v_lshlrev_b32 v84, 16, v56
    v_and_b32 v85, 0xffff0000, v56
    v_lshlrev_b32 v86, 16, v57
    v_and_b32 v87, 0xffff0000, v57
    v_lshlrev_b32 v88, 16, v58
    v_and_b32 v89, 0xffff0000, v58
    v_lshlrev_b32 v90, 16, v59
    v_and_b32 v91, 0xffff0000, v59
    v_lshlrev_b32 v92, 16, v60
    v_and_b32 v93, 0xffff0000, v60
    v_lshlrev_b32 v94, 16, v61
    v_and_b32 v95, 0xffff0000, v61
    v_lshlrev_b32 v96, 16, v62
    v_and_b32 v97, 0xffff0000, v62
    v_lshlrev_b32 v98, 16, v63
    v_and_b32 v99, 0xffff0000, v63
    v_lshlrev_b32 v100, 16, v64
    v_and_b32 v101, 0xffff0000, v64
    v_lshlrev_b32 v102, 16, v65
    v_and_b32 v103, 0xffff0000, v65
    v_lshlrev_b32 v104, 16, v66
    v_and_b32 v105, 0xffff0000, v66
    v_lshlrev_b32 v106, 16, v67
    v_and_b32 v107, 0xffff0000, v67
    v_pk_add_f32 v[10:11], v[10:11], v[68:69]
    v_pk_add_f32 v[10:11], v[10:11], v[70:71]
    v_pk_add_f32 v[10:11], v[10:11], v[72:73]
    v_pk_add_f32 v[10:11], v[10:11], v[74:75]
    v_pk_add_f32 v[10:11], v[10:11], v[76:77]
    v_pk_add_f32 v[10:11], v[10:11], v[78:79]
    v_pk_add_f32 v[10:11], v[10:11], v[80:81]
    v_pk_add_f32 v[10:11], v[10:11], v[82:83]
    v_pk_add_f32 v[10:11], v[10:11], v[84:85]
    v_pk_add_f32 v[10:11], v[10:11], v[86:87]
    v_pk_add_f32 v[10:11], v[10:11], v[88:89]
    v_pk_add_f32 v[10:11], v[10:11], v[90:91]
    v_pk_add_f32 v[10:11], v[10:11], v[92:93]
    v_pk_add_f32 v[10:11], v[10:11], v[94:95]
    v_pk_add_f32 v[10:11], v[10:11], v[96:97]
    v_pk_add_f32 v[10:11], v[10:11], v[98:99]
    v_pk_add_f32 v[10:11], v[10:11], v[100:101]
    v_pk_add_f32 v[10:11], v[10:11], v[102:103]
    v_pk_add_f32 v[10:11], v[10:11], v[104:105]
    v_pk_add_f32 v[10:11], v[10:11], v[106:107]
    v_add_f32 v10, v10, v11
    s_nop 1
    v_add_f32_dpp v10, v10, v10 row_ror:4 row_mask:0xf bank_mask:0xf
    s_nop 1
    v_add_f32_dpp v10, v10, v10 row_ror:8 row_mask:0xf bank_mask:0xf
    v_mov_b32 v12, v10
    s_nop 1
    v_permlane16_swap_b32 v12, v10
    s_nop 1
    v_add_f32 v10, v10, v12
    v_mov_b32 v12, v10
    s_nop 1
    v_permlane32_swap_b32 v12, v10
    s_nop 1
    v_add_f32 v10, v10, v12
    v_mul_f32 v10, -0.0015625, v10
    v_mov_b32 v14, 0
    v_mov_b32 v15, 0
    v_pk_add_f32 v[68:69], v[68:69], v[10:11] op_sel_hi:[1,0]
    v_pk_add_f32 v[70:71], v[70:71], v[10:11] op_sel_hi:[1,0]
    v_pk_add_f32 v[72:73], v[72:73], v[10:11] op_sel_hi:[1,0]
    v_pk_add_f32 v[74:75], v[74:75], v[10:11] op_sel_hi:[1,0]
    v_pk_add_f32 v[76:77], v[76:77], v[10:11] op_sel_hi:[1,0]
    v_pk_add_f32 v[78:79], v[78:79], v[10:11] op_sel_hi:[1,0]
    v_pk_add_f32 v[80:81], v[80:81], v[10:11] op_sel_hi:[1,0]
    v_pk_add_f32 v[82:83], v[82:83], v[10:11] op_sel_hi:[1,0]
    v_pk_add_f32 v[84:85], v[84:85], v[10:11] op_sel_hi:[1,0]
    v_pk_add_f32 v[86:87], v[86:87], v[10:11] op_sel_hi:[1,0]
    v_pk_add_f32 v[88:89], v[88:89], v[10:11] op_sel_hi:[1,0]
    v_pk_add_f32 v[90:91], v[90:91], v[10:11] op_sel_hi:[1,0]
    v_pk_add_f32 v[92:93], v[92:93], v[10:11] op_sel_hi:[1,0]
    v_pk_add_f32 v[94:95], v[94:95], v[10:11] op_sel_hi:[1,0]
    v_pk_add_f32 v[96:97], v[96:97], v[10:11] op_sel_hi:[1,0]
    v_pk_add_f32 v[98:99], v[98:99], v[10:11] op_sel_hi:[1,0]
    v_pk_add_f32 v[100:101], v[100:101], v[10:11] op_sel_hi:[1,0]
    v_pk_add_f32 v[102:103], v[102:103], v[10:11] op_sel_hi:[1,0]
    v_pk_add_f32 v[104:105], v[104:105], v[10:11] op_sel_hi:[1,0]
    v_pk_add_f32 v[106:107], v[106:107], v[10:11] op_sel_hi:[1,0]
    v_pk_fma_f32 v[14:15], v[68:69], v[68:69], v[14:15]
    v_pk_fma_f32 v[14:15], v[70:71], v[70:71], v[14:15]
    v_pk_fma_f32 v[14:15], v[72:73], v[72:73], v[14:15]
    v_pk_fma_f32 v[14:15], v[74:75], v[74:75], v[14:15]
    v_pk_fma_f32 v[14:15], v[76:77], v[76:77], v[14:15]
    v_pk_fma_f32 v[14:15], v[78:79], v[78:79], v[14:15]
    v_pk_fma_f32 v[14:15], v[80:81], v[80:81], v[14:15]
    v_pk_fma_f32 v[14:15], v[82:83], v[82:83], v[14:15]
    v_pk_fma_f32 v[14:15], v[84:85], v[84:85], v[14:15]
    v_pk_fma_f32 v[14:15], v[86:87], v[86:87], v[14:15]
    v_pk_fma_f32 v[14:15], v[88:89], v[88:89], v[14:15]
    v_pk_fma_f32 v[14:15], v[90:91], v[90:91], v[14:15]
    v_pk_fma_f32 v[14:15], v[92:93], v[92:93], v[14:15]
    v_pk_fma_f32 v[14:15], v[94:95], v[94:95], v[14:15]
    v_pk_fma_f32 v[14:15], v[96:97], v[96:97], v[14:15]
    v_pk_fma_f32 v[14:15], v[98:99], v[98:99], v[14:15]
    v_pk_fma_f32 v[14:15], v[100:101], v[100:101], v[14:15]
    v_pk_fma_f32 v[14:15], v[102:103], v[102:103], v[14:15]
    v_pk_fma_f32 v[14:15], v[104:105], v[104:105], v[14:15]
    v_pk_fma_f32 v[14:15], v[106:107], v[106:107], v[14:15]
    v_add_f32 v14, v14, v15
    s_nop 1
    v_add_f32_dpp v14, v14, v14 row_ror:4 row_mask:0xf bank_mask:0xf
    s_nop 1
    v_add_f32_dpp v14, v14, v14 row_ror:8 row_mask:0xf bank_mask:0xf
    v_mov_b32 v12, v14
    s_nop 1
    v_permlane16_swap_b32 v12, v14
    s_nop 1
    v_add_f32 v14, v14, v12
    v_mov_b32 v12, v14
    s_nop 1
    v_permlane32_swap_b32 v12, v14
    s_nop 1
    v_add_f32 v14, v14, v12
    v_mul_f32 v14, 0.0015625, v14
    v_add_f32 v14, 1e-5, v14
    v_rsq_f32 v11, v14
    s_nop 0
    v_mul_f32 v10, v10, v11
    v_lshlrev_b32 v6, 3, v13
    s_mov_b32 s38, 0
    s_mov_b64 exec, 15
    buffer_store_dwordx2 v[10:11], v6, s[8:11], s38 offen sc1
    s_mov_b64 exec, -1
    s_lshl_b32 s40, s56, 4
    s_add_u32 s40, s40, s57
    s_lshl_b32 s40, s40, 1
    s_add_u32 s40, s40, s3
    s_sub_u32 s40, s40, 4
    s_lshl_b32 s18, s40, 3
    s_add_u32 s18, s18, 37752832
    s_branch Pa_bsD
Pa_bsW:
    s_mov_b32 s18, 0
    s_cmp_ge_u32 s2, 200
    s_cbranch_scc1 Pa_bsD
    s_mov_b32 s4, s20
    s_mov_b32 s5, s21
    s_mov_b32 s6, 819200
    s_mov_b32 s7, 0x00020000
    s_mov_b32 s38, 214748365
    s_mul_hi_u32 s37, s2, s38
    s_mul_i32 s38, s37, 20
    s_sub_u32 s38, s2, s38
    s_lshl_b32 s39, s37, 7
    v_lshl_add_u32 v5, v1, 1, s39
    s_mul_i32 s36, s38, 40960
    s_sub_u32 s40, s3, 6
    s_mul_i32 s39, s40, 20480
    s_add_u32 s36, s36, s39
    s_add_u32 s54, s36, 0
    buffer_load_ushort v16, v5, s[4:7], s54 offen nt
    s_add_u32 s54, s36, 1280
    buffer_load_ushort v17, v5, s[4:7], s54 offen nt
    s_add_u32 s54, s36, 2560
    buffer_load_ushort v18, v5, s[4:7], s54 offen nt
    s_add_u32 s54, s36, 3840
    buffer_load_ushort v19, v5, s[4:7], s54 offen nt
    s_add_u32 s54, s36, 5120
    buffer_load_ushort v20, v5, s[4:7], s54 offen nt
    s_add_u32 s54, s36, 6400
    buffer_load_ushort v21, v5, s[4:7], s54 offen nt
    s_add_u32 s54, s36, 7680
    buffer_load_ushort v22, v5, s[4:7], s54 offen nt
    s_add_u32 s54, s36, 8960
    buffer_load_ushort v23, v5, s[4:7], s54 offen nt
    s_add_u32 s54, s36, 10240
    buffer_load_ushort v24, v5, s[4:7], s54 offen nt
    s_add_u32 s54, s36, 11520
    buffer_load_ushort v25, v5, s[4:7], s54 offen nt
    s_add_u32 s54, s36, 12800
    buffer_load_ushort v26, v5, s[4:7], s54 offen nt
    s_add_u32 s54, s36, 14080
    buffer_load_ushort v27, v5, s[4:7], s54 offen nt
    s_add_u32 s54, s36, 15360
    buffer_load_ushort v28, v5, s[4:7], s54 offen nt
    s_add_u32 s54, s36, 16640
    buffer_load_ushort v29, v5, s[4:7], s54 offen nt
    s_add_u32 s54, s36, 17920
    buffer_load_ushort v30, v5, s[4:7], s54 offen nt
    s_add_u32 s54, s36, 19200
    buffer_load_ushort v31, v5, s[4:7], s54 offen nt
    v_lshrrev_b32 v5, 4, v1
    s_lshl_b32 s39, s37, 2
    v_add_u32 v5, s39, v5
    v_mul_u32_u24 v6, 52, v5
    v_lshrrev_b32 v6, 8, v6
    v_mul_u32_u24 v7, 5, v6
    v_sub_u32 v7, v5, v7
    v_mul_u32_u24 v6, 100, v6
    v_add_u32 v6, v6, v7
    v_lshlrev_b32 v6, 10, v6
    v_and_b32 v7, 15, v1
    v_lshl_add_u32 v6, v7, 4, v6
    s_mul_i32 s39, s38, 5120
    s_lshl_b32 s38, s40, 9
    s_add_u32 s39, s39, s38
    s_add_u32 s39, s39, 8388608
    s_lshl_b32 s18, s2, 1
    s_add_u32 s18, s18, s40
    s_lshl_b32 s18, s18, 3
    s_add_u32 s18, s18, 38076416
    s_waitcnt vmcnt(0)
    v_lshl_or_b32 v80, v17, 16, v16
    v_lshl_or_b32 v81, v19, 16, v18
    v_lshl_or_b32 v82, v21, 16, v20
    v_lshl_or_b32 v83, v23, 16, v22
    buffer_store_dwordx4 v[80:83], v6, s[8:11], s39 offen offset:0 sc1
    v_lshl_or_b32 v84, v25, 16, v24
    v_lshl_or_b32 v85, v27, 16, v26
    v_lshl_or_b32 v86, v29, 16, v28
    v_lshl_or_b32 v87, v31, 16, v30
    buffer_store_dwordx4 v[84:87], v6, s[8:11], s39 offen offset:256 sc1
Pa_bsD:
    s_add_u32 m0, s63, 0
    s_add_u32 s48, s23, 0
    s_mov_b64 exec, s[32:33]
    buffer_load_dwordx4 v121, s[12:15], s48 offen  lds
    s_mov_b64 exec, -1
    s_add_u32 m0, s63, 4096
    s_add_u32 s48, s22, 40960
    buffer_load_dwordx4 v120, s[12:15], s48 offen  lds
    s_add_u32 m0, s63, 8192
    s_add_u32 s48, s22, 81920
    buffer_load_dwordx4 v120, s[12:15], s48 offen  lds
    s_add_u32 m0, s63, 12288
    s_add_u32 s48, s22, 122880
    buffer_load_dwordx4 v120, s[12:15], s48 offen  lds
    s_add_u32 m0, s63, 16384
    s_add_u32 s48, s22, 163840
    buffer_load_dwordx4 v120, s[12:15], s48 offen  lds
    s_add_u32 m0, s63, 18432
    s_add_u32 s48, s23, 128
    s_mov_b64 exec, s[32:33]
    buffer_load_dwordx4 v121, s[12:15], s48 offen  lds
    s_mov_b64 exec, -1
    s_add_u32 m0, s63, 22528
    s_add_u32 s48, s22, 41088
    buffer_load_dwordx4 v120, s[12:15], s48 offen  lds
    s_add_u32 m0, s63, 26624
    s_add_u32 s48, s22, 82048
    buffer_load_dwordx4 v120, s[12:15], s48 offen  lds
    s_add_u32 m0, s63, 30720
    s_add_u32 s48, s22, 123008
    buffer_load_dwordx4 v120, s[12:15], s48 offen  lds
    s_add_u32 m0, s63, 34816
    s_add_u32 s48, s22, 163968
    buffer_load_dwordx4 v120, s[12:15], s48 offen  lds
    s_add_u32 m0, s63, 36864
    s_add_u32 s48, s23, 256
    s_mov_b64 exec, s[32:33]
    buffer_load_dwordx4 v121, s[12:15], s48 offen  lds
    s_mov_b64 exec, -1
    s_add_u32 m0, s63, 40960
    s_add_u32 s48, s22, 41216
    buffer_load_dwordx4 v120, s[12:15], s48 offen  lds
    s_add_u32 m0, s63, 45056
    s_add_u32 s48, s22, 82176
    buffer_load_dwordx4 v120, s[12:15], s48 offen  lds
    s_add_u32 m0, s63, 49152
    s_add_u32 s48, s22, 123136
    buffer_load_dwordx4 v120, s[12:15], s48 offen  lds
    s_add_u32 m0, s63, 53248
    s_add_u32 s48, s22, 164096
    buffer_load_dwordx4 v120, s[12:15], s48 offen  lds
    s_sub_u32 s61, s3, 4
    s_lshl_b32 s61, s61, 8
    s_add_u32 s61, s61, s2
    s_mov_b32 s50, s61
    s_mov_b32 s36, s61
    s_mov_b32 s38, 15907287
    s_mul_hi_u32 s37, s36, s38
    s_mul_i32 s38, s37, 270
    s_sub_u32 s38, s36, s38
    s_mov_b32 s39, 429496730
    s_mul_hi_u32 s39, s38, s39
    s_mul_i32 s40, s39, 10
    s_sub_u32 s40, s38, s40
    s_cmp_eq_u32 s37, 0
    s_cselect_b32 s4, s24, s26
    s_cselect_b32 s5, s25, s27
    s_mov_b32 s6, 2211840
    s_mov_b32 s7, 0x00020000
    v_and_b32 v2, 15, v1
    v_lshrrev_b32 v3, 4, v1
    s_lshl_b32 s41, s40, 6
    v_lshl_add_u32 v4, v3, 3, s41
    s_movk_i32 s41, 3456
    v_mul_lo_u32 v4, v4, s41
    s_lshl_b32 s41, s39, 7
    v_add_u32 v4, s41, v4
    v_lshl_add_u32 v4, v2, 3, v4
    v_mov_b32 v5, 0x80000000
    s_cmp_ge_u32 s36, 540
    s_cselect_b64 vcc, -1, 0
    s_mov_b32 s44, s37
    s_mov_b32 s46, s39
    s_mov_b32 s47, s40
    v_cndmask_b32 v4, v4, v5, vcc
    s_mov_b32 s41, 0
    buffer_load_dwordx2 v[16:17], v4, s[4:7], s41 offen nt
    s_mov_b32 s41, 3456
    buffer_load_dwordx2 v[18:19], v4, s[4:7], s41 offen nt
    s_mov_b32 s41, 6912
    buffer_load_dwordx2 v[20:21], v4, s[4:7], s41 offen nt
    s_mov_b32 s41, 10368
    buffer_load_dwordx2 v[22:23], v4, s[4:7], s41 offen nt
    s_mov_b32 s41, 13824
    buffer_load_dwordx2 v[24:25], v4, s[4:7], s41 offen nt
    s_mov_b32 s41, 17280
    buffer_load_dwordx2 v[26:27], v4, s[4:7], s41 offen nt
    s_mov_b32 s41, 20736
    buffer_load_dwordx2 v[28:29], v4, s[4:7], s41 offen nt
    s_mov_b32 s41, 24192
    buffer_load_dwordx2 v[30:31], v4, s[4:7], s41 offen nt
    s_mov_b32 s41, 110592
    buffer_load_dwordx2 v[32:33], v4, s[4:7], s41 offen nt
    s_mov_b32 s41, 114048
    buffer_load_dwordx2 v[34:35], v4, s[4:7], s41 offen nt
    s_mov_b32 s41, 117504
    buffer_load_dwordx2 v[36:37], v4, s[4:7], s41 offen nt
    s_mov_b32 s41, 120960
    buffer_load_dwordx2 v[38:39], v4, s[4:7], s41 offen nt
    s_mov_b32 s41, 124416
    buffer_load_dwordx2 v[40:41], v4, s[4:7], s41 offen nt
    s_mov_b32 s41, 127872
    buffer_load_dwordx2 v[42:43], v4, s[4:7], s41 offen nt
    s_mov_b32 s41, 131328
    buffer_load_dwordx2 v[44:45], v4, s[4:7], s41 offen nt
    s_mov_b32 s41, 134784
    buffer_load_dwordx2 v[46:47], v4, s[4:7], s41 offen nt
    s_mov_b32 s24, s44
    s_mov_b32 s25, s46
    s_mov_b32 s26, s47
    s_mov_b32 s36, s50
    s_mov_b32 s4, s28
    s_mov_b32 s5, s29
    s_mov_b32 s6, 2211840
    s_mov_b32 s7, 0x00020000
    s_mov_b32 s38, 79536432
    s_mul_hi_u32 s37, s36, s38
    s_mul_i32 s38, s37, 54
    s_sub_u32 s38, s36, s38
    s_mov_b32 s20, s37
    s_mov_b32 s21, s38
    s_lshl_b32 s39, s37, 7
    v_lshl_add_u32 v4, v1, 1, s39
    v_mov_b32 v5, 0x80000000
    s_cmp_ge_u32 s36, 540
    s_cselect_b64 vcc, -1, 0
    s_cselect_b32 s38, 0, s38
    s_nop 0
    v_cndmask_b32 v4, v4, v5, vcc
    s_lshr_b32 s39, s38, 1
    s_and_b32 s40, s38, 1
    s_lshl_b32 s40, s40, 1
    s_add_u32 s40, s40, 0
    s_sub_u32 s41, s38, 32
    s_cmp_ge_u32 s38, 32
    s_cselect_b32 s39, s41, s39
    s_cselect_b32 s40, 4, s40
    s_sub_u32 s41, s38, 44
    s_lshl_b32 s41, s41, 1
    s_add_u32 s41, s41, 12
    s_cmp_ge_u32 s38, 44
    s_cselect_b32 s39, s41, s39
    s_cselect_b32 s40, 4, s40
    s_sub_u32 s41, s38, 46
    s_lshl_b32 s41, s41, 1
    s_add_u32 s41, s41, 0
    s_cmp_ge_u32 s38, 46
    s_cselect_b32 s39, s41, s39
    s_cselect_b32 s41, 1, 0
    s_cmp_lt_u32 s39, 12
    s_cselect_b32 s36, 6, 5
    s_cmp_eq_u32 s41, 1
    s_cselect_b32 s40, s36, s40
    s_mul_i32 s36, s39, 7
    s_sub_u32 s41, s39, 12
    s_cmp_gt_u32 s39, 12
    s_cselect_b32 s41, s41, 0
    s_sub_u32 s36, s36, s41
    s_add_u32 s36, s36, s40
    s_lshr_b32 s41, s36, 2
    s_lshl_b32 s41, s41, 6
    s_and_b32 s36, s36, 3
    s_add_u32 s36, s36, s41
    s_mul_i32 s40, s36, 1280
    s_add_u32 s41, s40, 0
    buffer_load_ushort v48, v4, s[4:7], s41 offen nt
    s_add_u32 s41, s40, 5120
    buffer_load_ushort v49, v4, s[4:7], s41 offen nt
    s_add_u32 s41, s40, 10240
    buffer_load_ushort v50, v4, s[4:7], s41 offen nt
    s_add_u32 s41, s40, 15360
    buffer_load_ushort v51, v4, s[4:7], s41 offen nt
    s_add_u32 s41, s40, 40960
    buffer_load_ushort v52, v4, s[4:7], s41 offen nt
    s_add_u32 s41, s40, 46080
    buffer_load_ushort v53, v4, s[4:7], s41 offen nt
    s_add_u32 s41, s40, 51200
    buffer_load_ushort v54, v4, s[4:7], s41 offen nt
    s_add_u32 s41, s40, 56320
    buffer_load_ushort v55, v4, s[4:7], s41 offen nt
    s_add_u32 s41, s40, 20480
    buffer_load_ushort v56, v4, s[4:7], s41 offen nt
    s_add_u32 s41, s40, 25600
    buffer_load_ushort v57, v4, s[4:7], s41 offen nt
    s_add_u32 s41, s40, 30720
    buffer_load_ushort v58, v4, s[4:7], s41 offen nt
    s_add_u32 s41, s40, 35840
    buffer_load_ushort v59, v4, s[4:7], s41 offen nt
    s_add_u32 s41, s40, 61440
    buffer_load_ushort v60, v4, s[4:7], s41 offen nt
    s_add_u32 s41, s40, 66560
    buffer_load_ushort v61, v4, s[4:7], s41 offen nt
    s_add_u32 s41, s40, 71680
    buffer_load_ushort v62, v4, s[4:7], s41 offen nt
    s_add_u32 s41, s40, 76800
    buffer_load_ushort v63, v4, s[4:7], s41 offen nt
    s_lshr_b32 s39, s38, 1
    s_and_b32 s40, s38, 1
    s_lshl_b32 s40, s40, 1
    s_add_u32 s40, s40, 1
    s_sub_u32 s41, s38, 32
    s_cmp_ge_u32 s38, 32
    s_cselect_b32 s39, s41, s39
    s_cselect_b32 s40, 5, s40
    s_sub_u32 s41, s38, 44
    s_lshl_b32 s41, s41, 1
    s_add_u32 s41, s41, 13
    s_cmp_ge_u32 s38, 44
    s_cselect_b32 s39, s41, s39
    s_cselect_b32 s40, 4, s40
    s_sub_u32 s41, s38, 46
    s_lshl_b32 s41, s41, 1
    s_add_u32 s41, s41, 1
    s_cmp_ge_u32 s38, 46
    s_cselect_b32 s39, s41, s39
    s_cselect_b32 s41, 1, 0
    s_cmp_lt_u32 s39, 12
    s_cselect_b32 s36, 6, 5
    s_cmp_eq_u32 s41, 1
    s_cselect_b32 s40, s36, s40
    s_mul_i32 s36, s39, 7
    s_sub_u32 s41, s39, 12
    s_cmp_gt_u32 s39, 12
    s_cselect_b32 s41, s41, 0
    s_sub_u32 s36, s36, s41
    s_add_u32 s36, s36, s40
    s_lshr_b32 s41, s36, 2
    s_lshl_b32 s41, s41, 6
    s_and_b32 s36, s36, 3
    s_add_u32 s36, s36, s41
    s_mul_i32 s40, s36, 1280
    s_add_u32 s41, s40, 0
    buffer_load_ushort v64, v4, s[4:7], s41 offen nt
    s_add_u32 s41, s40, 5120
    buffer_load_ushort v65, v4, s[4:7], s41 offen nt
    s_add_u32 s41, s40, 10240
    buffer_load_ushort v66, v4, s[4:7], s41 offen nt
    s_add_u32 s41, s40, 15360
    buffer_load_ushort v67, v4, s[4:7], s41 offen nt
    s_add_u32 s41, s40, 40960
    buffer_load_ushort v68, v4, s[4:7], s41 offen nt
    s_add_u32 s41, s40, 46080
    buffer_load_ushort v69, v4, s[4:7], s41 offen nt
    s_add_u32 s41, s40, 51200
    buffer_load_ushort v70, v4, s[4:7], s41 offen nt
    s_add_u32 s41, s40, 56320
    buffer_load_ushort v71, v4, s[4:7], s41 offen nt
    s_add_u32 s41, s40, 20480
    buffer_load_ushort v72, v4, s[4:7], s41 offen nt
    s_add_u32 s41, s40, 25600
    buffer_load_ushort v73, v4, s[4:7], s41 offen nt
    s_add_u32 s41, s40, 30720
    buffer_load_ushort v74, v4, s[4:7], s41 offen nt
    s_add_u32 s41, s40, 35840
    buffer_load_ushort v75, v4, s[4:7], s41 offen nt
    s_add_u32 s41, s40, 61440
    buffer_load_ushort v76, v4, s[4:7], s41 offen nt
    s_add_u32 s41, s40, 66560
    buffer_load_ushort v77, v4, s[4:7], s41 offen nt
    s_add_u32 s41, s40, 71680
    buffer_load_ushort v78, v4, s[4:7], s41 offen nt
    s_add_u32 s41, s40, 76800
    buffer_load_ushort v79, v4, s[4:7], s41 offen nt
    s_waitcnt vmcnt(63) lgkmcnt(0)
    s_add_u32 s60, s60, 1
    s_cmp_eq_u32 s18, 0
    s_cselect_b32 s38, 0x80000000, 0
    v_mov_b32 v9, s38
    v_mov_b32 v3, s60
    s_mov_b64 exec, 1
    buffer_atomic_swap v3, v9, s[8:11], s18 offen sc1
    s_mov_b64 exec, -1
    s_lshl_b32 s36, s57, 9
    s_add_u32 s36, s36, 37945344
    v_lshl_add_u32 v5, v1, 3, s36
    s_mov_b32 s51, 0
sequential_preLN__sliding_local_dilated__glu_gated_bilinear__prompt_kernel_poll9:
    buffer_load_dword v3, v5, s[8:11], 0 offen sc1
    s_add_u32 s51, s51, 1
    s_cmp_gt_u32 s51, 200000
    s_cbranch_scc1 sequential_preLN__sliding_local_dilated__glu_gated_bilinear__prompt_kernel_pollx10
    s_waitcnt vmcnt(0)
    v_cmp_ne_u32 vcc, s60, v3
    s_nop 1
    s_cbranch_vccz sequential_preLN__sliding_local_dilated__glu_gated_bilinear__prompt_kernel_pollx10
    s_sleep 2
    s_branch sequential_preLN__sliding_local_dilated__glu_gated_bilinear__prompt_kernel_poll9
sequential_preLN__sliding_local_dilated__glu_gated_bilinear__prompt_kernel_pollx10:
    s_waitcnt vmcnt(0)
    s_lshl_b32 s49, s63, 1
    s_add_u32 m0, s49, 92160
    s_add_u32 s48, s62, 0
    buffer_load_dwordx4 v122, s[8:11], s48 offen sc1 lds
    s_lshl_b32 s49, s63, 1
    s_add_u32 m0, s49, 93184
    s_add_u32 s48, s62, 1024
    buffer_load_dwordx4 v122, s[8:11], s48 offen sc1 lds
    s_lshl_b32 s49, s63, 1
    s_add_u32 m0, s49, 100352
    s_add_u32 s48, s62, 8192
    buffer_load_dwordx4 v122, s[8:11], s48 offen sc1 lds
    s_lshl_b32 s49, s63, 1
    s_add_u32 m0, s49, 101376
    s_add_u32 s48, s62, 9216
    buffer_load_dwordx4 v122, s[8:11], s48 offen sc1 lds
    s_lshl_b32 s49, s63, 1
    s_add_u32 m0, s49, 108544
    s_add_u32 s48, s62, 16384
    buffer_load_dwordx4 v122, s[8:11], s48 offen sc1 lds
    s_lshl_b32 s49, s63, 1
    s_add_u32 m0, s49, 109568
    s_add_u32 s48, s62, 17408
    buffer_load_dwordx4 v122, s[8:11], s48 offen sc1 lds
    s_lshl_b32 s49, s63, 1
    s_add_u32 m0, s49, 116736
    s_add_u32 s48, s62, 24576
    buffer_load_dwordx4 v122, s[8:11], s48 offen sc1 lds
    s_lshl_b32 s49, s63, 1
    s_add_u32 m0, s49, 117760
    s_add_u32 s48, s62, 25600
    buffer_load_dwordx4 v122, s[8:11], s48 offen sc1 lds
    s_lshl_b32 s49, s63, 1
    s_add_u32 m0, s49, 124928
    s_add_u32 s48, s62, 32768
    buffer_load_dwordx4 v122, s[8:11], s48 offen sc1 lds
    s_lshl_b32 s49, s63, 1
    s_add_u32 m0, s49, 125952
    s_add_u32 s48, s62, 33792
    buffer_load_dwordx4 v122, s[8:11], s48 offen sc1 lds
    s_lshl_b32 s49, s63, 1
    s_add_u32 m0, s49, 133120
    s_add_u32 s48, s62, 40960
    buffer_load_dwordx4 v122, s[8:11], s48 offen sc1 lds
    s_lshl_b32 s49, s63, 1
    s_add_u32 m0, s49, 134144
    s_add_u32 s48, s62, 41984
    buffer_load_dwordx4 v122, s[8:11], s48 offen sc1 lds
    s_add_u32 m0, s63, 55296
    s_add_u32 s48, s23, 384
    s_mov_b64 exec, s[32:33]
    buffer_load_dwordx4 v121, s[12:15], s48 offen  lds
    s_mov_b64 exec, -1
    s_add_u32 m0, s63, 59392
    s_add_u32 s48, s22, 41344
    buffer_load_dwordx4 v120, s[12:15], s48 offen  lds
    s_add_u32 m0, s63, 63488
    s_add_u32 s48, s22, 82304
    buffer_load_dwordx4 v120, s[12:15], s48 offen  lds
    s_add_u32 m0, s63, 67584
    s_add_u32 s48, s22, 123264
    buffer_load_dwordx4 v120, s[12:15], s48 offen  lds
    s_add_u32 m0, s63, 71680
    s_add_u32 s48, s22, 164224
    buffer_load_dwordx4 v120, s[12:15], s48 offen  lds
    s_waitcnt vmcnt(13)
    s_barrier
    s_lshl_b32 s49, s63, 1
    s_add_u32 m0, s49, 141312
    s_add_u32 s48, s62, 49152
    buffer_load_dwordx4 v122, s[8:11], s48 offen sc1 lds
    s_lshl_b32 s49, s63, 1
    s_add_u32 m0, s49, 142336
    s_add_u32 s48, s62, 50176
    buffer_load_dwordx4 v122, s[8:11], s48 offen sc1 lds
    s_lshl_b32 s49, s63, 1
    s_add_u32 m0, s49, 149504
    s_add_u32 s48, s62, 57344
    buffer_load_dwordx4 v122, s[8:11], s48 offen sc1 lds
    s_lshl_b32 s49, s63, 1
    s_add_u32 m0, s49, 150528
    s_add_u32 s48, s62, 58368
    buffer_load_dwordx4 v122, s[8:11], s48 offen sc1 lds
    s_add_u32 m0, s63, 73728
    s_add_u32 s48, s23, 512
    s_mov_b64 exec, s[32:33]
    buffer_load_dwordx4 v121, s[12:15], s48 offen  lds
    s_mov_b64 exec, -1
    s_add_u32 m0, s63, 77824
    s_add_u32 s48, s22, 41472
    buffer_load_dwordx4 v120, s[12:15], s48 offen  lds
    s_add_u32 m0, s63, 81920
    s_add_u32 s48, s22, 82432
    buffer_load_dwordx4 v120, s[12:15], s48 offen  lds
    s_add_u32 m0, s63, 86016
    s_add_u32 s48, s22, 123392
    buffer_load_dwordx4 v120, s[12:15], s48 offen  lds
    s_add_u32 m0, s63, 90112
    s_add_u32 s48, s22, 164352
    buffer_load_dwordx4 v120, s[12:15], s48 offen  lds
    s_waitcnt vmcnt(20)
    s_barrier
    s_lshl_b32 s49, s63, 1
    s_add_u32 m0, s49, 92160
    s_add_u32 s48, s62, 65536
    buffer_load_dwordx4 v122, s[8:11], s48 offen sc1 lds
    s_lshl_b32 s49, s63, 1
    s_add_u32 m0, s49, 93184
    s_add_u32 s48, s62, 66560
    buffer_load_dwordx4 v122, s[8:11], s48 offen sc1 lds
    s_waitcnt vmcnt(20)
    s_barrier
    s_lshl_b32 s49, s63, 1
    s_add_u32 m0, s49, 100352
    s_add_u32 s48, s62, 73728
    buffer_load_dwordx4 v122, s[8:11], s48 offen sc1 lds
    s_lshl_b32 s49, s63, 1
    s_add_u32 m0, s49, 101376
    s_add_u32 s48, s62, 74752
    buffer_load_dwordx4 v122, s[8:11], s48 offen sc1 lds
    s_add_u32 m0, s63, 0
    s_add_u32 s48, s23, 640
    s_mov_b64 exec, s[32:33]
    buffer_load_dwordx4 v121, s[12:15], s48 offen  lds
    s_mov_b64 exec, -1
    s_add_u32 m0, s63, 4096
    s_add_u32 s48, s22, 41600
    buffer_load_dwordx4 v120, s[12:15], s48 offen  lds
    s_add_u32 m0, s63, 8192
    s_add_u32 s48, s22, 82560
    buffer_load_dwordx4 v120, s[12:15], s48 offen  lds
    s_add_u32 m0, s63, 12288
    s_add_u32 s48, s22, 123520
    buffer_load_dwordx4 v120, s[12:15], s48 offen  lds
    s_add_u32 m0, s63, 16384
    s_add_u32 s48, s22, 164480
    buffer_load_dwordx4 v120, s[12:15], s48 offen  lds
    s_waitcnt vmcnt(25)
    s_barrier
    s_lshl_b32 s49, s63, 1
    s_add_u32 m0, s49, 108544
    s_add_u32 s48, s62, 81920
    buffer_load_dwordx4 v122, s[8:11], s48 offen sc1 lds
    s_lshl_b32 s49, s63, 1
    s_add_u32 m0, s49, 109568
    s_add_u32 s48, s62, 82944
    buffer_load_dwordx4 v122, s[8:11], s48 offen sc1 lds
    s_waitcnt vmcnt(25)
    s_barrier
    s_lshl_b32 s49, s63, 1
    s_add_u32 m0, s49, 116736
    s_add_u32 s48, s62, 90112
    buffer_load_dwordx4 v122, s[8:11], s48 offen sc1 lds
    s_lshl_b32 s49, s63, 1
    s_add_u32 m0, s49, 117760
    s_add_u32 s48, s62, 91136
    buffer_load_dwordx4 v122, s[8:11], s48 offen sc1 lds
    s_add_u32 m0, s63, 18432
    s_add_u32 s48, s23, 768
    s_mov_b64 exec, s[32:33]
    buffer_load_dwordx4 v121, s[12:15], s48 offen  lds
    s_mov_b64 exec, -1
    s_add_u32 m0, s63, 22528
    s_add_u32 s48, s22, 41728
    buffer_load_dwordx4 v120, s[12:15], s48 offen  lds
    s_add_u32 m0, s63, 26624
    s_add_u32 s48, s22, 82688
    buffer_load_dwordx4 v120, s[12:15], s48 offen  lds
    s_add_u32 m0, s63, 30720
    s_add_u32 s48, s22, 123648
    buffer_load_dwordx4 v120, s[12:15], s48 offen  lds
    s_add_u32 m0, s63, 34816
    s_add_u32 s48, s22, 164608
    buffer_load_dwordx4 v120, s[12:15], s48 offen  lds
    v_and_b32 v2, 15, v1
    v_lshrrev_b32 v3, 4, v1
    v_lshrrev_b32 v5, 1, v3
    v_lshlrev_b32 v5, 10, v5
    v_and_b32 v6, 1, v3
    v_lshl_add_u32 v5, v6, 9, v5
    v_lshl_add_u32 v5, v2, 4, v5
    s_lshl_b32 s41, s24, 8
    v_add_u32 v5, s41, v5
    s_mul_i32 s42, s25, 163840
    s_lshl_b32 s43, s26, 12
    s_add_u32 s42, s42, s43
    s_add_u32 s42, s42, 10485760
    v_mov_b32 v7, 0x80000000
    s_cmp_ge_u32 s61, 540
    s_cselect_b64 vcc, -1, 0
    s_cselect_b32 s42, 0, s42
    s_mov_b32 s46, 0x05040100
    s_mov_b32 s47, 0x07060302
    s_mov_b32 s50, 0x3f803f80
    v_cndmask_b32 v112, v5, v7, vcc
    v_lshlrev_b32 v6, 2, v2
    v_cndmask_b32 v113, v6, v7, vcc
    v_mov_b32 v8, 0
    v_mov_b32 v9, 0
    v_mov_b32 v10, 0
    v_mov_b32 v11, 0
    s_waitcnt vmcnt(25)
    s_barrier
    s_lshl_b32 s49, s63, 1
    s_add_u32 m0, s49, 124928
    s_add_u32 s48, s62, 98304
    buffer_load_dwordx4 v122, s[8:11], s48 offen sc1 lds
    s_lshl_b32 s49, s63, 1
    s_add_u32 m0, s49, 125952
    s_add_u32 s48, s62, 99328
    buffer_load_dwordx4 v122, s[8:11], s48 offen sc1 lds
    v_perm_b32 v80, v18, v16, s46
    v_perm_b32 v81, v22, v20, s46
    v_perm_b32 v82, v26, v24, s46
    v_perm_b32 v83, v30, v28, s46
    v_perm_b32 v84, v18, v16, s47
    v_perm_b32 v85, v22, v20, s47
    v_perm_b32 v86, v26, v24, s47
    v_perm_b32 v87, v30, v28, s47
    s_add_u32 s43, s42, 0
    buffer_store_dwordx4 v[80:83], v112, s[8:11], s43 offen sc1
    s_add_u32 s43, s42, 40960
    buffer_store_dwordx4 v[84:87], v112, s[8:11], s43 offen sc1
    s_waitcnt vmcnt(27)
    s_barrier
    s_lshl_b32 s49, s63, 1
    s_add_u32 m0, s49, 133120
    s_add_u32 s48, s62, 106496
    buffer_load_dwordx4 v122, s[8:11], s48 offen sc1 lds
    s_lshl_b32 s49, s63, 1
    s_add_u32 m0, s49, 134144
    s_add_u32 s48, s62, 107520
    buffer_load_dwordx4 v122, s[8:11], s48 offen sc1 lds
    s_add_u32 m0, s63, 36864
    s_add_u32 s48, s23, 896
    s_mov_b64 exec, s[32:33]
    buffer_load_dwordx4 v121, s[12:15], s48 offen  lds
    s_mov_b64 exec, -1
    s_add_u32 m0, s63, 40960
    s_add_u32 s48, s22, 41856
    buffer_load_dwordx4 v120, s[12:15], s48 offen  lds
    s_add_u32 m0, s63, 45056
    s_add_u32 s48, s22, 82816
    buffer_load_dwordx4 v120, s[12:15], s48 offen  lds
    s_add_u32 m0, s63, 49152
    s_add_u32 s48, s22, 123776
    buffer_load_dwordx4 v120, s[12:15], s48 offen  lds
    s_add_u32 m0, s63, 53248
    s_add_u32 s48, s22, 164736
    buffer_load_dwordx4 v120, s[12:15], s48 offen  lds
    v_perm_b32 v88, v19, v17, s46
    v_perm_b32 v89, v23, v21, s46
    v_perm_b32 v90, v27, v25, s46
    v_perm_b32 v91, v31, v29, s46
    v_perm_b32 v92, v19, v17, s47
    v_perm_b32 v93, v23, v21, s47
    v_perm_b32 v94, v27, v25, s47
    v_perm_b32 v95, v31, v29, s47
    s_add_u32 s43, s42, 81920
    buffer_store_dwordx4 v[88:91], v112, s[8:11], s43 offen sc1
    s_add_u32 s43, s42, 122880
    buffer_store_dwordx4 v[92:95], v112, s[8:11], s43 offen sc1
    s_waitcnt vmcnt(29)
    s_barrier
    s_lshl_b32 s49, s63, 1
    s_add_u32 m0, s49, 141312
    s_add_u32 s48, s62, 114688
    buffer_load_dwordx4 v122, s[8:11], s48 offen sc1 lds
    s_lshl_b32 s49, s63, 1
    s_add_u32 m0, s49, 142336
    s_add_u32 s48, s62, 115712
    buffer_load_dwordx4 v122, s[8:11], s48 offen sc1 lds
    v_perm_b32 v96, v34, v32, s46
    v_perm_b32 v97, v38, v36, s46
    v_perm_b32 v98, v42, v40, s46
    v_perm_b32 v99, v46, v44, s46
    v_perm_b32 v100, v34, v32, s47
    v_perm_b32 v101, v38, v36, s47
    v_perm_b32 v102, v42, v40, s47
    v_perm_b32 v103, v46, v44, s47
    s_add_u32 s43, s42, 2048
    buffer_store_dwordx4 v[96:99], v112, s[8:11], s43 offen sc1
    s_add_u32 s43, s42, 43008
    buffer_store_dwordx4 v[100:103], v112, s[8:11], s43 offen sc1
    s_waitcnt vmcnt(31)
    s_barrier
    s_lshl_b32 s49, s63, 1
    s_add_u32 m0, s49, 149504
    s_add_u32 s48, s62, 122880
    buffer_load_dwordx4 v122, s[8:11], s48 offen sc1 lds
    s_lshl_b32 s49, s63, 1
    s_add_u32 m0, s49, 150528
    s_add_u32 s48, s62, 123904
    buffer_load_dwordx4 v122, s[8:11], s48 offen sc1 lds
    s_add_u32 m0, s63, 55296
    s_add_u32 s48, s23, 1024
    s_mov_b64 exec, s[32:33]
    buffer_load_dwordx4 v121, s[12:15], s48 offen  lds
    s_mov_b64 exec, -1
    s_add_u32 m0, s63, 59392
    s_add_u32 s48, s22, 41984
    buffer_load_dwordx4 v120, s[12:15], s48 offen  lds
    s_add_u32 m0, s63, 63488
    s_add_u32 s48, s22, 82944
    buffer_load_dwordx4 v120, s[12:15], s48 offen  lds
    s_add_u32 m0, s63, 67584
    s_add_u32 s48, s22, 123904
    buffer_load_dwordx4 v120, s[12:15], s48 offen  lds
    s_add_u32 m0, s63, 71680
    s_add_u32 s48, s22, 164864
    buffer_load_dwordx4 v120, s[12:15], s48 offen  lds
    v_perm_b32 v104, v35, v33, s46
    v_perm_b32 v105, v39, v37, s46
    v_perm_b32 v106, v43, v41, s46
    v_perm_b32 v107, v47, v45, s46
    v_perm_b32 v108, v35, v33, s47
    v_perm_b32 v109, v39, v37, s47
    v_perm_b32 v110, v43, v41, s47
    v_perm_b32 v111, v47, v45, s47
    s_add_u32 s43, s42, 83968
    buffer_store_dwordx4 v[104:107], v112, s[8:11], s43 offen sc1
    s_add_u32 s43, s42, 124928
    buffer_store_dwordx4 v[108:111], v112, s[8:11], s43 offen sc1
    s_waitcnt vmcnt(33)
    s_barrier
    s_lshl_b32 s49, s63, 1
    s_add_u32 m0, s49, 92160
    s_add_u32 s48, s62, 131072
    buffer_load_dwordx4 v122, s[8:11], s48 offen sc1 lds
    s_lshl_b32 s49, s63, 1
    s_add_u32 m0, s49, 93184
    s_add_u32 s48, s62, 132096
    buffer_load_dwordx4 v122, s[8:11], s48 offen sc1 lds
    v_dot2c_f32_bf16 v8, s50, v80
    v_dot2c_f32_bf16 v9, s50, v84
    v_dot2c_f32_bf16 v10, s50, v88
    v_dot2c_f32_bf16 v11, s50, v92
    v_dot2c_f32_bf16 v8, s50, v81
    v_dot2c_f32_bf16 v9, s50, v85
    v_dot2c_f32_bf16 v10, s50, v89
    v_dot2c_f32_bf16 v11, s50, v93
    v_dot2c_f32_bf16 v8, s50, v82
    v_dot2c_f32_bf16 v9, s50, v86
    v_dot2c_f32_bf16 v10, s50, v90
    v_dot2c_f32_bf16 v11, s50, v94
    v_dot2c_f32_bf16 v8, s50, v83
    v_dot2c_f32_bf16 v9, s50, v87
    v_dot2c_f32_bf16 v10, s50, v91
    v_dot2c_f32_bf16 v11, s50, v95
    v_dot2c_f32_bf16 v8, s50, v96
    v_dot2c_f32_bf16 v9, s50, v100
    v_dot2c_f32_bf16 v10, s50, v104
    v_dot2c_f32_bf16 v11, s50, v108
    v_dot2c_f32_bf16 v8, s50, v97
    v_dot2c_f32_bf16 v9, s50, v101
    v_dot2c_f32_bf16 v10, s50, v105
    v_dot2c_f32_bf16 v11, s50, v109
    v_dot2c_f32_bf16 v8, s50, v98
    v_dot2c_f32_bf16 v9, s50, v102
    v_dot2c_f32_bf16 v10, s50, v106
    v_dot2c_f32_bf16 v11, s50, v110
    v_dot2c_f32_bf16 v8, s50, v99
    v_dot2c_f32_bf16 v9, s50, v103
    v_dot2c_f32_bf16 v10, s50, v107
    v_dot2c_f32_bf16 v11, s50, v111
    s_waitcnt vmcnt(33)
    s_barrier
    s_lshl_b32 s49, s63, 1
    s_add_u32 m0, s49, 100352
    s_add_u32 s48, s62, 139264
    buffer_load_dwordx4 v122, s[8:11], s48 offen sc1 lds
    s_lshl_b32 s49, s63, 1
    s_add_u32 m0, s49, 101376
    s_add_u32 s48, s62, 140288
    buffer_load_dwordx4 v122, s[8:11], s48 offen sc1 lds
    s_add_u32 m0, s63, 73728
    s_add_u32 s48, s23, 1152
    s_mov_b64 exec, s[32:33]
    buffer_load_dwordx4 v121, s[12:15], s48 offen  lds
    s_mov_b64 exec, -1
    s_add_u32 m0, s63, 77824
    s_add_u32 s48, s22, 42112
    buffer_load_dwordx4 v120, s[12:15], s48 offen  lds
    s_add_u32 m0, s63, 81920
    s_add_u32 s48, s22, 83072
    buffer_load_dwordx4 v120, s[12:15], s48 offen  lds
    s_add_u32 m0, s63, 86016
    s_add_u32 s48, s22, 124032
    buffer_load_dwordx4 v120, s[12:15], s48 offen  lds
    s_add_u32 m0, s63, 90112
    s_add_u32 s48, s22, 164992
    buffer_load_dwordx4 v120, s[12:15], s48 offen  lds
    s_nop 2
    v_mov_b32 v12, v8
    s_nop 1
    v_permlane16_swap_b32 v12, v8
    s_nop 1
    v_add_f32 v8, v8, v12
    v_mov_b32 v12, v8
    s_nop 1
    v_permlane32_swap_b32 v12, v8
    s_nop 1
    v_add_f32 v8, v8, v12
    v_mov_b32 v12, v9
    s_nop 1
    v_permlane16_swap_b32 v12, v9
    s_nop 1
    v_add_f32 v9, v9, v12
    v_mov_b32 v12, v9
    s_nop 1
    v_permlane32_swap_b32 v12, v9
    s_nop 1
    v_add_f32 v9, v9, v12
    s_waitcnt vmcnt(33)
    s_barrier
    s_lshl_b32 s49, s63, 1
    s_add_u32 m0, s49, 108544
    s_add_u32 s48, s62, 147456
    buffer_load_dwordx4 v122, s[8:11], s48 offen sc1 lds
    s_lshl_b32 s49, s63, 1
    s_add_u32 m0, s49, 109568
    s_add_u32 s48, s62, 148480
    buffer_load_dwordx4 v122, s[8:11], s48 offen sc1 lds
    s_nop 2
    v_mov_b32 v12, v10
    s_nop 1
    v_permlane16_swap_b32 v12, v10
    s_nop 1
    v_add_f32 v10, v10, v12
    v_mov_b32 v12, v10
    s_nop 1
    v_permlane32_swap_b32 v12, v10
    s_nop 1
    v_add_f32 v10, v10, v12
    v_mov_b32 v12, v11
    s_nop 1
    v_permlane16_swap_b32 v12, v11
    s_nop 1
    v_add_f32 v11, v11, v12
    v_mov_b32 v12, v11
    s_nop 1
    v_permlane32_swap_b32 v12, v11
    s_nop 1
    v_add_f32 v11, v11, v12
    s_waitcnt vmcnt(31)
    s_barrier
    s_lshl_b32 s49, s63, 1
    s_add_u32 m0, s49, 116736
    s_add_u32 s48, s62, 155648
    buffer_load_dwordx4 v122, s[8:11], s48 offen sc1 lds
    s_lshl_b32 s49, s63, 1
    s_add_u32 m0, s49, 117760
    s_add_u32 s48, s62, 156672
    buffer_load_dwordx4 v122, s[8:11], s48 offen sc1 lds
    s_mul_i32 s43, s26, 108
    s_lshl_b32 s41, s25, 2
    s_add_u32 s43, s43, s41
    s_lshl_b32 s43, s43, 7
    s_lshl_b32 s41, s24, 6
    s_add_u32 s43, s43, s41
    s_add_u32 s43, s43, 20971520
    s_cmp_ge_u32 s61, 540
    s_cselect_b32 s43, 0, s43
    s_mov_b64 exec, 0xffff
    buffer_store_dword v8, v113, s[8:11], s43 offen offset:0 sc1
    buffer_store_dword v9, v113, s[8:11], s43 offen offset:128 sc1
    buffer_store_dword v10, v113, s[8:11], s43 offen offset:256 sc1
    buffer_store_dword v11, v113, s[8:11], s43 offen offset:384 sc1
    s_mov_b64 exec, -1
    v_and_b32 v4, 31, v1
    s_lshl_b32 s36, s56, 5
    v_add_u32 v5, s36, v4
    v_and_b32 v6, 3, v1
    s_sub_u32 s37, s36, 4
    s_cmp_eq_u32 s56, 0
    s_cselect_b32 s37, 0, s37
    v_add_u32 v6, s37, v6
    v_cmp_gt_u32 vcc, 32, v1
    s_nop 1
    v_cndmask_b32 v5, v6, v5, vcc
    v_lshlrev_b32 v5, 3, v5
    v_add_u32 v103, 37752832, v5
    buffer_load_dword v102, v103, s[8:11], 0 offen sc1
    s_waitcnt vmcnt(29)
    s_barrier
    v_lshrrev_b32 v5, 4, v1
    s_lshl_b32 s39, s20, 2
    v_add_u32 v5, s39, v5
    v_mul_u32_u24 v6, 52, v5
    v_lshrrev_b32 v6, 8, v6
    v_mul_u32_u24 v7, 5, v6
    v_sub_u32 v7, v5, v7
    v_mul_u32_u24 v6, 0x10e, v6
    v_add_u32 v6, v6, v7
    v_lshlrev_b32 v6, 10, v6
    v_and_b32 v7, 15, v1
    v_lshl_add_u32 v6, v7, 4, v6
    s_mul_i32 s39, s21, 5120
    s_add_u32 s39, s39, 16777216
    v_mov_b32 v7, 0x80000000
    s_cmp_ge_u32 s61, 540
    s_cselect_b64 vcc, -1, 0
    s_cselect_b32 s39, 0, s39
    s_nop 0
    v_cndmask_b32 v114, v6, v7, vcc
    s_mov_b32 s19, s39
    v_lshl_or_b32 v80, v49, 16, v48
    v_lshl_or_b32 v81, v51, 16, v50
    v_lshl_or_b32 v82, v53, 16, v52
    v_lshl_or_b32 v83, v55, 16, v54
    buffer_store_dwordx4 v[80:83], v114, s[8:11], s19 offen offset:0 sc1
    v_lshl_or_b32 v84, v57, 16, v56
    v_lshl_or_b32 v85, v59, 16, v58
    v_lshl_or_b32 v86, v61, 16, v60
    v_lshl_or_b32 v87, v63, 16, v62
    buffer_store_dwordx4 v[84:87], v114, s[8:11], s19 offen offset:256 sc1
    s_waitcnt vmcnt(27)
    s_barrier
    v_lshl_or_b32 v88, v65, 16, v64
    v_lshl_or_b32 v89, v67, 16, v66
    v_lshl_or_b32 v90, v69, 16, v68
    v_lshl_or_b32 v91, v71, 16, v70
    buffer_store_dwordx4 v[88:91], v114, s[8:11], s19 offen offset:512 sc1
    v_lshl_or_b32 v92, v73, 16, v72
    v_lshl_or_b32 v93, v75, 16, v74
    v_lshl_or_b32 v94, v77, 16, v76
    v_lshl_or_b32 v95, v79, 16, v78
    buffer_store_dwordx4 v[92:95], v114, s[8:11], s19 offen offset:768 sc1
    s_waitcnt vmcnt(20)
    s_barrier
    s_waitcnt vmcnt(4)
    v_cmp_ne_u32 vcc, s60, v102
    s_nop 1
    s_cbranch_vccz sequential_preLN__sliding_local_dilated__glu_gated_bilinear__prompt_kernel_sfok11
    s_mov_b32 s51, 0
sequential_preLN__sliding_local_dilated__glu_gated_bilinear__prompt_kernel_poll12:
    buffer_load_dword v3, v103, s[8:11], 0 offen sc1
    s_add_u32 s51, s51, 1
    s_cmp_gt_u32 s51, 200000
    s_cbranch_scc1 sequential_preLN__sliding_local_dilated__glu_gated_bilinear__prompt_kernel_pollx13
    s_waitcnt vmcnt(0)
    v_cmp_ne_u32 vcc, s60, v3
    s_nop 1
    s_cbranch_vccz sequential_preLN__sliding_local_dilated__glu_gated_bilinear__prompt_kernel_pollx13
    s_sleep 2
    s_branch sequential_preLN__sliding_local_dilated__glu_gated_bilinear__prompt_kernel_poll12
sequential_preLN__sliding_local_dilated__glu_gated_bilinear__prompt_kernel_pollx13:
    s_waitcnt vmcnt(0)
sequential_preLN__sliding_local_dilated__glu_gated_bilinear__prompt_kernel_sfok11:
    s_lshl_b32 s36, s56, 7
    s_sub_u32 s36, s36, 16
    v_add_u32 v4, s36, v1
    v_lshlrev_b32 v5, 3, v4
    v_mov_b32 v6, 0x80000000
    v_cmp_gt_i32 vcc, 0, v4
    s_nop 1
    v_cndmask_b32 v5, v5, v6, vcc
    s_mov_b32 s36, 0
    buffer_load_dwordx2 v[96:97], v5, s[8:11], s36 offen sc1
    v_add_u32 v4, 64, v4
    v_lshlrev_b32 v5, 3, v4
    buffer_load_dwordx2 v[98:99], v5, s[8:11], s36 offen sc1
    buffer_load_dwordx2 v[100:101], v5, s[8:11], s36 offen offset:512 sc1
    s_barrier
    s_barrier
    s_barrier
    s_waitcnt vmcnt(3)
    s_lshl_b32 s36, s61, 3
    s_add_u32 s36, s36, 38141952
    s_cmp_ge_u32 s61, 540
    s_cselect_b32 s38, 0x80000000, 0
    s_cselect_b32 s36, 0, s36
    v_mov_b32 v13, s38
    v_mov_b32 v3, s60
    s_mov_b64 exec, 1
    buffer_atomic_swap v3, v13, s[8:11], s36 offen sc1
    s_mov_b64 exec, -1
    s_lshl_b32 s36, s61, 3
    s_add_u32 s36, s36, 38207488
    s_cmp_ge_u32 s61, 540
    s_cselect_b32 s38, 0x80000000, 0
    s_cselect_b32 s36, 0, s36
    v_mov_b32 v13, s38
    v_mov_b32 v3, s60
    s_mov_b64 exec, 1
    buffer_atomic_swap v3, v13, s[8:11], s36 offen sc1
    s_mov_b64 exec, -1
    s_waitcnt vmcnt(2)
    s_cmp_lg_u32 s3, 4
    s_cbranch_scc1 sequential_preLN__sliding_local_dilated__glu_gated_bilinear__prompt_kernel_sts14
    v_lshlrev_b32 v5, 3, v1
    v_add_u32 v5, 157696, v5
    ds_write_b64 v5, v[96:97]
    ds_write_b64 v5, v[98:99] offset:512
    s_mov_b64 exec, 0xffff
    ds_write_b64 v5, v[100:101] offset:1024
    s_mov_b64 exec, -1
sequential_preLN__sliding_local_dilated__glu_gated_bilinear__prompt_kernel_sts14:
    s_barrier
    s_waitcnt vmcnt(0)
    s_waitcnt vmcnt(0) lgkmcnt(0)
    s_branch P_p1ld_done
P_p1ld_b:
    s_barrier
    s_cmp_ge_u32 s3, 6
    s_cbranch_scc1 Pb_bsW
    s_mov_b32 s4, s16
    s_mov_b32 s5, s17
    s_mov_b32 s6, 2621440
    s_mov_b32 s7, 0x00020000
    v_and_b32 v2, 3, v1
    v_lshrrev_b32 v3, 2, v1
    s_lshl_b32 s37, s56, 7
    s_lshl_b32 s38, s57, 3
    s_add_u32 s37, s37, s38
    s_sub_u32 s38, s3, 4
    s_lshl_b32 s38, s38, 2
    s_add_u32 s37, s37, s38
    v_add_u32 v13, s37, v2
    s_movk_i32 s38, 1280
    v_mul_lo_u32 v5, v13, s38
    v_lshl_add_u32 v5, v3, 4, v5
    buffer_load_dwordx4 v[48:51], v5, s[4:7], 0 offen offset:0
    buffer_load_dwordx4 v[52:55], v5, s[4:7], 0 offen offset:256
    buffer_load_dwordx4 v[56:59], v5, s[4:7], 0 offen offset:512
    buffer_load_dwordx4 v[60:63], v5, s[4:7], 0 offen offset:768
    buffer_load_dwordx4 v[64:67], v5, s[4:7], 0 offen offset:1024
    v_mov_b32 v10, 0
    v_mov_b32 v11, 0
    s_waitcnt vmcnt(0)
    v_lshlrev_b32 v68, 16, v48
    v_and_b32 v69, 0xffff0000, v48
    v_lshlrev_b32 v70, 16, v49
    v_and_b32 v71, 0xffff0000, v49
    v_lshlrev_b32 v72, 16, v50
    v_and_b32 v73, 0xffff0000, v50
    v_lshlrev_b32 v74, 16, v51
    v_and_b32 v75, 0xffff0000, v51
    v_lshlrev_b32 v76, 16, v52
    v_and_b32 v77, 0xffff0000, v52
    v_lshlrev_b32 v78, 16, v53
    v_and_b32 v79, 0xffff0000, v53
    v_lshlrev_b32 v80, 16, v54
    v_and_b32 v81, 0xffff0000, v54
    v_lshlrev_b32 v82, 16, v55
    v_and_b32 v83, 0xffff0000, v55
    v_lshlrev_b32 v84, 16, v56
    v_and_b32 v85, 0xffff0000, v56
    v_lshlrev_b32 v86, 16, v57
    v_and_b32 v87, 0xffff0000, v57
    v_lshlrev_b32 v88, 16, v58
    v_and_b32 v89, 0xffff0000, v58
    v_lshlrev_b32 v90, 16, v59
    v_and_b32 v91, 0xffff0000, v59
    v_lshlrev_b32 v92, 16, v60
    v_and_b32 v93, 0xffff0000, v60
    v_lshlrev_b32 v94, 16, v61
    v_and_b32 v95, 0xffff0000, v61
    v_lshlrev_b32 v96, 16, v62
    v_and_b32 v97, 0xffff0000, v62
    v_lshlrev_b32 v98, 16, v63
    v_and_b32 v99, 0xffff0000, v63
    v_lshlrev_b32 v100, 16, v64
    v_and_b32 v101, 0xffff0000, v64
    v_lshlrev_b32 v102, 16, v65
    v_and_b32 v103, 0xffff0000, v65
    v_lshlrev_b32 v104, 16, v66
    v_and_b32 v105, 0xffff0000, v66
    v_lshlrev_b32 v106, 16, v67
    v_and_b32 v107, 0xffff0000, v67
    v_pk_add_f32 v[10:11], v[10:11], v[68:69]
    v_pk_add_f32 v[10:11], v[10:11], v[70:71]
    v_pk_add_f32 v[10:11], v[10:11], v[72:73]
    v_pk_add_f32 v[10:11], v[10:11], v[74:75]
    v_pk_add_f32 v[10:11], v[10:11], v[76:77]
    v_pk_add_f32 v[10:11], v[10:11], v[78:79]
    v_pk_add_f32 v[10:11], v[10:11], v[80:81]
    v_pk_add_f32 v[10:11], v[10:11], v[82:83]
    v_pk_add_f32 v[10:11], v[10:11], v[84:85]
    v_pk_add_f32 v[10:11], v[10:11], v[86:87]
    v_pk_add_f32 v[10:11], v[10:11], v[88:89]
    v_pk_add_f32 v[10:11], v[10:11], v[90:91]
    v_pk_add_f32 v[10:11], v[10:11], v[92:93]
    v_pk_add_f32 v[10:11], v[10:11], v[94:95]
    v_pk_add_f32 v[10:11], v[10:11], v[96:97]
    v_pk_add_f32 v[10:11], v[10:11], v[98:99]
    v_pk_add_f32 v[10:11], v[10:11], v[100:101]
    v_pk_add_f32 v[10:11], v[10:11], v[102:103]
    v_pk_add_f32 v[10:11], v[10:11], v[104:105]
    v_pk_add_f32 v[10:11], v[10:11], v[106:107]
    v_add_f32 v10, v10, v11
    s_nop 1
    v_add_f32_dpp v10, v10, v10 row_ror:4 row_mask:0xf bank_mask:0xf
    s_nop 1
    v_add_f32_dpp v10, v10, v10 row_ror:8 row_mask:0xf bank_mask:0xf
    v_mov_b32 v12, v10
    s_nop 1
    v_permlane16_swap_b32 v12, v10
    s_nop 1
    v_add_f32 v10, v10, v12
    v_mov_b32 v12, v10
    s_nop 1
    v_permlane32_swap_b32 v12, v10
    s_nop 1
    v_add_f32 v10, v10, v12
    v_mul_f32 v10, -0.0015625, v10
    v_mov_b32 v14, 0
    v_mov_b32 v15, 0
    v_pk_add_f32 v[68:69], v[68:69], v[10:11] op_sel_hi:[1,0]
    v_pk_add_f32 v[70:71], v[70:71], v[10:11] op_sel_hi:[1,0]
    v_pk_add_f32 v[72:73], v[72:73], v[10:11] op_sel_hi:[1,0]
    v_pk_add_f32 v[74:75], v[74:75], v[10:11] op_sel_hi:[1,0]
    v_pk_add_f32 v[76:77], v[76:77], v[10:11] op_sel_hi:[1,0]
    v_pk_add_f32 v[78:79], v[78:79], v[10:11] op_sel_hi:[1,0]
    v_pk_add_f32 v[80:81], v[80:81], v[10:11] op_sel_hi:[1,0]
    v_pk_add_f32 v[82:83], v[82:83], v[10:11] op_sel_hi:[1,0]
    v_pk_add_f32 v[84:85], v[84:85], v[10:11] op_sel_hi:[1,0]
    v_pk_add_f32 v[86:87], v[86:87], v[10:11] op_sel_hi:[1,0]
    v_pk_add_f32 v[88:89], v[88:89], v[10:11] op_sel_hi:[1,0]
    v_pk_add_f32 v[90:91], v[90:91], v[10:11] op_sel_hi:[1,0]
    v_pk_add_f32 v[92:93], v[92:93], v[10:11] op_sel_hi:[1,0]
    v_pk_add_f32 v[94:95], v[94:95], v[10:11] op_sel_hi:[1,0]
    v_pk_add_f32 v[96:97], v[96:97], v[10:11] op_sel_hi:[1,0]
    v_pk_add_f32 v[98:99], v[98:99], v[10:11] op_sel_hi:[1,0]
    v_pk_add_f32 v[100:101], v[100:101], v[10:11] op_sel_hi:[1,0]
    v_pk_add_f32 v[102:103], v[102:103], v[10:11] op_sel_hi:[1,0]
    v_pk_add_f32 v[104:105], v[104:105], v[10:11] op_sel_hi:[1,0]
    v_pk_add_f32 v[106:107], v[106:107], v[10:11] op_sel_hi:[1,0]
    v_pk_fma_f32 v[14:15], v[68:69], v[68:69], v[14:15]
    v_pk_fma_f32 v[14:15], v[70:71], v[70:71], v[14:15]
    v_pk_fma_f32 v[14:15], v[72:73], v[72:73], v[14:15]
    v_pk_fma_f32 v[14:15], v[74:75], v[74:75], v[14:15]
    v_pk_fma_f32 v[14:15], v[76:77], v[76:77], v[14:15]
    v_pk_fma_f32 v[14:15], v[78:79], v[78:79], v[14:15]
    v_pk_fma_f32 v[14:15], v[80:81], v[80:81], v[14:15]
    v_pk_fma_f32 v[14:15], v[82:83], v[82:83], v[14:15]
    v_pk_fma_f32 v[14:15], v[84:85], v[84:85], v[14:15]
    v_pk_fma_f32 v[14:15], v[86:87], v[86:87], v[14:15]
    v_pk_fma_f32 v[14:15], v[88:89], v[88:89], v[14:15]
    v_pk_fma_f32 v[14:15], v[90:91], v[90:91], v[14:15]
    v_pk_fma_f32 v[14:15], v[92:93], v[92:93], v[14:15]
    v_pk_fma_f32 v[14:15], v[94:95], v[94:95], v[14:15]
    v_pk_fma_f32 v[14:15], v[96:97], v[96:97], v[14:15]
    v_pk_fma_f32 v[14:15], v[98:99], v[98:99], v[14:15]
    v_pk_fma_f32 v[14:15], v[100:101], v[100:101], v[14:15]
    v_pk_fma_f32 v[14:15], v[102:103], v[102:103], v[14:15]
    v_pk_fma_f32 v[14:15], v[104:105], v[104:105], v[14:15]
    v_pk_fma_f32 v[14:15], v[106:107], v[106:107], v[14:15]
    v_add_f32 v14, v14, v15
    s_nop 1
    v_add_f32_dpp v14, v14, v14 row_ror:4 row_mask:0xf bank_mask:0xf
    s_nop 1
    v_add_f32_dpp v14, v14, v14 row_ror:8 row_mask:0xf bank_mask:0xf
    v_mov_b32 v12, v14
    s_nop 1
    v_permlane16_swap_b32 v12, v14
    s_nop 1
    v_add_f32 v14, v14, v12
    v_mov_b32 v12, v14
    s_nop 1
    v_permlane32_swap_b32 v12, v14
    s_nop 1
    v_add_f32 v14, v14, v12
    v_mul_f32 v14, 0.0015625, v14
    v_add_f32 v14, 1e-5, v14
    v_rsq_f32 v11, v14
    s_nop 0
    v_mul_f32 v10, v10, v11
    v_lshlrev_b32 v6, 3, v13
    s_mov_b32 s38, 0
    s_mov_b64 exec, 15
    buffer_store_dwordx2 v[10:11], v6, s[8:11], s38 offen sc1
    s_mov_b64 exec, -1
    s_lshl_b32 s40, s56, 4
    s_add_u32 s40, s40, s57
    s_lshl_b32 s40, s40, 1
    s_add_u32 s40, s40, s3
    s_sub_u32 s40, s40, 4
    s_lshl_b32 s18, s40, 3
    s_add_u32 s18, s18, 37752832
    s_branch Pb_bsD
Pb_bsW:
    s_mov_b32 s18, 0
    s_cmp_ge_u32 s2, 200
    s_cbranch_scc1 Pb_bsD
    s_mov_b32 s4, s20
    s_mov_b32 s5, s21
    s_mov_b32 s6, 819200
    s_mov_b32 s7, 0x00020000
    s_mov_b32 s38, 214748365
    s_mul_hi_u32 s37, s2, s38
    s_mul_i32 s38, s37, 20
    s_sub_u32 s38, s2, s38
    s_lshl_b32 s39, s37, 7
    v_lshl_add_u32 v5, v1, 1, s39
    s_mul_i32 s36, s38, 40960
    s_sub_u32 s40, s3, 6
    s_mul_i32 s39, s40, 20480
    s_add_u32 s36, s36, s39
    s_add_u32 s54, s36, 0
    buffer_load_ushort v16, v5, s[4:7], s54 offen nt
    s_add_u32 s54, s36, 1280
    buffer_load_ushort v17, v5, s[4:7], s54 offen nt
    s_add_u32 s54, s36, 2560
    buffer_load_ushort v18, v5, s[4:7], s54 offen nt
    s_add_u32 s54, s36, 3840
    buffer_load_ushort v19, v5, s[4:7], s54 offen nt
    s_add_u32 s54, s36, 5120
    buffer_load_ushort v20, v5, s[4:7], s54 offen nt
    s_add_u32 s54, s36, 6400
    buffer_load_ushort v21, v5, s[4:7], s54 offen nt
    s_add_u32 s54, s36, 7680
    buffer_load_ushort v22, v5, s[4:7], s54 offen nt
    s_add_u32 s54, s36, 8960
    buffer_load_ushort v23, v5, s[4:7], s54 offen nt
    s_add_u32 s54, s36, 10240
    buffer_load_ushort v24, v5, s[4:7], s54 offen nt
    s_add_u32 s54, s36, 11520
    buffer_load_ushort v25, v5, s[4:7], s54 offen nt
    s_add_u32 s54, s36, 12800
    buffer_load_ushort v26, v5, s[4:7], s54 offen nt
    s_add_u32 s54, s36, 14080
    buffer_load_ushort v27, v5, s[4:7], s54 offen nt
    s_add_u32 s54, s36, 15360
    buffer_load_ushort v28, v5, s[4:7], s54 offen nt
    s_add_u32 s54, s36, 16640
    buffer_load_ushort v29, v5, s[4:7], s54 offen nt
    s_add_u32 s54, s36, 17920
    buffer_load_ushort v30, v5, s[4:7], s54 offen nt
    s_add_u32 s54, s36, 19200
    buffer_load_ushort v31, v5, s[4:7], s54 offen nt
    v_lshrrev_b32 v5, 4, v1
    s_lshl_b32 s39, s37, 2
    v_add_u32 v5, s39, v5
    v_mul_u32_u24 v6, 52, v5
    v_lshrrev_b32 v6, 8, v6
    v_mul_u32_u24 v7, 5, v6
    v_sub_u32 v7, v5, v7
    v_mul_u32_u24 v6, 100, v6
    v_add_u32 v6, v6, v7
    v_lshlrev_b32 v6, 10, v6
    v_and_b32 v7, 15, v1
    v_lshl_add_u32 v6, v7, 4, v6
    s_mul_i32 s39, s38, 5120
    s_lshl_b32 s38, s40, 9
    s_add_u32 s39, s39, s38
    s_add_u32 s39, s39, 8388608
    s_lshl_b32 s18, s2, 1
    s_add_u32 s18, s18, s40
    s_lshl_b32 s18, s18, 3
    s_add_u32 s18, s18, 38076416
    s_waitcnt vmcnt(0)
    v_lshl_or_b32 v80, v17, 16, v16
    v_lshl_or_b32 v81, v19, 16, v18
    v_lshl_or_b32 v82, v21, 16, v20
    v_lshl_or_b32 v83, v23, 16, v22
    buffer_store_dwordx4 v[80:83], v6, s[8:11], s39 offen offset:0 sc1
    v_lshl_or_b32 v84, v25, 16, v24
    v_lshl_or_b32 v85, v27, 16, v26
    v_lshl_or_b32 v86, v29, 16, v28
    v_lshl_or_b32 v87, v31, 16, v30
    buffer_store_dwordx4 v[84:87], v6, s[8:11], s39 offen offset:256 sc1
Pb_bsD:
    s_add_u32 m0, s63, 0
    s_add_u32 s48, s23, 0
    s_mov_b64 exec, s[32:33]
    buffer_load_dwordx4 v121, s[12:15], s48 offen  lds
    s_mov_b64 exec, -1
    s_add_u32 m0, s63, 4096
    s_add_u32 s48, s22, 40960
    buffer_load_dwordx4 v120, s[12:15], s48 offen  lds
    s_add_u32 m0, s63, 8192
    s_add_u32 s48, s22, 81920
    buffer_load_dwordx4 v120, s[12:15], s48 offen  lds
    s_add_u32 m0, s63, 12288
    s_add_u32 s48, s22, 122880
    buffer_load_dwordx4 v120, s[12:15], s48 offen  lds
    s_add_u32 m0, s63, 18432
    s_add_u32 s48, s23, 128
    s_mov_b64 exec, s[32:33]
    buffer_load_dwordx4 v121, s[12:15], s48 offen  lds
    s_mov_b64 exec, -1
    s_add_u32 m0, s63, 22528
    s_add_u32 s48, s22, 41088
    buffer_load_dwordx4 v120, s[12:15], s48 offen  lds
    s_add_u32 m0, s63, 26624
    s_add_u32 s48, s22, 82048
    buffer_load_dwordx4 v120, s[12:15], s48 offen  lds
    s_add_u32 m0, s63, 30720
    s_add_u32 s48, s22, 123008
    buffer_load_dwordx4 v120, s[12:15], s48 offen  lds
    s_add_u32 m0, s63, 36864
    s_add_u32 s48, s23, 256
    s_mov_b64 exec, s[32:33]
    buffer_load_dwordx4 v121, s[12:15], s48 offen  lds
    s_mov_b64 exec, -1
    s_add_u32 m0, s63, 40960
    s_add_u32 s48, s22, 41216
    buffer_load_dwordx4 v120, s[12:15], s48 offen  lds
    s_add_u32 m0, s63, 45056
    s_add_u32 s48, s22, 82176
    buffer_load_dwordx4 v120, s[12:15], s48 offen  lds
    s_add_u32 m0, s63, 49152
    s_add_u32 s48, s22, 123136
    buffer_load_dwordx4 v120, s[12:15], s48 offen  lds
    s_sub_u32 s61, s3, 4
    s_lshl_b32 s61, s61, 8
    s_add_u32 s61, s61, s2
    s_sub_u32 s36, s2, 200
    s_add_u32 s37, s36, 512
    s_cmp_lt_u32 s36, 28
    s_cselect_b32 s61, s37, 1000
    s_cmp_eq_u32 s3, 6
    s_cselect_b32 s61, s61, 1000
    s_mov_b32 s50, s61
    s_mov_b32 s36, s61
    s_mov_b32 s38, 15907287
    s_mul_hi_u32 s37, s36, s38
    s_mul_i32 s38, s37, 270
    s_sub_u32 s38, s36, s38
    s_mov_b32 s39, 429496730
    s_mul_hi_u32 s39, s38, s39
    s_mul_i32 s40, s39, 10
    s_sub_u32 s40, s38, s40
    s_cmp_eq_u32 s37, 0
    s_cselect_b32 s4, s24, s26
    s_cselect_b32 s5, s25, s27
    s_mov_b32 s6, 2211840
    s_mov_b32 s7, 0x00020000
    v_and_b32 v2, 15, v1
    v_lshrrev_b32 v3, 4, v1
    s_lshl_b32 s41, s40, 6
    v_lshl_add_u32 v4, v3, 3, s41
    s_movk_i32 s41, 3456
    v_mul_lo_u32 v4, v4, s41
    s_lshl_b32 s41, s39, 7
    v_add_u32 v4, s41, v4
    v_lshl_add_u32 v4, v2, 3, v4
    v_mov_b32 v5, 0x80000000
    s_cmp_ge_u32 s36, 540
    s_cselect_b64 vcc, -1, 0
    s_mov_b32 s44, s37
    s_mov_b32 s46, s39
    s_mov_b32 s47, s40
    v_cndmask_b32 v4, v4, v5, vcc
    s_mov_b32 s41, 0
    buffer_load_dwordx2 v[16:17], v4, s[4:7], s41 offen nt
    s_mov_b32 s41, 3456
    buffer_load_dwordx2 v[18:19], v4, s[4:7], s41 offen nt
    s_mov_b32 s41, 6912
    buffer_load_dwordx2 v[20:21], v4, s[4:7], s41 offen nt
    s_mov_b32 s41, 10368
    buffer_load_dwordx2 v[22:23], v4, s[4:7], s41 offen nt
    s_mov_b32 s41, 13824
    buffer_load_dwordx2 v[24:25], v4, s[4:7], s41 offen nt
    s_mov_b32 s41, 17280
    buffer_load_dwordx2 v[26:27], v4, s[4:7], s41 offen nt
    s_mov_b32 s41, 20736
    buffer_load_dwordx2 v[28:29], v4, s[4:7], s41 offen nt
    s_mov_b32 s41, 24192
    buffer_load_dwordx2 v[30:31], v4, s[4:7], s41 offen nt
    s_mov_b32 s41, 110592
    buffer_load_dwordx2 v[32:33], v4, s[4:7], s41 offen nt
    s_mov_b32 s41, 114048
    buffer_load_dwordx2 v[34:35], v4, s[4:7], s41 offen nt
    s_mov_b32 s41, 117504
    buffer_load_dwordx2 v[36:37], v4, s[4:7], s41 offen nt
    s_mov_b32 s41, 120960
    buffer_load_dwordx2 v[38:39], v4, s[4:7], s41 offen nt
    s_mov_b32 s41, 124416
    buffer_load_dwordx2 v[40:41], v4, s[4:7], s41 offen nt
    s_mov_b32 s41, 127872
    buffer_load_dwordx2 v[42:43], v4, s[4:7], s41 offen nt
    s_mov_b32 s41, 131328
    buffer_load_dwordx2 v[44:45], v4, s[4:7], s41 offen nt
    s_mov_b32 s41, 134784
    buffer_load_dwordx2 v[46:47], v4, s[4:7], s41 offen nt
    s_mov_b32 s24, s44
    s_mov_b32 s25, s46
    s_mov_b32 s26, s47
    s_mov_b32 s36, s50
    s_mov_b32 s4, s28
    s_mov_b32 s5, s29
    s_mov_b32 s6, 2211840
    s_mov_b32 s7, 0x00020000
    s_mov_b32 s38, 79536432
    s_mul_hi_u32 s37, s36, s38
    s_mul_i32 s38, s37, 54
    s_sub_u32 s38, s36, s38
    s_mov_b32 s20, s37
    s_mov_b32 s21, s38
    s_lshl_b32 s39, s37, 7
    v_lshl_add_u32 v4, v1, 1, s39
    v_mov_b32 v5, 0x80000000
    s_cmp_ge_u32 s36, 540
    s_cselect_b64 vcc, -1, 0
    s_cselect_b32 s38, 0, s38
    s_nop 0
    v_cndmask_b32 v4, v4, v5, vcc
    s_lshr_b32 s39, s38, 1
    s_and_b32 s40, s38, 1
    s_lshl_b32 s40, s40, 1
    s_add_u32 s40, s40, 0
    s_sub_u32 s41, s38, 32
    s_cmp_ge_u32 s38, 32
    s_cselect_b32 s39, s41, s39
    s_cselect_b32 s40, 4, s40
    s_sub_u32 s41, s38, 44
    s_lshl_b32 s41, s41, 1
    s_add_u32 s41, s41, 12
    s_cmp_ge_u32 s38, 44
    s_cselect_b32 s39, s41, s39
    s_cselect_b32 s40, 4, s40
    s_sub_u32 s41, s38, 46
    s_lshl_b32 s41, s41, 1
    s_add_u32 s41, s41, 0
    s_cmp_ge_u32 s38, 46
    s_cselect_b32 s39, s41, s39
    s_cselect_b32 s41, 1, 0
    s_cmp_lt_u32 s39, 12
    s_cselect_b32 s36, 6, 5
    s_cmp_eq_u32 s41, 1
    s_cselect_b32 s40, s36, s40
    s_mul_i32 s36, s39, 7
    s_sub_u32 s41, s39, 12
    s_cmp_gt_u32 s39, 12
    s_cselect_b32 s41, s41, 0
    s_sub_u32 s36, s36, s41
    s_add_u32 s36, s36, s40
    s_lshr_b32 s41, s36, 2
    s_lshl_b32 s41, s41, 6
    s_and_b32 s36, s36, 3
    s_add_u32 s36, s36, s41
    s_mul_i32 s40, s36, 1280
    s_add_u32 s41, s40, 0
    buffer_load_ushort v48, v4, s[4:7], s41 offen nt
    s_add_u32 s41, s40, 5120
    buffer_load_ushort v49, v4, s[4:7], s41 offen nt
    s_add_u32 s41, s40, 10240
    buffer_load_ushort v50, v4, s[4:7], s41 offen nt
    s_add_u32 s41, s40, 15360
    buffer_load_ushort v51, v4, s[4:7], s41 offen nt
    s_add_u32 s41, s40, 40960
    buffer_load_ushort v52, v4, s[4:7], s41 offen nt
    s_add_u32 s41, s40, 46080
    buffer_load_ushort v53, v4, s[4:7], s41 offen nt
    s_add_u32 s41, s40, 51200
    buffer_load_ushort v54, v4, s[4:7], s41 offen nt
    s_add_u32 s41, s40, 56320
    buffer_load_ushort v55, v4, s[4:7], s41 offen nt
    s_add_u32 s41, s40, 20480
    buffer_load_ushort v56, v4, s[4:7], s41 offen nt
    s_add_u32 s41, s40, 25600
    buffer_load_ushort v57, v4, s[4:7], s41 offen nt
    s_add_u32 s41, s40, 30720
    buffer_load_ushort v58, v4, s[4:7], s41 offen nt
    s_add_u32 s41, s40, 35840
    buffer_load_ushort v59, v4, s[4:7], s41 offen nt
    s_add_u32 s41, s40, 61440
    buffer_load_ushort v60, v4, s[4:7], s41 offen nt
    s_add_u32 s41, s40, 66560
    buffer_load_ushort v61, v4, s[4:7], s41 offen nt
    s_add_u32 s41, s40, 71680
    buffer_load_ushort v62, v4, s[4:7], s41 offen nt
    s_add_u32 s41, s40, 76800
    buffer_load_ushort v63, v4, s[4:7], s41 offen nt
    s_lshr_b32 s39, s38, 1
    s_and_b32 s40, s38, 1
    s_lshl_b32 s40, s40, 1
    s_add_u32 s40, s40, 1
    s_sub_u32 s41, s38, 32
    s_cmp_ge_u32 s38, 32
    s_cselect_b32 s39, s41, s39
    s_cselect_b32 s40, 5, s40
    s_sub_u32 s41, s38, 44
    s_lshl_b32 s41, s41, 1
    s_add_u32 s41, s41, 13
    s_cmp_ge_u32 s38, 44
    s_cselect_b32 s39, s41, s39
    s_cselect_b32 s40, 4, s40
    s_sub_u32 s41, s38, 46
    s_lshl_b32 s41, s41, 1
    s_add_u32 s41, s41, 1
    s_cmp_ge_u32 s38, 46
    s_cselect_b32 s39, s41, s39
    s_cselect_b32 s41, 1, 0
    s_cmp_lt_u32 s39, 12
    s_cselect_b32 s36, 6, 5
    s_cmp_eq_u32 s41, 1
    s_cselect_b32 s40, s36, s40
    s_mul_i32 s36, s39, 7
    s_sub_u32 s41, s39, 12
    s_cmp_gt_u32 s39, 12
    s_cselect_b32 s41, s41, 0
    s_sub_u32 s36, s36, s41
    s_add_u32 s36, s36, s40
    s_lshr_b32 s41, s36, 2
    s_lshl_b32 s41, s41, 6
    s_and_b32 s36, s36, 3
    s_add_u32 s36, s36, s41
    s_mul_i32 s40, s36, 1280
    s_add_u32 s41, s40, 0
    buffer_load_ushort v64, v4, s[4:7], s41 offen nt
    s_add_u32 s41, s40, 5120
    buffer_load_ushort v65, v4, s[4:7], s41 offen nt
    s_add_u32 s41, s40, 10240
    buffer_load_ushort v66, v4, s[4:7], s41 offen nt
    s_add_u32 s41, s40, 15360
    buffer_load_ushort v67, v4, s[4:7], s41 offen nt
    s_add_u32 s41, s40, 40960
    buffer_load_ushort v68, v4, s[4:7], s41 offen nt
    s_add_u32 s41, s40, 46080
    buffer_load_ushort v69, v4, s[4:7], s41 offen nt
    s_add_u32 s41, s40, 51200
    buffer_load_ushort v70, v4, s[4:7], s41 offen nt
    s_add_u32 s41, s40, 56320
    buffer_load_ushort v71, v4, s[4:7], s41 offen nt
    s_add_u32 s41, s40, 20480
    buffer_load_ushort v72, v4, s[4:7], s41 offen nt
    s_add_u32 s41, s40, 25600
    buffer_load_ushort v73, v4, s[4:7], s41 offen nt
    s_add_u32 s41, s40, 30720
    buffer_load_ushort v74, v4, s[4:7], s41 offen nt
    s_add_u32 s41, s40, 35840
    buffer_load_ushort v75, v4, s[4:7], s41 offen nt
    s_add_u32 s41, s40, 61440
    buffer_load_ushort v76, v4, s[4:7], s41 offen nt
    s_add_u32 s41, s40, 66560
    buffer_load_ushort v77, v4, s[4:7], s41 offen nt
    s_add_u32 s41, s40, 71680
    buffer_load_ushort v78, v4, s[4:7], s41 offen nt
    s_add_u32 s41, s40, 76800
    buffer_load_ushort v79, v4, s[4:7], s41 offen nt
    s_waitcnt vmcnt(60) lgkmcnt(0)
    s_add_u32 s60, s60, 1
    s_cmp_eq_u32 s18, 0
    s_cselect_b32 s38, 0x80000000, 0
    v_mov_b32 v9, s38
    v_mov_b32 v3, s60
    s_mov_b64 exec, 1
    buffer_atomic_swap v3, v9, s[8:11], s18 offen sc1
    s_mov_b64 exec, -1
    s_lshl_b32 s36, s57, 9
    s_add_u32 s36, s36, 37945344
    v_lshl_add_u32 v5, v1, 3, s36
    s_mov_b32 s51, 0
sequential_preLN__sliding_local_dilated__glu_gated_bilinear__prompt_kernel_poll15:
    buffer_load_dword v3, v5, s[8:11], 0 offen sc1
    s_add_u32 s51, s51, 1
    s_cmp_gt_u32 s51, 200000
    s_cbranch_scc1 sequential_preLN__sliding_local_dilated__glu_gated_bilinear__prompt_kernel_pollx16
    s_waitcnt vmcnt(0)
    v_cmp_ne_u32 vcc, s60, v3
    s_nop 1
    s_cbranch_vccz sequential_preLN__sliding_local_dilated__glu_gated_bilinear__prompt_kernel_pollx16
    s_sleep 2
    s_branch sequential_preLN__sliding_local_dilated__glu_gated_bilinear__prompt_kernel_poll15
sequential_preLN__sliding_local_dilated__glu_gated_bilinear__prompt_kernel_pollx16:
    s_waitcnt vmcnt(0)
    s_lshl_b32 s49, s63, 1
    s_add_u32 m0, s49, 92160
    s_add_u32 s48, s62, 0
    buffer_load_dwordx4 v122, s[8:11], s48 offen sc1 lds
    s_lshl_b32 s49, s63, 1
    s_add_u32 m0, s49, 93184
    s_add_u32 s48, s62, 1024
    buffer_load_dwordx4 v122, s[8:11], s48 offen sc1 lds
    s_lshl_b32 s49, s63, 1
    s_add_u32 m0, s49, 100352
    s_add_u32 s48, s62, 8192
    buffer_load_dwordx4 v122, s[8:11], s48 offen sc1 lds
    s_lshl_b32 s49, s63, 1
    s_add_u32 m0, s49, 101376
    s_add_u32 s48, s62, 9216
    buffer_load_dwordx4 v122, s[8:11], s48 offen sc1 lds
    s_lshl_b32 s49, s63, 1
    s_add_u32 m0, s49, 108544
    s_add_u32 s48, s62, 16384
    buffer_load_dwordx4 v122, s[8:11], s48 offen sc1 lds
    s_lshl_b32 s49, s63, 1
    s_add_u32 m0, s49, 109568
    s_add_u32 s48, s62, 17408
    buffer_load_dwordx4 v122, s[8:11], s48 offen sc1 lds
    s_lshl_b32 s49, s63, 1
    s_add_u32 m0, s49, 116736
    s_add_u32 s48, s62, 24576
    buffer_load_dwordx4 v122, s[8:11], s48 offen sc1 lds
    s_lshl_b32 s49, s63, 1
    s_add_u32 m0, s49, 117760
    s_add_u32 s48, s62, 25600
    buffer_load_dwordx4 v122, s[8:11], s48 offen sc1 lds
    s_lshl_b32 s49, s63, 1
    s_add_u32 m0, s49, 124928
    s_add_u32 s48, s62, 32768
    buffer_load_dwordx4 v122, s[8:11], s48 offen sc1 lds
    s_lshl_b32 s49, s63, 1
    s_add_u32 m0, s49, 125952
    s_add_u32 s48, s62, 33792
    buffer_load_dwordx4 v122, s[8:11], s48 offen sc1 lds
    s_lshl_b32 s49, s63, 1
    s_add_u32 m0, s49, 133120
    s_add_u32 s48, s62, 40960
    buffer_load_dwordx4 v122, s[8:11], s48 offen sc1 lds
    s_lshl_b32 s49, s63, 1
    s_add_u32 m0, s49, 134144
    s_add_u32 s48, s62, 41984
    buffer_load_dwordx4 v122, s[8:11], s48 offen sc1 lds
    s_add_u32 m0, s63, 55296
    s_add_u32 s48, s23, 384
    s_mov_b64 exec, s[32:33]
    buffer_load_dwordx4 v121, s[12:15], s48 offen  lds
    s_mov_b64 exec, -1
    s_add_u32 m0, s63, 59392
    s_add_u32 s48, s22, 41344
    buffer_load_dwordx4 v120, s[12:15], s48 offen  lds
    s_add_u32 m0, s63, 63488
    s_add_u32 s48, s22, 82304
    buffer_load_dwordx4 v120, s[12:15], s48 offen  lds
    s_add_u32 m0, s63, 67584
    s_add_u32 s48, s22, 123264
    buffer_load_dwordx4 v120, s[12:15], s48 offen  lds
    s_waitcnt vmcnt(12)
    s_barrier
    s_lshl_b32 s49, s63, 1
    s_add_u32 m0, s49, 141312
    s_add_u32 s48, s62, 49152
    buffer_load_dwordx4 v122, s[8:11], s48 offen sc1 lds
    s_lshl_b32 s49, s63, 1
    s_add_u32 m0, s49, 142336
    s_add_u32 s48, s62, 50176
    buffer_load_dwordx4 v122, s[8:11], s48 offen sc1 lds
    s_lshl_b32 s49, s63, 1
    s_add_u32 m0, s49, 149504
    s_add_u32 s48, s62, 57344
    buffer_load_dwordx4 v122, s[8:11], s48 offen sc1 lds
    s_lshl_b32 s49, s63, 1
    s_add_u32 m0, s49, 150528
    s_add_u32 s48, s62, 58368
    buffer_load_dwordx4 v122, s[8:11], s48 offen sc1 lds
    s_add_u32 m0, s63, 73728
    s_add_u32 s48, s23, 512
    s_mov_b64 exec, s[32:33]
    buffer_load_dwordx4 v121, s[12:15], s48 offen  lds
    s_mov_b64 exec, -1
    s_add_u32 m0, s63, 77824
    s_add_u32 s48, s22, 41472
    buffer_load_dwordx4 v120, s[12:15], s48 offen  lds
    s_add_u32 m0, s63, 81920
    s_add_u32 s48, s22, 82432
    buffer_load_dwordx4 v120, s[12:15], s48 offen  lds
    s_add_u32 m0, s63, 86016
    s_add_u32 s48, s22, 123392
    buffer_load_dwordx4 v120, s[12:15], s48 offen  lds
    s_waitcnt vmcnt(18)
    s_barrier
    s_lshl_b32 s49, s63, 1
    s_add_u32 m0, s49, 92160
    s_add_u32 s48, s62, 65536
    buffer_load_dwordx4 v122, s[8:11], s48 offen sc1 lds
    s_lshl_b32 s49, s63, 1
    s_add_u32 m0, s49, 93184
    s_add_u32 s48, s62, 66560
    buffer_load_dwordx4 v122, s[8:11], s48 offen sc1 lds
    s_waitcnt vmcnt(18)
    s_barrier
    s_lshl_b32 s49, s63, 1
    s_add_u32 m0, s49, 100352
    s_add_u32 s48, s62, 73728
    buffer_load_dwordx4 v122, s[8:11], s48 offen sc1 lds
    s_lshl_b32 s49, s63, 1
    s_add_u32 m0, s49, 101376
    s_add_u32 s48, s62, 74752
    buffer_load_dwordx4 v122, s[8:11], s48 offen sc1 lds
    s_add_u32 m0, s63, 0
    s_add_u32 s48, s23, 640
    s_mov_b64 exec, s[32:33]
    buffer_load_dwordx4 v121, s[12:15], s48 offen  lds
    s_mov_b64 exec, -1
    s_add_u32 m0, s63, 4096
    s_add_u32 s48, s22, 41600
    buffer_load_dwordx4 v120, s[12:15], s48 offen  lds
    s_add_u32 m0, s63, 8192
    s_add_u32 s48, s22, 82560
    buffer_load_dwordx4 v120, s[12:15], s48 offen  lds
    s_add_u32 m0, s63, 12288
    s_add_u32 s48, s22, 123520
    buffer_load_dwordx4 v120, s[12:15], s48 offen  lds
    s_waitcnt vmcnt(22)
    s_barrier
    s_lshl_b32 s49, s63, 1
    s_add_u32 m0, s49, 108544
    s_add_u32 s48, s62, 81920
    buffer_load_dwordx4 v122, s[8:11], s48 offen sc1 lds
    s_lshl_b32 s49, s63, 1
    s_add_u32 m0, s49, 109568
    s_add_u32 s48, s62, 82944
    buffer_load_dwordx4 v122, s[8:11], s48 offen sc1 lds
    s_waitcnt vmcnt(22)
    s_barrier
    s_lshl_b32 s49, s63, 1
    s_add_u32 m0, s49, 116736
    s_add_u32 s48, s62, 90112
    buffer_load_dwordx4 v122, s[8:11], s48 offen sc1 lds
    s_lshl_b32 s49, s63, 1
    s_add_u32 m0, s49, 117760
    s_add_u32 s48, s62, 91136
    buffer_load_dwordx4 v122, s[8:11], s48 offen sc1 lds
    s_add_u32 m0, s63, 18432
    s_add_u32 s48, s23, 768
    s_mov_b64 exec, s[32:33]
    buffer_load_dwordx4 v121, s[12:15], s48 offen  lds
    s_mov_b64 exec, -1
    s_add_u32 m0, s63, 22528
    s_add_u32 s48, s22, 41728
    buffer_load_dwordx4 v120, s[12:15], s48 offen  lds
    s_add_u32 m0, s63, 26624
    s_add_u32 s48, s22, 82688
    buffer_load_dwordx4 v120, s[12:15], s48 offen  lds
    s_add_u32 m0, s63, 30720
    s_add_u32 s48, s22, 123648
    buffer_load_dwordx4 v120, s[12:15], s48 offen  lds
    v_and_b32 v2, 15, v1
    v_lshrrev_b32 v3, 4, v1
    v_lshrrev_b32 v5, 1, v3
    v_lshlrev_b32 v5, 10, v5
    v_and_b32 v6, 1, v3
    v_lshl_add_u32 v5, v6, 9, v5
    v_lshl_add_u32 v5, v2, 4, v5
    s_lshl_b32 s41, s24, 8
    v_add_u32 v5, s41, v5
    s_mul_i32 s42, s25, 163840
    s_lshl_b32 s43, s26, 12
    s_add_u32 s42, s42, s43
    s_add_u32 s42, s42, 10485760
    v_mov_b32 v7, 0x80000000
    s_cmp_ge_u32 s61, 540
    s_cselect_b64 vcc, -1, 0
    s_cselect_b32 s42, 0, s42
    s_mov_b32 s46, 0x05040100
    s_mov_b32 s47, 0x07060302
    s_mov_b32 s50, 0x3f803f80
    v_cndmask_b32 v112, v5, v7, vcc
    v_lshlrev_b32 v6, 2, v2
    v_cndmask_b32 v113, v6, v7, vcc
    v_mov_b32 v8, 0
    v_mov_b32 v9, 0
    v_mov_b32 v10, 0
    v_mov_b32 v11, 0
    s_waitcnt vmcnt(22)
    s_barrier
    s_lshl_b32 s49, s63, 1
    s_add_u32 m0, s49, 124928
    s_add_u32 s48, s62, 98304
    buffer_load_dwordx4 v122, s[8:11], s48 offen sc1 lds
    s_lshl_b32 s49, s63, 1
    s_add_u32 m0, s49, 125952
    s_add_u32 s48, s62, 99328
    buffer_load_dwordx4 v122, s[8:11], s48 offen sc1 lds
    v_perm_b32 v80, v18, v16, s46
    v_perm_b32 v81, v22, v20, s46
    v_perm_b32 v82, v26, v24, s46
    v_perm_b32 v83, v30, v28, s46
    v_perm_b32 v84, v18, v16, s47
    v_perm_b32 v85, v22, v20, s47
    v_perm_b32 v86, v26, v24, s47
    v_perm_b32 v87, v30, v28, s47
    s_add_u32 s43, s42, 0
    buffer_store_dwordx4 v[80:83], v112, s[8:11], s43 offen sc1
    s_add_u32 s43, s42, 40960
    buffer_store_dwordx4 v[84:87], v112, s[8:11], s43 offen sc1
    s_waitcnt vmcnt(24)
    s_barrier
    s_lshl_b32 s49, s63, 1
    s_add_u32 m0, s49, 133120
    s_add_u32 s48, s62, 106496
    buffer_load_dwordx4 v122, s[8:11], s48 offen sc1 lds
    s_lshl_b32 s49, s63, 1
    s_add_u32 m0, s49, 134144
    s_add_u32 s48, s62, 107520
    buffer_load_dwordx4 v122, s[8:11], s48 offen sc1 lds
    s_add_u32 m0, s63, 36864
    s_add_u32 s48, s23, 896
    s_mov_b64 exec, s[32:33]
    buffer_load_dwordx4 v121, s[12:15], s48 offen  lds
    s_mov_b64 exec, -1
    s_add_u32 m0, s63, 40960
    s_add_u32 s48, s22, 41856
    buffer_load_dwordx4 v120, s[12:15], s48 offen  lds
    s_add_u32 m0, s63, 45056
    s_add_u32 s48, s22, 82816
    buffer_load_dwordx4 v120, s[12:15], s48 offen  lds
    s_add_u32 m0, s63, 49152
    s_add_u32 s48, s22, 123776
    buffer_load_dwordx4 v120, s[12:15], s48 offen  lds
    v_perm_b32 v88, v19, v17, s46
    v_perm_b32 v89, v23, v21, s46
    v_perm_b32 v90, v27, v25, s46
    v_perm_b32 v91, v31, v29, s46
    v_perm_b32 v92, v19, v17, s47
    v_perm_b32 v93, v23, v21, s47
    v_perm_b32 v94, v27, v25, s47
    v_perm_b32 v95, v31, v29, s47
    s_add_u32 s43, s42, 81920
    buffer_store_dwordx4 v[88:91], v112, s[8:11], s43 offen sc1
    s_add_u32 s43, s42, 122880
    buffer_store_dwordx4 v[92:95], v112, s[8:11], s43 offen sc1
    s_waitcnt vmcnt(26)
    s_barrier
    s_lshl_b32 s49, s63, 1
    s_add_u32 m0, s49, 141312
    s_add_u32 s48, s62, 114688
    buffer_load_dwordx4 v122, s[8:11], s48 offen sc1 lds
    s_lshl_b32 s49, s63, 1
    s_add_u32 m0, s49, 142336
    s_add_u32 s48, s62, 115712
    buffer_load_dwordx4 v122, s[8:11], s48 offen sc1 lds
    v_perm_b32 v96, v34, v32, s46
    v_perm_b32 v97, v38, v36, s46
    v_perm_b32 v98, v42, v40, s46
    v_perm_b32 v99, v46, v44, s46
    v_perm_b32 v100, v34, v32, s47
    v_perm_b32 v101, v38, v36, s47
    v_perm_b32 v102, v42, v40, s47
    v_perm_b32 v103, v46, v44, s47
    s_add_u32 s43, s42, 2048
    buffer_store_dwordx4 v[96:99], v112, s[8:11], s43 offen sc1
    s_add_u32 s43, s42, 43008
    buffer_store_dwordx4 v[100:103], v112, s[8:11], s43 offen sc1
    s_waitcnt vmcnt(28)
    s_barrier
    s_lshl_b32 s49, s63, 1
    s_add_u32 m0, s49, 149504
    s_add_u32 s48, s62, 122880
    buffer_load_dwordx4 v122, s[8:11], s48 offen sc1 lds
    s_lshl_b32 s49, s63, 1
    s_add_u32 m0, s49, 150528
    s_add_u32 s48, s62, 123904
    buffer_load_dwordx4 v122, s[8:11], s48 offen sc1 lds
    s_add_u32 m0, s63, 55296
    s_add_u32 s48, s23, 1024
    s_mov_b64 exec, s[32:33]
    buffer_load_dwordx4 v121, s[12:15], s48 offen  lds
    s_mov_b64 exec, -1
    s_add_u32 m0, s63, 59392
    s_add_u32 s48, s22, 41984
    buffer_load_dwordx4 v120, s[12:15], s48 offen  lds
    s_add_u32 m0, s63, 63488
    s_add_u32 s48, s22, 82944
    buffer_load_dwordx4 v120, s[12:15], s48 offen  lds
    s_add_u32 m0, s63, 67584
    s_add_u32 s48, s22, 123904
    buffer_load_dwordx4 v120, s[12:15], s48 offen  lds
    v_perm_b32 v104, v35, v33, s46
    v_perm_b32 v105, v39, v37, s46
    v_perm_b32 v106, v43, v41, s46
    v_perm_b32 v107, v47, v45, s46
    v_perm_b32 v108, v35, v33, s47
    v_perm_b32 v109, v39, v37, s47
    v_perm_b32 v110, v43, v41, s47
    v_perm_b32 v111, v47, v45, s47
    s_add_u32 s43, s42, 83968
    buffer_store_dwordx4 v[104:107], v112, s[8:11], s43 offen sc1
    s_add_u32 s43, s42, 124928
    buffer_store_dwordx4 v[108:111], v112, s[8:11], s43 offen sc1
    s_waitcnt vmcnt(30)
    s_barrier
    s_lshl_b32 s49, s63, 1
    s_add_u32 m0, s49, 92160
    s_add_u32 s48, s62, 131072
    buffer_load_dwordx4 v122, s[8:11], s48 offen sc1 lds
    s_lshl_b32 s49, s63, 1
    s_add_u32 m0, s49, 93184
    s_add_u32 s48, s62, 132096
    buffer_load_dwordx4 v122, s[8:11], s48 offen sc1 lds
    v_dot2c_f32_bf16 v8, s50, v80
    v_dot2c_f32_bf16 v9, s50, v84
    v_dot2c_f32_bf16 v10, s50, v88
    v_dot2c_f32_bf16 v11, s50, v92
    v_dot2c_f32_bf16 v8, s50, v81
    v_dot2c_f32_bf16 v9, s50, v85
    v_dot2c_f32_bf16 v10, s50, v89
    v_dot2c_f32_bf16 v11, s50, v93
    v_dot2c_f32_bf16 v8, s50, v82
    v_dot2c_f32_bf16 v9, s50, v86
    v_dot2c_f32_bf16 v10, s50, v90
    v_dot2c_f32_bf16 v11, s50, v94
    v_dot2c_f32_bf16 v8, s50, v83
    v_dot2c_f32_bf16 v9, s50, v87
    v_dot2c_f32_bf16 v10, s50, v91
    v_dot2c_f32_bf16 v11, s50, v95
    v_dot2c_f32_bf16 v8, s50, v96
    v_dot2c_f32_bf16 v9, s50, v100
    v_dot2c_f32_bf16 v10, s50, v104
    v_dot2c_f32_bf16 v11, s50, v108
    v_dot2c_f32_bf16 v8, s50, v97
    v_dot2c_f32_bf16 v9, s50, v101
    v_dot2c_f32_bf16 v10, s50, v105
    v_dot2c_f32_bf16 v11, s50, v109
    v_dot2c_f32_bf16 v8, s50, v98
    v_dot2c_f32_bf16 v9, s50, v102
    v_dot2c_f32_bf16 v10, s50, v106
    v_dot2c_f32_bf16 v11, s50, v110
    v_dot2c_f32_bf16 v8, s50, v99
    v_dot2c_f32_bf16 v9, s50, v103
    v_dot2c_f32_bf16 v10, s50, v107
    v_dot2c_f32_bf16 v11, s50, v111
    s_waitcnt vmcnt(30)
    s_barrier
    s_lshl_b32 s49, s63, 1
    s_add_u32 m0, s49, 100352
    s_add_u32 s48, s62, 139264
    buffer_load_dwordx4 v122, s[8:11], s48 offen sc1 lds
    s_lshl_b32 s49, s63, 1
    s_add_u32 m0, s49, 101376
    s_add_u32 s48, s62, 140288
    buffer_load_dwordx4 v122, s[8:11], s48 offen sc1 lds
    s_add_u32 m0, s63, 73728
    s_add_u32 s48, s23, 1152
    s_mov_b64 exec, s[32:33]
    buffer_load_dwordx4 v121, s[12:15], s48 offen  lds
    s_mov_b64 exec, -1
    s_add_u32 m0, s63, 77824
    s_add_u32 s48, s22, 42112
    buffer_load_dwordx4 v120, s[12:15], s48 offen  lds
    s_add_u32 m0, s63, 81920
    s_add_u32 s48, s22, 83072
    buffer_load_dwordx4 v120, s[12:15], s48 offen  lds
    s_add_u32 m0, s63, 86016
    s_add_u32 s48, s22, 124032
    buffer_load_dwordx4 v120, s[12:15], s48 offen  lds
    s_nop 2
    v_mov_b32 v12, v8
    s_nop 1
    v_permlane16_swap_b32 v12, v8
    s_nop 1
    v_add_f32 v8, v8, v12
    v_mov_b32 v12, v8
    s_nop 1
    v_permlane32_swap_b32 v12, v8
    s_nop 1
    v_add_f32 v8, v8, v12
    v_mov_b32 v12, v9
    s_nop 1
    v_permlane16_swap_b32 v12, v9
    s_nop 1
    v_add_f32 v9, v9, v12
    v_mov_b32 v12, v9
    s_nop 1
    v_permlane32_swap_b32 v12, v9
    s_nop 1
    v_add_f32 v9, v9, v12
    s_waitcnt vmcnt(30)
    s_barrier
    s_lshl_b32 s49, s63, 1
    s_add_u32 m0, s49, 108544
    s_add_u32 s48, s62, 147456
    buffer_load_dwordx4 v122, s[8:11], s48 offen sc1 lds
    s_lshl_b32 s49, s63, 1
    s_add_u32 m0, s49, 109568
    s_add_u32 s48, s62, 148480
    buffer_load_dwordx4 v122, s[8:11], s48 offen sc1 lds
    s_nop 2
    v_mov_b32 v12, v10
    s_nop 1
    v_permlane16_swap_b32 v12, v10
    s_nop 1
    v_add_f32 v10, v10, v12
    v_mov_b32 v12, v10
    s_nop 1
    v_permlane32_swap_b32 v12, v10
    s_nop 1
    v_add_f32 v10, v10, v12
    v_mov_b32 v12, v11
    s_nop 1
    v_permlane16_swap_b32 v12, v11
    s_nop 1
    v_add_f32 v11, v11, v12
    v_mov_b32 v12, v11
    s_nop 1
    v_permlane32_swap_b32 v12, v11
    s_nop 1
    v_add_f32 v11, v11, v12
    s_waitcnt vmcnt(28)
    s_barrier
    s_lshl_b32 s49, s63, 1
    s_add_u32 m0, s49, 116736
    s_add_u32 s48, s62, 155648
    buffer_load_dwordx4 v122, s[8:11], s48 offen sc1 lds
    s_lshl_b32 s49, s63, 1
    s_add_u32 m0, s49, 117760
    s_add_u32 s48, s62, 156672
    buffer_load_dwordx4 v122, s[8:11], s48 offen sc1 lds
    s_mul_i32 s43, s26, 108
    s_lshl_b32 s41, s25, 2
    s_add_u32 s43, s43, s41
    s_lshl_b32 s43, s43, 7
    s_lshl_b32 s41, s24, 6
    s_add_u32 s43, s43, s41
    s_add_u32 s43, s43, 20971520
    s_cmp_ge_u32 s61, 540
    s_cselect_b32 s43, 0, s43
    s_mov_b64 exec, 0xffff
    buffer_store_dword v8, v113, s[8:11], s43 offen offset:0 sc1
    buffer_store_dword v9, v113, s[8:11], s43 offen offset:128 sc1
    buffer_store_dword v10, v113, s[8:11], s43 offen offset:256 sc1
    buffer_store_dword v11, v113, s[8:11], s43 offen offset:384 sc1
    s_mov_b64 exec, -1
    v_and_b32 v4, 31, v1
    s_lshl_b32 s36, s56, 5
    v_add_u32 v5, s36, v4
    v_and_b32 v6, 3, v1
    s_sub_u32 s37, s36, 4
    s_cmp_eq_u32 s56, 0
    s_cselect_b32 s37, 0, s37
    v_add_u32 v6, s37, v6
    v_cmp_gt_u32 vcc, 32, v1
    s_nop 1
    v_cndmask_b32 v5, v6, v5, vcc
    v_lshlrev_b32 v5, 3, v5
    v_add_u32 v103, 37752832, v5
    buffer_load_dword v102, v103, s[8:11], 0 offen sc1
    s_waitcnt vmcnt(27)
    s_barrier
    v_lshrrev_b32 v5, 4, v1
    s_lshl_b32 s39, s20, 2
    v_add_u32 v5, s39, v5
    v_mul_u32_u24 v6, 52, v5
    v_lshrrev_b32 v6, 8, v6
    v_mul_u32_u24 v7, 5, v6
    v_sub_u32 v7, v5, v7
    v_mul_u32_u24 v6, 0x10e, v6
    v_add_u32 v6, v6, v7
    v_lshlrev_b32 v6, 10, v6
    v_and_b32 v7, 15, v1
    v_lshl_add_u32 v6, v7, 4, v6
    s_mul_i32 s39, s21, 5120
    s_add_u32 s39, s39, 16777216
    v_mov_b32 v7, 0x80000000
    s_cmp_ge_u32 s61, 540
    s_cselect_b64 vcc, -1, 0
    s_cselect_b32 s39, 0, s39
    s_nop 0
    v_cndmask_b32 v114, v6, v7, vcc
    s_mov_b32 s19, s39
    v_lshl_or_b32 v80, v49, 16, v48
    v_lshl_or_b32 v81, v51, 16, v50
    v_lshl_or_b32 v82, v53, 16, v52
    v_lshl_or_b32 v83, v55, 16, v54
    buffer_store_dwordx4 v[80:83], v114, s[8:11], s19 offen offset:0 sc1
    v_lshl_or_b32 v84, v57, 16, v56
    v_lshl_or_b32 v85, v59, 16, v58
    v_lshl_or_b32 v86, v61, 16, v60
    v_lshl_or_b32 v87, v63, 16, v62
    buffer_store_dwordx4 v[84:87], v114, s[8:11], s19 offen offset:256 sc1
    s_waitcnt vmcnt(25)
    s_barrier
    v_lshl_or_b32 v88, v65, 16, v64
    v_lshl_or_b32 v89, v67, 16, v66
    v_lshl_or_b32 v90, v69, 16, v68
    v_lshl_or_b32 v91, v71, 16, v70
    buffer_store_dwordx4 v[88:91], v114, s[8:11], s19 offen offset:512 sc1
    v_lshl_or_b32 v92, v73, 16, v72
    v_lshl_or_b32 v93, v75, 16, v74
    v_lshl_or_b32 v94, v77, 16, v76
    v_lshl_or_b32 v95, v79, 16, v78
    buffer_store_dwordx4 v[92:95], v114, s[8:11], s19 offen offset:768 sc1
    s_waitcnt vmcnt(19)
    s_barrier
    s_waitcnt vmcnt(4)
    v_cmp_ne_u32 vcc, s60, v102
    s_nop 1
    s_cbranch_vccz sequential_preLN__sliding_local_dilated__glu_gated_bilinear__prompt_kernel_sfok17
    s_mov_b32 s51, 0
sequential_preLN__sliding_local_dilated__glu_gated_bilinear__prompt_kernel_poll18:
    buffer_load_dword v3, v103, s[8:11], 0 offen sc1
    s_add_u32 s51, s51, 1
    s_cmp_gt_u32 s51, 200000
    s_cbranch_scc1 sequential_preLN__sliding_local_dilated__glu_gated_bilinear__prompt_kernel_pollx19
    s_waitcnt vmcnt(0)
    v_cmp_ne_u32 vcc, s60, v3
    s_nop 1
    s_cbranch_vccz sequential_preLN__sliding_local_dilated__glu_gated_bilinear__prompt_kernel_pollx19
    s_sleep 2
    s_branch sequential_preLN__sliding_local_dilated__glu_gated_bilinear__prompt_kernel_poll18
sequential_preLN__sliding_local_dilated__glu_gated_bilinear__prompt_kernel_pollx19:
    s_waitcnt vmcnt(0)
sequential_preLN__sliding_local_dilated__glu_gated_bilinear__prompt_kernel_sfok17:
    s_lshl_b32 s36, s56, 7
    s_sub_u32 s36, s36, 16
    v_add_u32 v4, s36, v1
    v_lshlrev_b32 v5, 3, v4
    v_mov_b32 v6, 0x80000000
    v_cmp_gt_i32 vcc, 0, v4
    s_nop 1
    v_cndmask_b32 v5, v5, v6, vcc
    s_mov_b32 s36, 0
    buffer_load_dwordx2 v[96:97], v5, s[8:11], s36 offen sc1
    v_add_u32 v4, 64, v4
    v_lshlrev_b32 v5, 3, v4
    buffer_load_dwordx2 v[98:99], v5, s[8:11], s36 offen sc1
    buffer_load_dwordx2 v[100:101], v5, s[8:11], s36 offen offset:512 sc1
    s_barrier
    s_barrier
    s_barrier
    s_waitcnt vmcnt(3)
    s_lshl_b32 s36, s61, 3
    s_add_u32 s36, s36, 38141952
    s_cmp_ge_u32 s61, 540
    s_cselect_b32 s38, 0x80000000, 0
    s_cselect_b32 s36, 0, s36
    v_mov_b32 v13, s38
    v_mov_b32 v3, s60
    s_mov_b64 exec, 1
    buffer_atomic_swap v3, v13, s[8:11], s36 offen sc1
    s_mov_b64 exec, -1
    s_lshl_b32 s36, s61, 3
    s_add_u32 s36, s36, 38207488
    s_cmp_ge_u32 s61, 540
    s_cselect_b32 s38, 0x80000000, 0
    s_cselect_b32 s36, 0, s36
    v_mov_b32 v13, s38
    v_mov_b32 v3, s60
    s_mov_b64 exec, 1
    buffer_atomic_swap v3, v13, s[8:11], s36 offen sc1
    s_mov_b64 exec, -1
    s_waitcnt vmcnt(2)
    s_cmp_lg_u32 s3, 4
    s_cbranch_scc1 sequential_preLN__sliding_local_dilated__glu_gated_bilinear__prompt_kernel_sts20
    v_lshlrev_b32 v5, 3, v1
    v_add_u32 v5, 157696, v5
    ds_write_b64 v5, v[96:97]
    ds_write_b64 v5, v[98:99] offset:512
    s_mov_b64 exec, 0xffff
    ds_write_b64 v5, v[100:101] offset:1024
    s_mov_b64 exec, -1
sequential_preLN__sliding_local_dilated__glu_gated_bilinear__prompt_kernel_sts20:
    s_barrier
    s_waitcnt vmcnt(0)
    s_waitcnt vmcnt(0) lgkmcnt(0)
P_p1ld_done:
    s_barrier
    s_sub_u32 s32, s3, 4
    s_mul_i32 s36, s59, 5
    s_lshr_b32 s36, s36, 2
    s_mul_i32 s36, s36, 40
    v_min_u32 v2, 0x4f, v1
    v_add_u32 v2, s36, v2
    v_lshlrev_b32 v2, 3, v2
    v_add_u32 v5, 38076416, v2
    buffer_load_dword v120, v5, s[8:11], 0 offen sc1
    buffer_load_dword v121, v5, s[8:11], 0 offen offset:128 sc1
    v_lshlrev_b32 v2, 4, v1
    s_mul_i32 s23, s32, 25600
    s_mul_i32 s22, s59, 102400
    s_add_u32 s22, s22, s23
    s_add_u32 s22, s22, 8388608
    s_barrier
    s_waitcnt vmcnt(0)
sequential_preLN__sliding_local_dilated__glu_gated_bilinear__prompt_kernel_wore22:
    v_cmp_ne_u32 vcc, s60, v120
    v_cmp_ne_u32 s[36:37], s60, v121
    s_nop 1
    s_or_b64 vcc, vcc, s[36:37]
    s_cbranch_vccz sequential_preLN__sliding_local_dilated__glu_gated_bilinear__prompt_kernel_wook21
    s_sleep 2
    buffer_load_dword v120, v5, s[8:11], 0 offen sc1
    buffer_load_dword v121, v5, s[8:11], 0 offen offset:128 sc1
    s_waitcnt vmcnt(0)
    s_branch sequential_preLN__sliding_local_dilated__glu_gated_bilinear__prompt_kernel_wore22
sequential_preLN__sliding_local_dilated__glu_gated_bilinear__prompt_kernel_wook21:
    s_add_u32 m0, s23, 61440
    s_add_u32 s32, s22, 0
    buffer_load_dwordx4 v2, s[8:11], s32 offen sc1 lds
    s_add_u32 m0, s23, 62464
    s_add_u32 s32, s22, 1024
    buffer_load_dwordx4 v2, s[8:11], s32 offen sc1 lds
    s_add_u32 m0, s23, 63488
    s_add_u32 s32, s22, 2048
    buffer_load_dwordx4 v2, s[8:11], s32 offen sc1 lds
    s_add_u32 m0, s23, 64512
    s_add_u32 s32, s22, 3072
    buffer_load_dwordx4 v2, s[8:11], s32 offen sc1 lds
    s_add_u32 m0, s23, 65536
    s_add_u32 s32, s22, 4096
    buffer_load_dwordx4 v2, s[8:11], s32 offen sc1 lds
    s_add_u32 m0, s23, 66560
    s_add_u32 s32, s22, 5120
    buffer_load_dwordx4 v2, s[8:11], s32 offen sc1 lds
    s_add_u32 m0, s23, 67584
    s_add_u32 s32, s22, 6144
    buffer_load_dwordx4 v2, s[8:11], s32 offen sc1 lds
    s_add_u32 m0, s23, 68608
    s_add_u32 s32, s22, 7168
    buffer_load_dwordx4 v2, s[8:11], s32 offen sc1 lds
    s_add_u32 m0, s23, 69632
    s_add_u32 s32, s22, 8192
    buffer_load_dwordx4 v2, s[8:11], s32 offen sc1 lds
    s_add_u32 m0, s23, 70656
    s_add_u32 s32, s22, 9216
    buffer_load_dwordx4 v2, s[8:11], s32 offen sc1 lds
    s_add_u32 m0, s23, 71680
    s_add_u32 s32, s22, 10240
    buffer_load_dwordx4 v2, s[8:11], s32 offen sc1 lds
    s_add_u32 m0, s23, 72704
    s_add_u32 s32, s22, 11264
    buffer_load_dwordx4 v2, s[8:11], s32 offen sc1 lds
    s_add_u32 m0, s23, 73728
    s_add_u32 s32, s22, 12288
    buffer_load_dwordx4 v2, s[8:11], s32 offen sc1 lds
    s_add_u32 m0, s23, 74752
    s_add_u32 s32, s22, 13312
    buffer_load_dwordx4 v2, s[8:11], s32 offen sc1 lds
    s_add_u32 m0, s23, 75776
    s_add_u32 s32, s22, 14336
    buffer_load_dwordx4 v2, s[8:11], s32 offen sc1 lds
    s_add_u32 m0, s23, 76800
    s_add_u32 s32, s22, 15360
    buffer_load_dwordx4 v2, s[8:11], s32 offen sc1 lds
    s_add_u32 m0, s23, 77824
    s_add_u32 s32, s22, 16384
    buffer_load_dwordx4 v2, s[8:11], s32 offen sc1 lds
    s_add_u32 m0, s23, 78848
    s_add_u32 s32, s22, 17408
    buffer_load_dwordx4 v2, s[8:11], s32 offen sc1 lds
    s_add_u32 m0, s23, 79872
    s_add_u32 s32, s22, 18432
    buffer_load_dwordx4 v2, s[8:11], s32 offen sc1 lds
    s_add_u32 m0, s23, 80896
    s_add_u32 s32, s22, 19456
    buffer_load_dwordx4 v2, s[8:11], s32 offen sc1 lds
    s_add_u32 m0, s23, 81920
    s_add_u32 s32, s22, 20480
    buffer_load_dwordx4 v2, s[8:11], s32 offen sc1 lds
    s_add_u32 m0, s23, 82944
    s_add_u32 s32, s22, 21504
    buffer_load_dwordx4 v2, s[8:11], s32 offen sc1 lds
    s_add_u32 m0, s23, 83968
    s_add_u32 s32, s22, 22528
    buffer_load_dwordx4 v2, s[8:11], s32 offen sc1 lds
    s_add_u32 m0, s23, 84992
    s_add_u32 s32, s22, 23552
    buffer_load_dwordx4 v2, s[8:11], s32 offen sc1 lds
    s_add_u32 m0, s23, 86016
    s_add_u32 s32, s22, 24576
    buffer_load_dwordx4 v2, s[8:11], s32 offen sc1 lds
    v_lshlrev_b32 v2, 4, v1
    v_and_b32 v5, 15, v1
    v_lshrrev_b32 v6, 4, v1
    s_lshl_b32 s42, s58, 6
    s_sub_u32 s43, s3, 4
    s_lshl_b32 s43, s43, 4
    s_add_u32 s42, s42, s43
    v_add_u32 v7, s42, v5
    s_mov_b32 s4, s16
    s_mov_b32 s5, s17
    s_mov_b32 s6, 2621440
    s_mov_b32 s7, 0x00020000
    s_movk_i32 s42, 1280
    v_mul_lo_u32 v8, v7, s42
    v_lshl_add_u32 v8, v6, 3, v8
    s_mul_i32 s42, s59, 160
    v_add_u32 v8, s42, v8
    buffer_load_dwordx2 v[112:113], v8, s[4:7], 0 offen offset:0
    buffer_load_dwordx2 v[114:115], v8, s[4:7], 0 offen offset:32
    buffer_load_dwordx2 v[116:117], v8, s[4:7], 0 offen offset:64
    buffer_load_dwordx2 v[118:119], v8, s[4:7], 0 offen offset:96
    buffer_load_dwordx2 v[120:121], v8, s[4:7], 0 offen offset:128
    s_sub_u32 s37, s3, 4
    s_lshr_b32 s37, s37, 1
    s_and_b32 s36, s58, 1
    s_lshl_b32 s36, s36, 1
    s_add_u32 s36, s36, s37
    s_lshl_b32 s37, s56, 2
    s_add_u32 s36, s36, s37
    s_lshl_b32 s36, s36, 7
    s_add_u32 s36, s36, 38338560
    v_lshl_add_u32 v4, v5, 2, s36
    s_sub_u32 s49, s3, 4
    s_lshl_b32 s42, s58, 2
    s_add_u32 s42, s42, s49
    s_mul_i32 s44, s42, 20480
    s_add_u32 s44, s44, 22020096
    v_add_u32 v9, 61440, v2
    v_add_u32 v10, 0x8000, v9
    v_add_u32 v11, 0x10000, v9
    v_add_u32 v12, 0x18000, v9
    v_lshrrev_b32 v21, 4, v7
    s_movk_i32 s42, 20480
    v_mul_lo_u32 v21, v21, s42
    v_lshl_add_u32 v21, v5, 4, v21
    v_and_b32 v22, 1, v6
    v_lshl_add_u32 v21, v22, 3, v21
    v_lshrrev_b32 v22, 1, v6
    s_mul_i32 s42, s59, 10
    v_add_u32 v22, s42, v22
    v_lshrrev_b32 v23, 2, v22
    v_lshl_add_u32 v100, v23, 10, v21
    v_and_b32 v23, 3, v22
    v_lshl_add_u32 v100, v23, 8, v100
    v_add_u32 v22, 2, v22
    v_lshrrev_b32 v23, 2, v22
    v_lshl_add_u32 v101, v23, 10, v21
    v_and_b32 v23, 3, v22
    v_lshl_add_u32 v101, v23, 8, v101
    v_add_u32 v22, 2, v22
    v_lshrrev_b32 v23, 2, v22
    v_lshl_add_u32 v102, v23, 10, v21
    v_and_b32 v23, 3, v22
    v_lshl_add_u32 v102, v23, 8, v102
    v_add_u32 v22, 2, v22
    v_lshrrev_b32 v23, 2, v22
    v_lshl_add_u32 v103, v23, 10, v21
    v_and_b32 v23, 3, v22
    v_lshl_add_u32 v103, v23, 8, v103
    v_add_u32 v22, 2, v22
    v_lshrrev_b32 v23, 2, v22
    v_lshl_add_u32 v104, v23, 10, v21
    v_and_b32 v23, 3, v22
    v_lshl_add_u32 v104, v23, 8, v104
    v_add_u32 v22, 2, v22
    v_lshlrev_b32 v105, 6, v7
    v_and_b32 v23, 1, v6
    v_lshlrev_b32 v23, 1, v23
    v_lshrrev_b32 v24, 1, v6
    v_add_u32 v23, v23, v24
    s_mul_i32 s42, s59, 10
    v_add_u32 v23, s42, v23
    v_lshrrev_b32 v21, 4, v7
    s_movk_i32 s42, 20480
    v_mul_lo_u32 v21, v21, s42
    v_lshl_add_u32 v21, v5, 4, v21
    v_lshrrev_b32 v24, 2, v23
    v_lshl_add_u32 v100, v24, 10, v21
    v_and_b32 v24, 3, v23
    v_lshl_add_u32 v100, v24, 8, v100
    v_add_u32 v23, 4, v23
    v_lshrrev_b32 v24, 2, v23
    v_lshl_add_u32 v101, v24, 10, v21
    v_and_b32 v24, 3, v23
    v_lshl_add_u32 v101, v24, 8, v101
    v_add_u32 v23, 4, v23
    s_waitcnt vmcnt(5)
    s_barrier
    s_mov_b32 s51, 0
sequential_preLN__sliding_local_dilated__glu_gated_bilinear__prompt_kernel_poll23:
    buffer_load_dword v3, v4, s[8:11], 0 offen sc1
    s_add_u32 s51, s51, 1
    s_cmp_gt_u32 s51, 200000
    s_cbranch_scc1 sequential_preLN__sliding_local_dilated__glu_gated_bilinear__prompt_kernel_pollx24
    s_waitcnt vmcnt(0)
    v_cmp_ne_u32 vcc, s60, v3
    s_nop 1
    s_cbranch_vccz sequential_preLN__sliding_local_dilated__glu_gated_bilinear__prompt_kernel_pollx24
    s_sleep 2
    s_branch sequential_preLN__sliding_local_dilated__glu_gated_bilinear__prompt_kernel_poll23
sequential_preLN__sliding_local_dilated__glu_gated_bilinear__prompt_kernel_pollx24:
    s_waitcnt vmcnt(0)
    s_setprio 2
    s_add_u32 s45, s44, 0
    buffer_load_dwordx4 a[0:3], v2, s[8:11], s45 offen offset:0 sc1
    buffer_load_dwordx4 a[4:7], v2, s[8:11], s45 offen offset:1024 sc1
    buffer_load_dwordx4 a[8:11], v2, s[8:11], s45 offen offset:2048 sc1
    buffer_load_dwordx4 a[12:15], v2, s[8:11], s45 offen offset:3072 sc1
    s_add_u32 s45, s44, 4096
    buffer_load_dwordx4 a[16:19], v2, s[8:11], s45 offen offset:0 sc1
    buffer_load_dwordx4 a[20:23], v2, s[8:11], s45 offen offset:1024 sc1
    buffer_load_dwordx4 a[24:27], v2, s[8:11], s45 offen offset:2048 sc1
    buffer_load_dwordx4 a[28:31], v2, s[8:11], s45 offen offset:3072 sc1
    s_add_u32 s45, s44, 8192
    buffer_load_dwordx4 a[32:35], v2, s[8:11], s45 offen offset:0 sc1
    buffer_load_dwordx4 a[36:39], v2, s[8:11], s45 offen offset:1024 sc1
    buffer_load_dwordx4 a[40:43], v2, s[8:11], s45 offen offset:2048 sc1
    buffer_load_dwordx4 a[44:47], v2, s[8:11], s45 offen offset:3072 sc1
    s_add_u32 s45, s44, 12288
    buffer_load_dwordx4 a[48:51], v2, s[8:11], s45 offen offset:0 sc1
    buffer_load_dwordx4 a[52:55], v2, s[8:11], s45 offen offset:1024 sc1
    buffer_load_dwordx4 a[56:59], v2, s[8:11], s45 offen offset:2048 sc1
    buffer_load_dwordx4 a[60:63], v2, s[8:11], s45 offen offset:3072 sc1
    s_add_u32 s45, s44, 16384
    buffer_load_dwordx4 a[64:67], v2, s[8:11], s45 offen offset:0 sc1
    buffer_load_dwordx4 a[68:71], v2, s[8:11], s45 offen offset:1024 sc1
    buffer_load_dwordx4 a[72:75], v2, s[8:11], s45 offen offset:2048 sc1
    buffer_load_dwordx4 a[76:79], v2, s[8:11], s45 offen offset:3072 sc1
    s_barrier
    ds_read_b128 v[64:67], v9 offset:0
    ds_read_b128 v[68:71], v9 offset:1024
    ds_read_b128 v[72:75], v9 offset:2048
    ds_read_b128 v[76:79], v9 offset:3072
    ds_read_b128 v[80:83], v9 offset:4096
    s_waitcnt vmcnt(19)
    ds_read_b128 v[84:87], v9 offset:5120
    s_waitcnt lgkmcnt(5)
    v_mfma_f32_16x16x32_bf16 v[32:35], v[64:67], a[0:3], 0
    ds_read_b128 v[64:67], v9 offset:6144
    s_waitcnt lgkmcnt(5)
    v_mfma_f32_16x16x32_bf16 v[36:39], v[68:71], a[0:3], 0
    ds_read_b128 v[68:71], v9 offset:7168
    s_waitcnt lgkmcnt(5)
    v_mfma_f32_16x16x32_bf16 v[40:43], v[72:75], a[0:3], 0
    ds_read_b128 v[72:75], v9 offset:8192
    s_waitcnt lgkmcnt(5)
    v_mfma_f32_16x16x32_bf16 v[44:47], v[76:79], a[0:3], 0
    ds_read_b128 v[76:79], v9 offset:9216
    s_waitcnt lgkmcnt(5)
    v_mfma_f32_16x16x32_bf16 v[48:51], v[80:83], a[0:3], 0
    s_waitcnt vmcnt(18)
    ds_read_b128 v[80:83], v9 offset:10240
    s_waitcnt lgkmcnt(5)
    v_mfma_f32_16x16x32_bf16 v[32:35], v[84:87], a[4:7], v[32:35]
    ds_read_b128 v[84:87], v9 offset:11264
    s_waitcnt lgkmcnt(5)
    v_mfma_f32_16x16x32_bf16 v[36:39], v[64:67], a[4:7], v[36:39]
    ds_read_b128 v[64:67], v9 offset:12288
    s_waitcnt lgkmcnt(5)
    v_mfma_f32_16x16x32_bf16 v[40:43], v[68:71], a[4:7], v[40:43]
    ds_read_b128 v[68:71], v9 offset:13312
    s_waitcnt lgkmcnt(5)
    v_mfma_f32_16x16x32_bf16 v[44:47], v[72:75], a[4:7], v[44:47]
    ds_read_b128 v[72:75], v9 offset:14336
    s_waitcnt lgkmcnt(5)
    v_mfma_f32_16x16x32_bf16 v[48:51], v[76:79], a[4:7], v[48:51]
    s_waitcnt vmcnt(17)
    ds_read_b128 v[76:79], v9 offset:15360
    s_waitcnt lgkmcnt(5)
    v_mfma_f32_16x16x32_bf16 v[32:35], v[80:83], a[8:11], v[32:35]
    ds_read_b128 v[80:83], v9 offset:16384
    s_waitcnt lgkmcnt(5)
    v_mfma_f32_16x16x32_bf16 v[36:39], v[84:87], a[8:11], v[36:39]
    ds_read_b128 v[84:87], v9 offset:17408
    s_waitcnt lgkmcnt(5)
    v_mfma_f32_16x16x32_bf16 v[40:43], v[64:67], a[8:11], v[40:43]
    ds_read_b128 v[64:67], v9 offset:18432
    s_waitcnt lgkmcnt(5)
    v_mfma_f32_16x16x32_bf16 v[44:47], v[68:71], a[8:11], v[44:47]
    ds_read_b128 v[68:71], v9 offset:19456
    s_waitcnt lgkmcnt(5)
    v_mfma_f32_16x16x32_bf16 v[48:51], v[72:75], a[8:11], v[48:51]
    s_waitcnt vmcnt(16)
    ds_read_b128 v[72:75], v9 offset:20480
    s_waitcnt lgkmcnt(5)
    v_mfma_f32_16x16x32_bf16 v[32:35], v[76:79], a[12:15], v[32:35]
    ds_read_b128 v[76:79], v9 offset:21504
    s_waitcnt lgkmcnt(5)
    v_mfma_f32_16x16x32_bf16 v[36:39], v[80:83], a[12:15], v[36:39]
    ds_read_b128 v[80:83], v9 offset:22528
    s_waitcnt lgkmcnt(5)
    v_mfma_f32_16x16x32_bf16 v[40:43], v[84:87], a[12:15], v[40:43]
    ds_read_b128 v[84:87], v9 offset:23552
    s_waitcnt lgkmcnt(5)
    v_mfma_f32_16x16x32_bf16 v[44:47], v[64:67], a[12:15], v[44:47]
    ds_read_b128 v[64:67], v9 offset:24576
    s_waitcnt lgkmcnt(5)
    v_mfma_f32_16x16x32_bf16 v[48:51], v[68:71], a[12:15], v[48:51]
    s_waitcnt vmcnt(15)
    ds_read_b128 v[68:71], v9 offset:25600
    s_waitcnt lgkmcnt(5)
    v_mfma_f32_16x16x32_bf16 v[32:35], v[72:75], a[16:19], v[32:35]
    ds_read_b128 v[72:75], v9 offset:26624
    s_waitcnt lgkmcnt(5)
    v_mfma_f32_16x16x32_bf16 v[36:39], v[76:79], a[16:19], v[36:39]
    ds_read_b128 v[76:79], v9 offset:27648
    s_waitcnt lgkmcnt(5)
    v_mfma_f32_16x16x32_bf16 v[40:43], v[80:83], a[16:19], v[40:43]
    ds_read_b128 v[80:83], v9 offset:28672
    s_waitcnt lgkmcnt(5)
    v_mfma_f32_16x16x32_bf16 v[44:47], v[84:87], a[16:19], v[44:47]
    ds_read_b128 v[84:87], v9 offset:29696
    s_waitcnt lgkmcnt(5)
    v_mfma_f32_16x16x32_bf16 v[48:51], v[64:67], a[16:19], v[48:51]
    s_waitcnt vmcnt(14)
    ds_read_b128 v[64:67], v9 offset:30720
    s_waitcnt lgkmcnt(5)
    v_mfma_f32_16x16x32_bf16 v[32:35], v[68:71], a[20:23], v[32:35]
    ds_read_b128 v[68:71], v9 offset:31744
    s_waitcnt lgkmcnt(5)
    v_mfma_f32_16x16x32_bf16 v[36:39], v[72:75], a[20:23], v[36:39]
    ds_read_b128 v[72:75], v10 offset:0
    s_waitcnt lgkmcnt(5)
    v_mfma_f32_16x16x32_bf16 v[40:43], v[76:79], a[20:23], v[40:43]
    ds_read_b128 v[76:79], v10 offset:1024
    s_waitcnt lgkmcnt(5)
    v_mfma_f32_16x16x32_bf16 v[44:47], v[80:83], a[20:23], v[44:47]
    ds_read_b128 v[80:83], v10 offset:2048
    s_waitcnt lgkmcnt(5)
    v_mfma_f32_16x16x32_bf16 v[48:51], v[84:87], a[20:23], v[48:51]
    s_waitcnt vmcnt(13)
    ds_read_b128 v[84:87], v10 offset:3072
    s_waitcnt lgkmcnt(5)
    v_mfma_f32_16x16x32_bf16 v[32:35], v[64:67], a[24:27], v[32:35]
    ds_read_b128 v[64:67], v10 offset:4096
    s_waitcnt lgkmcnt(5)
    v_mfma_f32_16x16x32_bf16 v[36:39], v[68:71], a[24:27], v[36:39]
    ds_read_b128 v[68:71], v10 offset:5120
    s_waitcnt lgkmcnt(5)
    v_mfma_f32_16x16x32_bf16 v[40:43], v[72:75], a[24:27], v[40:43]
    ds_read_b128 v[72:75], v10 offset:6144
    s_waitcnt lgkmcnt(5)
    v_mfma_f32_16x16x32_bf16 v[44:47], v[76:79], a[24:27], v[44:47]
    ds_read_b128 v[76:79], v10 offset:7168
    s_waitcnt lgkmcnt(5)
    v_mfma_f32_16x16x32_bf16 v[48:51], v[80:83], a[24:27], v[48:51]
    s_waitcnt vmcnt(12)
    ds_read_b128 v[80:83], v10 offset:8192
    s_waitcnt lgkmcnt(5)
    v_mfma_f32_16x16x32_bf16 v[32:35], v[84:87], a[28:31], v[32:35]
    ds_read_b128 v[84:87], v10 offset:9216
    s_waitcnt lgkmcnt(5)
    v_mfma_f32_16x16x32_bf16 v[36:39], v[64:67], a[28:31], v[36:39]
    ds_read_b128 v[64:67], v10 offset:10240
    s_waitcnt lgkmcnt(5)
    v_mfma_f32_16x16x32_bf16 v[40:43], v[68:71], a[28:31], v[40:43]
    ds_read_b128 v[68:71], v10 offset:11264
    s_waitcnt lgkmcnt(5)
    v_mfma_f32_16x16x32_bf16 v[44:47], v[72:75], a[28:31], v[44:47]
    ds_read_b128 v[72:75], v10 offset:12288
    s_waitcnt lgkmcnt(5)
    v_mfma_f32_16x16x32_bf16 v[48:51], v[76:79], a[28:31], v[48:51]
    s_waitcnt vmcnt(11)
    ds_read_b128 v[76:79], v10 offset:13312
    s_waitcnt lgkmcnt(5)
    v_mfma_f32_16x16x32_bf16 v[32:35], v[80:83], a[32:35], v[32:35]
    ds_read_b128 v[80:83], v10 offset:14336
    s_waitcnt lgkmcnt(5)
    v_mfma_f32_16x16x32_bf16 v[36:39], v[84:87], a[32:35], v[36:39]
    ds_read_b128 v[84:87], v10 offset:15360
    s_waitcnt lgkmcnt(5)
    v_mfma_f32_16x16x32_bf16 v[40:43], v[64:67], a[32:35], v[40:43]
    ds_read_b128 v[64:67], v10 offset:16384
    s_waitcnt lgkmcnt(5)
    v_mfma_f32_16x16x32_bf16 v[44:47], v[68:71], a[32:35], v[44:47]
    ds_read_b128 v[68:71], v10 offset:17408
    s_waitcnt lgkmcnt(5)
    v_mfma_f32_16x16x32_bf16 v[48:51], v[72:75], a[32:35], v[48:51]
    s_waitcnt vmcnt(10)
    ds_read_b128 v[72:75], v10 offset:18432
    s_waitcnt lgkmcnt(5)
    v_mfma_f32_16x16x32_bf16 v[32:35], v[76:79], a[36:39], v[32:35]
    ds_read_b128 v[76:79], v10 offset:19456
    s_waitcnt lgkmcnt(5)
    v_mfma_f32_16x16x32_bf16 v[36:39], v[80:83], a[36:39], v[36:39]
    ds_read_b128 v[80:83], v10 offset:20480
    s_waitcnt lgkmcnt(5)
    v_mfma_f32_16x16x32_bf16 v[40:43], v[84:87], a[36:39], v[40:43]
    ds_read_b128 v[84:87], v10 offset:21504
    s_waitcnt lgkmcnt(5)
    v_mfma_f32_16x16x32_bf16 v[44:47], v[64:67], a[36:39], v[44:47]
    ds_read_b128 v[64:67], v10 offset:22528
    s_waitcnt lgkmcnt(5)
    v_mfma_f32_16x16x32_bf16 v[48:51], v[68:71], a[36:39], v[48:51]
    s_waitcnt vmcnt(9)
    ds_read_b128 v[68:71], v10 offset:23552
    s_waitcnt lgkmcnt(5)
    v_mfma_f32_16x16x32_bf16 v[32:35], v[72:75], a[40:43], v[32:35]
    ds_read_b128 v[72:75], v10 offset:24576
    s_waitcnt lgkmcnt(5)
    v_mfma_f32_16x16x32_bf16 v[36:39], v[76:79], a[40:43], v[36:39]
    ds_read_b128 v[76:79], v10 offset:25600
    s_waitcnt lgkmcnt(5)
    v_mfma_f32_16x16x32_bf16 v[40:43], v[80:83], a[40:43], v[40:43]
    ds_read_b128 v[80:83], v10 offset:26624
    s_waitcnt lgkmcnt(5)
    v_mfma_f32_16x16x32_bf16 v[44:47], v[84:87], a[40:43], v[44:47]
    ds_read_b128 v[84:87], v10 offset:27648
    s_waitcnt lgkmcnt(5)
    v_mfma_f32_16x16x32_bf16 v[48:51], v[64:67], a[40:43], v[48:51]
    s_waitcnt vmcnt(8)
    ds_read_b128 v[64:67], v10 offset:28672
    s_waitcnt lgkmcnt(5)
    v_mfma_f32_16x16x32_bf16 v[32:35], v[68:71], a[44:47], v[32:35]
    ds_read_b128 v[68:71], v10 offset:29696
    s_waitcnt lgkmcnt(5)
    v_mfma_f32_16x16x32_bf16 v[36:39], v[72:75], a[44:47], v[36:39]
    ds_read_b128 v[72:75], v10 offset:30720
    s_waitcnt lgkmcnt(5)
    v_mfma_f32_16x16x32_bf16 v[40:43], v[76:79], a[44:47], v[40:43]
    ds_read_b128 v[76:79], v10 offset:31744
    s_waitcnt lgkmcnt(5)
    v_mfma_f32_16x16x32_bf16 v[44:47], v[80:83], a[44:47], v[44:47]
    ds_read_b128 v[80:83], v11 offset:0
    s_waitcnt lgkmcnt(5)
    v_mfma_f32_16x16x32_bf16 v[48:51], v[84:87], a[44:47], v[48:51]
    s_waitcnt vmcnt(7)
    ds_read_b128 v[84:87], v11 offset:1024
    s_waitcnt lgkmcnt(5)
    v_mfma_f32_16x16x32_bf16 v[32:35], v[64:67], a[48:51], v[32:35]
    ds_read_b128 v[64:67], v11 offset:2048
    s_waitcnt lgkmcnt(5)
    v_mfma_f32_16x16x32_bf16 v[36:39], v[68:71], a[48:51], v[36:39]
    ds_read_b128 v[68:71], v11 offset:3072
    s_waitcnt lgkmcnt(5)
    v_mfma_f32_16x16x32_bf16 v[40:43], v[72:75], a[48:51], v[40:43]
    ds_read_b128 v[72:75], v11 offset:4096
    s_waitcnt lgkmcnt(5)
    v_mfma_f32_16x16x32_bf16 v[44:47], v[76:79], a[48:51], v[44:47]
    ds_read_b128 v[76:79], v11 offset:5120
    s_waitcnt lgkmcnt(5)
    v_mfma_f32_16x16x32_bf16 v[48:51], v[80:83], a[48:51], v[48:51]
    s_waitcnt vmcnt(6)
    ds_read_b128 v[80:83], v11 offset:6144
    s_waitcnt lgkmcnt(5)
    v_mfma_f32_16x16x32_bf16 v[32:35], v[84:87], a[52:55], v[32:35]
    ds_read_b128 v[84:87], v11 offset:7168
    s_waitcnt lgkmcnt(5)
    v_mfma_f32_16x16x32_bf16 v[36:39], v[64:67], a[52:55], v[36:39]
    ds_read_b128 v[64:67], v11 offset:8192
    s_waitcnt lgkmcnt(5)
    v_mfma_f32_16x16x32_bf16 v[40:43], v[68:71], a[52:55], v[40:43]
    ds_read_b128 v[68:71], v11 offset:9216
    s_waitcnt lgkmcnt(5)
    v_mfma_f32_16x16x32_bf16 v[44:47], v[72:75], a[52:55], v[44:47]
    ds_read_b128 v[72:75], v11 offset:10240
    s_waitcnt lgkmcnt(5)
    v_mfma_f32_16x16x32_bf16 v[48:51], v[76:79], a[52:55], v[48:51]
    s_waitcnt vmcnt(5)
    ds_read_b128 v[76:79], v11 offset:11264
    s_waitcnt lgkmcnt(5)
    v_mfma_f32_16x16x32_bf16 v[32:35], v[80:83], a[56:59], v[32:35]
    ds_read_b128 v[80:83], v11 offset:12288
    s_waitcnt lgkmcnt(5)
    v_mfma_f32_16x16x32_bf16 v[36:39], v[84:87], a[56:59], v[36:39]
    ds_read_b128 v[84:87], v11 offset:13312
    s_waitcnt lgkmcnt(5)
    v_mfma_f32_16x16x32_bf16 v[40:43], v[64:67], a[56:59], v[40:43]
    ds_read_b128 v[64:67], v11 offset:14336
    s_waitcnt lgkmcnt(5)
    v_mfma_f32_16x16x32_bf16 v[44:47], v[68:71], a[56:59], v[44:47]
    ds_read_b128 v[68:71], v11 offset:15360
    s_waitcnt lgkmcnt(5)
    v_mfma_f32_16x16x32_bf16 v[48:51], v[72:75], a[56:59], v[48:51]
    s_waitcnt vmcnt(4)
    ds_read_b128 v[72:75], v11 offset:16384
    s_waitcnt lgkmcnt(5)
    v_mfma_f32_16x16x32_bf16 v[32:35], v[76:79], a[60:63], v[32:35]
    ds_read_b128 v[76:79], v11 offset:17408
    s_waitcnt lgkmcnt(5)
    v_mfma_f32_16x16x32_bf16 v[36:39], v[80:83], a[60:63], v[36:39]
    ds_read_b128 v[80:83], v11 offset:18432
    s_waitcnt lgkmcnt(5)
    v_mfma_f32_16x16x32_bf16 v[40:43], v[84:87], a[60:63], v[40:43]
    ds_read_b128 v[84:87], v11 offset:19456
    s_waitcnt lgkmcnt(5)
    v_mfma_f32_16x16x32_bf16 v[44:47], v[64:67], a[60:63], v[44:47]
    ds_read_b128 v[64:67], v11 offset:20480
    s_waitcnt lgkmcnt(5)
    v_mfma_f32_16x16x32_bf16 v[48:51], v[68:71], a[60:63], v[48:51]
    s_waitcnt vmcnt(3)
    ds_read_b128 v[68:71], v11 offset:21504
    s_waitcnt lgkmcnt(5)
    v_mfma_f32_16x16x32_bf16 v[32:35], v[72:75], a[64:67], v[32:35]
    ds_read_b128 v[72:75], v11 offset:22528
    s_waitcnt lgkmcnt(5)
    v_mfma_f32_16x16x32_bf16 v[36:39], v[76:79], a[64:67], v[36:39]
    ds_read_b128 v[76:79], v11 offset:23552
    s_waitcnt lgkmcnt(5)
    v_mfma_f32_16x16x32_bf16 v[40:43], v[80:83], a[64:67], v[40:43]
    ds_read_b128 v[80:83], v11 offset:24576
    s_waitcnt lgkmcnt(5)
    v_mfma_f32_16x16x32_bf16 v[44:47], v[84:87], a[64:67], v[44:47]
    ds_read_b128 v[84:87], v11 offset:25600
    s_waitcnt lgkmcnt(5)
    v_mfma_f32_16x16x32_bf16 v[48:51], v[64:67], a[64:67], v[48:51]
    s_waitcnt vmcnt(2)
    ds_read_b128 v[64:67], v11 offset:26624
    s_waitcnt lgkmcnt(5)
    v_mfma_f32_16x16x32_bf16 v[32:35], v[68:71], a[68:71], v[32:35]
    ds_read_b128 v[68:71], v11 offset:27648
    s_waitcnt lgkmcnt(5)
    v_mfma_f32_16x16x32_bf16 v[36:39], v[72:75], a[68:71], v[36:39]
    ds_read_b128 v[72:75], v11 offset:28672
    s_waitcnt lgkmcnt(5)
    v_mfma_f32_16x16x32_bf16 v[40:43], v[76:79], a[68:71], v[40:43]
    ds_read_b128 v[76:79], v11 offset:29696
    s_waitcnt lgkmcnt(5)
    v_mfma_f32_16x16x32_bf16 v[44:47], v[80:83], a[68:71], v[44:47]
    ds_read_b128 v[80:83], v11 offset:30720
    s_waitcnt lgkmcnt(5)
    v_mfma_f32_16x16x32_bf16 v[48:51], v[84:87], a[68:71], v[48:51]
    s_waitcnt vmcnt(1)
    ds_read_b128 v[84:87], v11 offset:31744
    s_waitcnt lgkmcnt(5)
    v_mfma_f32_16x16x32_bf16 v[32:35], v[64:67], a[72:75], v[32:35]
    ds_read_b128 v[64:67], v12 offset:0
    s_waitcnt lgkmcnt(5)
    v_mfma_f32_16x16x32_bf16 v[36:39], v[68:71], a[72:75], v[36:39]
    ds_read_b128 v[68:71], v12 offset:1024
    s_waitcnt lgkmcnt(5)
    v_mfma_f32_16x16x32_bf16 v[40:43], v[72:75], a[72:75], v[40:43]
    ds_read_b128 v[72:75], v12 offset:2048
    s_waitcnt lgkmcnt(5)
    v_mfma_f32_16x16x32_bf16 v[44:47], v[76:79], a[72:75], v[44:47]
    ds_read_b128 v[76:79], v12 offset:3072
    s_waitcnt lgkmcnt(5)
    v_mfma_f32_16x16x32_bf16 v[48:51], v[80:83], a[72:75], v[48:51]
    s_waitcnt vmcnt(0)
    s_waitcnt lgkmcnt(4)
    v_mfma_f32_16x16x32_bf16 v[32:35], v[84:87], a[76:79], v[32:35]
    s_waitcnt lgkmcnt(3)
    v_mfma_f32_16x16x32_bf16 v[36:39], v[64:67], a[76:79], v[36:39]
    s_waitcnt lgkmcnt(2)
    v_mfma_f32_16x16x32_bf16 v[40:43], v[68:71], a[76:79], v[40:43]
    s_waitcnt lgkmcnt(1)
    v_mfma_f32_16x16x32_bf16 v[44:47], v[72:75], a[76:79], v[44:47]
    s_waitcnt lgkmcnt(0)
    v_mfma_f32_16x16x32_bf16 v[48:51], v[76:79], a[76:79], v[48:51]
    s_nop 7
    v_lshlrev_b32 v16, 16, v112
    v_and_b32 v17, 0xffff0000, v112
    v_add_f32 v32, v32, v16
    v_add_f32 v33, v33, v17
    v_lshlrev_b32 v16, 16, v113
    v_and_b32 v17, 0xffff0000, v113
    v_add_f32 v34, v34, v16
    v_add_f32 v35, v35, v17
    v_lshlrev_b32 v16, 16, v114
    v_and_b32 v17, 0xffff0000, v114
    v_add_f32 v36, v36, v16
    v_add_f32 v37, v37, v17
    v_lshlrev_b32 v16, 16, v115
    v_and_b32 v17, 0xffff0000, v115
    v_add_f32 v38, v38, v16
    v_add_f32 v39, v39, v17
    v_lshlrev_b32 v16, 16, v116
    v_and_b32 v17, 0xffff0000, v116
    v_add_f32 v40, v40, v16
    v_add_f32 v41, v41, v17
    v_lshlrev_b32 v16, 16, v117
    v_and_b32 v17, 0xffff0000, v117
    v_add_f32 v42, v42, v16
    v_add_f32 v43, v43, v17
    v_lshlrev_b32 v16, 16, v118
    v_and_b32 v17, 0xffff0000, v118
    v_add_f32 v44, v44, v16
    v_add_f32 v45, v45, v17
    v_lshlrev_b32 v16, 16, v119
    v_and_b32 v17, 0xffff0000, v119
    v_add_f32 v46, v46, v16
    v_add_f32 v47, v47, v17
    v_lshlrev_b32 v16, 16, v120
    v_and_b32 v17, 0xffff0000, v120
    v_add_f32 v48, v48, v16
    v_add_f32 v49, v49, v17
    v_lshlrev_b32 v16, 16, v121
    v_and_b32 v17, 0xffff0000, v121
    v_add_f32 v50, v50, v16
    v_add_f32 v51, v51, v17
    v_cvt_pk_bf16_f32 v56, v32, v33
    v_cvt_pk_bf16_f32 v57, v34, v35
    v_cvt_pk_bf16_f32 v58, v36, v37
    v_cvt_pk_bf16_f32 v59, v38, v39
    v_cvt_pk_bf16_f32 v60, v40, v41
    v_cvt_pk_bf16_f32 v61, v42, v43
    v_cvt_pk_bf16_f32 v62, v44, v45
    v_cvt_pk_bf16_f32 v63, v46, v47
    v_cvt_pk_bf16_f32 v64, v48, v49
    v_cvt_pk_bf16_f32 v65, v50, v51
    s_mov_b32 s42, 25165824
    s_nop 1
    v_permlane16_swap_b32 v56, v58
    v_permlane16_swap_b32 v57, v59
    v_permlane16_swap_b32 v60, v62
    v_permlane16_swap_b32 v61, v63
    s_nop 1
    buffer_store_dwordx4 v[56:59], v100, s[8:11], s42 offen sc1
    buffer_store_dwordx4 v[60:63], v101, s[8:11], s42 offen sc1
    buffer_store_dwordx2 v[64:65], v104, s[8:11], s42 offen sc1
    v_mov_b32 v18, 0
    v_mov_b32 v19, 0
    v_mov_b32 v26, 0
    v_mov_b32 v27, 0
    v_lshlrev_b32 v16, 16, v56
    v_and_b32 v17, 0xffff0000, v56
    v_add_f32 v18, v18, v16
    v_fmac_f32 v19, v16, v16
    v_add_f32 v26, v26, v17
    v_fmac_f32 v27, v17, v17
    v_lshlrev_b32 v16, 16, v57
    v_and_b32 v17, 0xffff0000, v57
    v_add_f32 v18, v18, v16
    v_fmac_f32 v19, v16, v16
    v_add_f32 v26, v26, v17
    v_fmac_f32 v27, v17, v17
    v_lshlrev_b32 v16, 16, v58
    v_and_b32 v17, 0xffff0000, v58
    v_add_f32 v18, v18, v16
    v_fmac_f32 v19, v16, v16
    v_add_f32 v26, v26, v17
    v_fmac_f32 v27, v17, v17
    v_lshlrev_b32 v16, 16, v59
    v_and_b32 v17, 0xffff0000, v59
    v_add_f32 v18, v18, v16
    v_fmac_f32 v19, v16, v16
    v_add_f32 v26, v26, v17
    v_fmac_f32 v27, v17, v17
    v_lshlrev_b32 v16, 16, v60
    v_and_b32 v17, 0xffff0000, v60
    v_add_f32 v18, v18, v16
    v_fmac_f32 v19, v16, v16
    v_add_f32 v26, v26, v17
    v_fmac_f32 v27, v17, v17
    v_lshlrev_b32 v16, 16, v61
    v_and_b32 v17, 0xffff0000, v61
    v_add_f32 v18, v18, v16
    v_fmac_f32 v19, v16, v16
    v_add_f32 v26, v26, v17
    v_fmac_f32 v27, v17, v17
    v_lshlrev_b32 v16, 16, v62
    v_and_b32 v17, 0xffff0000, v62
    v_add_f32 v18, v18, v16
    v_fmac_f32 v19, v16, v16
    v_add_f32 v26, v26, v17
    v_fmac_f32 v27, v17, v17
    v_lshlrev_b32 v16, 16, v63
    v_and_b32 v17, 0xffff0000, v63
    v_add_f32 v18, v18, v16
    v_fmac_f32 v19, v16, v16
    v_add_f32 v26, v26, v17
    v_fmac_f32 v27, v17, v17
    v_lshlrev_b32 v16, 16, v64
    v_and_b32 v17, 0xffff0000, v64
    v_add_f32 v18, v18, v16
    v_fmac_f32 v19, v16, v16
    v_add_f32 v26, v26, v17
    v_fmac_f32 v27, v17, v17
    v_lshlrev_b32 v16, 16, v65
    v_and_b32 v17, 0xffff0000, v65
    v_add_f32 v18, v18, v16
    v_fmac_f32 v19, v16, v16
    v_add_f32 v26, v26, v17
    v_fmac_f32 v27, v17, v17
    v_add_f32 v18, v18, v26
    v_add_f32 v19, v19, v27
    v_mov_b32 v20, v18
    v_mov_b32 v21, v19
    s_nop 1
    v_permlane16_swap_b32 v20, v18
    v_permlane16_swap_b32 v21, v19
    s_nop 1
    v_add_f32 v18, v18, v20
    v_add_f32 v19, v19, v21
    v_mov_b32 v20, v18
    v_mov_b32 v21, v19
    s_nop 1
    v_permlane32_swap_b32 v20, v18
    v_permlane32_swap_b32 v21, v19
    s_nop 1
    v_add_f32 v18, v18, v20
    v_add_f32 v19, v19, v21
    s_lshl_b32 s42, s59, 3
    s_add_u32 s42, s42, 28311552
    s_mov_b64 exec, 0xffff
    buffer_store_dwordx2 v[18:19], v105, s[8:11], s42 offen sc1
    s_mov_b64 exec, -1
    s_waitcnt vmcnt(0)
    s_setprio 0
    s_sub_u32 s40, s3, 4
    s_lshl_b32 s36, s58, 2
    s_add_u32 s36, s36, s40
    s_lshl_b32 s36, s36, 7
    s_lshl_b32 s37, s59, 2
    s_add_u32 s36, s36, s37
    s_add_u32 s36, s36, 38273024
    v_mov_b32 v3, s60
    v_mov_b32 v4, 0
    s_mov_b64 exec, 1
    buffer_atomic_swap v3, v4, s[8:11], s36 offen sc1
    s_mov_b64 exec, -1
    s_barrier
    v_lshlrev_b32 v2, 4, v1
    v_mov_b32 v120, v2
    v_mov_b32 v122, v2
    s_mul_i32 s42, s57, 7
    s_sub_u32 s43, s57, 12
    s_cmp_gt_u32 s57, 12
    s_cselect_b32 s43, s43, 0
    s_sub_u32 s42, s42, s43
    s_cmp_lt_u32 s57, 12
    s_cselect_b32 s43, 7, 6
    s_sub_u32 s44, s3, 4
    s_mul_i32 s47, s42, 40960
    s_mul_i32 s48, s44, 5120
    s_add_u32 s47, s47, s48
    s_add_u32 s47, s47, 10485760
    s_mul_i32 s54, s59, 276480
    s_add_u32 s54, s54, 16777216
    s_mov_b32 s55, s48
    s_barrier
    s_add_u32 m0, s48, 61440
    s_add_u32 s50, s47, 61440
    buffer_load_dwordx4 v120, s[8:11], s50 offen sc1 lds
    s_add_u32 m0, s48, 62464
    s_add_u32 s50, s47, 62464
    buffer_load_dwordx4 v120, s[8:11], s50 offen sc1 lds
    s_add_u32 m0, s48, 63488
    s_add_u32 s50, s47, 63488
    buffer_load_dwordx4 v120, s[8:11], s50 offen sc1 lds
    s_add_u32 m0, s48, 64512
    s_add_u32 s50, s47, 64512
    buffer_load_dwordx4 v120, s[8:11], s50 offen sc1 lds
    s_add_u32 m0, s48, 65536
    s_add_u32 s50, s47, 65536
    buffer_load_dwordx4 v120, s[8:11], s50 offen sc1 lds
    s_add_u32 m0, s48, 81920
    s_add_u32 s50, s47, 81920
    buffer_load_dwordx4 v120, s[8:11], s50 offen sc1 lds
    s_add_u32 m0, s48, 82944
    s_add_u32 s50, s47, 82944
    buffer_load_dwordx4 v120, s[8:11], s50 offen sc1 lds
    s_add_u32 m0, s48, 83968
    s_add_u32 s50, s47, 83968
    buffer_load_dwordx4 v120, s[8:11], s50 offen sc1 lds
    s_add_u32 m0, s48, 84992
    s_add_u32 s50, s47, 84992
    buffer_load_dwordx4 v120, s[8:11], s50 offen sc1 lds
    s_add_u32 m0, s48, 86016
    s_add_u32 s50, s47, 86016
    buffer_load_dwordx4 v120, s[8:11], s50 offen sc1 lds
    s_add_u32 m0, s48, 102400
    s_add_u32 s50, s47, 102400
    buffer_load_dwordx4 v120, s[8:11], s50 offen sc1 lds
    s_add_u32 m0, s48, 103424
    s_add_u32 s50, s47, 103424
    buffer_load_dwordx4 v120, s[8:11], s50 offen sc1 lds
    s_add_u32 m0, s48, 104448
    s_add_u32 s50, s47, 104448
    buffer_load_dwordx4 v120, s[8:11], s50 offen sc1 lds
    s_add_u32 m0, s48, 105472
    s_add_u32 s50, s47, 105472
    buffer_load_dwordx4 v120, s[8:11], s50 offen sc1 lds
    s_add_u32 m0, s48, 106496
    s_add_u32 s50, s47, 106496
    buffer_load_dwordx4 v120, s[8:11], s50 offen sc1 lds
    s_add_u32 m0, s48, 122880
    s_add_u32 s50, s47, 122880
    buffer_load_dwordx4 v120, s[8:11], s50 offen sc1 lds
    s_add_u32 m0, s48, 123904
    s_add_u32 s50, s47, 123904
    buffer_load_dwordx4 v120, s[8:11], s50 offen sc1 lds
    s_add_u32 m0, s48, 124928
    s_add_u32 s50, s47, 124928
    buffer_load_dwordx4 v120, s[8:11], s50 offen sc1 lds
    s_add_u32 m0, s48, 125952
    s_add_u32 s50, s47, 125952
    buffer_load_dwordx4 v120, s[8:11], s50 offen sc1 lds
    s_add_u32 m0, s48, 126976
    s_add_u32 s50, s47, 126976
    buffer_load_dwordx4 v120, s[8:11], s50 offen sc1 lds
    s_barrier
    s_add_u32 m0, s48, 0
    s_add_u32 s50, s47, 143360
    buffer_load_dwordx4 v120, s[8:11], s50 offen sc1 lds
    s_add_u32 m0, s48, 1024
    s_add_u32 s50, s47, 144384
    buffer_load_dwordx4 v120, s[8:11], s50 offen sc1 lds
    s_add_u32 m0, s48, 2048
    s_add_u32 s50, s47, 145408
    buffer_load_dwordx4 v120, s[8:11], s50 offen sc1 lds
    s_add_u32 m0, s48, 3072
    s_add_u32 s50, s47, 146432
    buffer_load_dwordx4 v120, s[8:11], s50 offen sc1 lds
    s_add_u32 m0, s48, 4096
    s_add_u32 s50, s47, 147456
    buffer_load_dwordx4 v120, s[8:11], s50 offen sc1 lds
    s_waitcnt vmcnt(20)
    s_barrier
    s_add_u32 m0, s48, 20480
    s_add_u32 s50, s47, 163840
    buffer_load_dwordx4 v120, s[8:11], s50 offen sc1 lds
    s_add_u32 m0, s48, 21504
    s_add_u32 s50, s47, 164864
    buffer_load_dwordx4 v120, s[8:11], s50 offen sc1 lds
    s_add_u32 m0, s48, 22528
    s_add_u32 s50, s47, 165888
    buffer_load_dwordx4 v120, s[8:11], s50 offen sc1 lds
    s_add_u32 m0, s48, 23552
    s_add_u32 s50, s47, 166912
    buffer_load_dwordx4 v120, s[8:11], s50 offen sc1 lds
    s_add_u32 m0, s48, 24576
    s_add_u32 s50, s47, 167936
    buffer_load_dwordx4 v120, s[8:11], s50 offen sc1 lds
    s_waitcnt vmcnt(20)
    s_barrier
    s_add_u32 m0, s48, 40960
    s_add_u32 s50, s47, 184320
    buffer_load_dwordx4 v120, s[8:11], s50 offen sc1 lds
    s_add_u32 m0, s48, 41984
    s_add_u32 s50, s47, 185344
    buffer_load_dwordx4 v120, s[8:11], s50 offen sc1 lds
    s_add_u32 m0, s48, 43008
    s_add_u32 s50, s47, 186368
    buffer_load_dwordx4 v120, s[8:11], s50 offen sc1 lds
    s_add_u32 m0, s48, 44032
    s_add_u32 s50, s47, 187392
    buffer_load_dwordx4 v120, s[8:11], s50 offen sc1 lds
    s_add_u32 m0, s48, 45056
    s_add_u32 s50, s47, 188416
    buffer_load_dwordx4 v120, s[8:11], s50 offen sc1 lds
    s_waitcnt vmcnt(20)
    s_barrier
    s_add_u32 m0, s48, 61440
    s_add_u32 s50, s47, 204800
    buffer_load_dwordx4 v120, s[8:11], s50 offen sc1 lds
    s_add_u32 m0, s48, 62464
    s_add_u32 s50, s47, 205824
    buffer_load_dwordx4 v120, s[8:11], s50 offen sc1 lds
    s_add_u32 m0, s48, 63488
    s_add_u32 s50, s47, 206848
    buffer_load_dwordx4 v120, s[8:11], s50 offen sc1 lds
    s_add_u32 m0, s48, 64512
    s_add_u32 s50, s47, 207872
    buffer_load_dwordx4 v120, s[8:11], s50 offen sc1 lds
    s_add_u32 m0, s48, 65536
    s_add_u32 s50, s47, 208896
    buffer_load_dwordx4 v120, s[8:11], s50 offen sc1 lds
    s_mul_i32 s36, s59, 5
    s_lshr_b32 s36, s36, 2
    s_mul_i32 s36, s36, 54
    v_add_u32 v4, s36, v1
    v_lshlrev_b32 v4, 3, v4
    v_add_u32 v100, 38207488, v4
    v_min_u32 v4, 43, v1
    v_add_u32 v4, 64, v4
    v_add_u32 v4, s36, v4
    v_lshlrev_b32 v4, 3, v4
    v_add_u32 v101, 38207488, v4
    buffer_load_dword v102, v100, s[8:11], 0 offen sc1
    buffer_load_dword v103, v101, s[8:11], 0 offen sc1
    s_waitcnt vmcnt(22)
    s_barrier
    s_add_u32 m0, s48, 81920
    s_add_u32 s50, s47, 225280
    buffer_load_dwordx4 v120, s[8:11], s50 offen sc1 lds
    s_add_u32 m0, s48, 82944
    s_add_u32 s50, s47, 226304
    buffer_load_dwordx4 v120, s[8:11], s50 offen sc1 lds
    s_add_u32 m0, s48, 83968
    s_add_u32 s50, s47, 227328
    buffer_load_dwordx4 v120, s[8:11], s50 offen sc1 lds
    s_add_u32 m0, s48, 84992
    s_add_u32 s50, s47, 228352
    buffer_load_dwordx4 v120, s[8:11], s50 offen sc1 lds
    s_add_u32 m0, s48, 86016
    s_add_u32 s50, s47, 229376
    buffer_load_dwordx4 v120, s[8:11], s50 offen sc1 lds
    s_waitcnt vmcnt(22)
    s_barrier
    s_cmp_eq_u32 s43, 6
    s_cselect_b32 s36, 0x80000000, 0
    v_or_b32 v120, s36, v2
    s_add_u32 m0, s48, 102400
    s_add_u32 s50, s47, 245760
    buffer_load_dwordx4 v120, s[8:11], s50 offen sc1 lds
    s_add_u32 m0, s48, 103424
    s_add_u32 s50, s47, 246784
    buffer_load_dwordx4 v120, s[8:11], s50 offen sc1 lds
    s_add_u32 m0, s48, 104448
    s_add_u32 s50, s47, 247808
    buffer_load_dwordx4 v120, s[8:11], s50 offen sc1 lds
    s_add_u32 m0, s48, 105472
    s_add_u32 s50, s47, 248832
    buffer_load_dwordx4 v120, s[8:11], s50 offen sc1 lds
    s_add_u32 m0, s48, 106496
    s_add_u32 s50, s47, 249856
    buffer_load_dwordx4 v120, s[8:11], s50 offen sc1 lds
    s_waitcnt vmcnt(22)
    s_barrier
    s_cmp_eq_u32 s43, 6
    s_cselect_b32 s36, 0x80000000, 0
    v_or_b32 v120, s36, v2
    s_add_u32 m0, s48, 122880
    s_add_u32 s50, s47, 266240
    buffer_load_dwordx4 v120, s[8:11], s50 offen sc1 lds
    s_add_u32 m0, s48, 123904
    s_add_u32 s50, s47, 267264
    buffer_load_dwordx4 v120, s[8:11], s50 offen sc1 lds
    s_add_u32 m0, s48, 124928
    s_add_u32 s50, s47, 268288
    buffer_load_dwordx4 v120, s[8:11], s50 offen sc1 lds
    s_add_u32 m0, s48, 125952
    s_add_u32 s50, s47, 269312
    buffer_load_dwordx4 v120, s[8:11], s50 offen sc1 lds
    s_add_u32 m0, s48, 126976
    s_add_u32 s50, s47, 270336
    buffer_load_dwordx4 v120, s[8:11], s50 offen sc1 lds
    s_waitcnt vmcnt(15)
    v_cmp_ne_u32 vcc, s60, v102
    v_cmp_ne_u32 s[36:37], s60, v103
    s_nop 1
    s_or_b64 vcc, vcc, s[36:37]
    s_cbranch_vccz sequential_preLN__sliding_local_dilated__glu_gated_bilinear__prompt_kernel_dfok25
    s_mov_b32 s51, 0
sequential_preLN__sliding_local_dilated__glu_gated_bilinear__prompt_kernel_poll26:
    buffer_load_dword v3, v100, s[8:11], 0 offen sc1
    s_add_u32 s51, s51, 1
    s_cmp_gt_u32 s51, 200000
    s_cbranch_scc1 sequential_preLN__sliding_local_dilated__glu_gated_bilinear__prompt_kernel_pollx27
    s_waitcnt vmcnt(0)
    v_cmp_ne_u32 vcc, s60, v3
    s_nop 1
    s_cbranch_vccz sequential_preLN__sliding_local_dilated__glu_gated_bilinear__prompt_kernel_pollx27
    s_sleep 2
    s_branch sequential_preLN__sliding_local_dilated__glu_gated_bilinear__prompt_kernel_poll26
sequential_preLN__sliding_local_dilated__glu_gated_bilinear__prompt_kernel_pollx27:
    s_waitcnt vmcnt(0)
    s_mov_b32 s51, 0
sequential_preLN__sliding_local_dilated__glu_gated_bilinear__prompt_kernel_poll28:
    buffer_load_dword v3, v101, s[8:11], 0 offen sc1
    s_add_u32 s51, s51, 1
    s_cmp_gt_u32 s51, 200000
    s_cbranch_scc1 sequential_preLN__sliding_local_dilated__glu_gated_bilinear__prompt_kernel_pollx29
    s_waitcnt vmcnt(0)
    v_cmp_ne_u32 vcc, s60, v3
    s_nop 1
    s_cbranch_vccz sequential_preLN__sliding_local_dilated__glu_gated_bilinear__prompt_kernel_pollx29
    s_sleep 2
    s_branch sequential_preLN__sliding_local_dilated__glu_gated_bilinear__prompt_kernel_poll28
sequential_preLN__sliding_local_dilated__glu_gated_bilinear__prompt_kernel_pollx29:
    s_waitcnt vmcnt(0)
sequential_preLN__sliding_local_dilated__glu_gated_bilinear__prompt_kernel_dfok25:
    s_barrier
    s_mov_b32 s50, 0
    s_cmp_eq_u32 s44, 1
    s_cselect_b32 s50, 5120, s50
    s_cmp_eq_u32 s44, 2
    s_cselect_b32 s50, 10240, s50
    s_cmp_eq_u32 s44, 3
    s_cselect_b32 s50, 15360, s50
    s_add_u32 s50, s50, s54
    s_add_u32 m0, s55, 0
    s_add_u32 s51, s50, 0
    buffer_load_dwordx4 v122, s[8:11], s51 offen sc1 lds
    s_add_u32 m0, s55, 1024
    s_add_u32 s51, s50, 1024
    buffer_load_dwordx4 v122, s[8:11], s51 offen sc1 lds
    s_add_u32 m0, s55, 2048
    s_add_u32 s51, s50, 2048
    buffer_load_dwordx4 v122, s[8:11], s51 offen sc1 lds
    s_add_u32 m0, s55, 3072
    s_add_u32 s51, s50, 3072
    buffer_load_dwordx4 v122, s[8:11], s51 offen sc1 lds
    s_add_u32 m0, s55, 4096
    s_add_u32 s51, s50, 4096
    buffer_load_dwordx4 v122, s[8:11], s51 offen sc1 lds
    s_barrier
    s_mov_b32 s50, 20480
    s_cmp_eq_u32 s44, 1
    s_cselect_b32 s50, 25600, s50
    s_cmp_eq_u32 s44, 2
    s_cselect_b32 s50, 30720, s50
    s_cmp_eq_u32 s44, 3
    s_cselect_b32 s50, 35840, s50
    s_add_u32 s50, s50, s54
    s_add_u32 m0, s55, 20480
    s_add_u32 s51, s50, 0
    buffer_load_dwordx4 v122, s[8:11], s51 offen sc1 lds
    s_add_u32 m0, s55, 21504
    s_add_u32 s51, s50, 1024
    buffer_load_dwordx4 v122, s[8:11], s51 offen sc1 lds
    s_add_u32 m0, s55, 22528
    s_add_u32 s51, s50, 2048
    buffer_load_dwordx4 v122, s[8:11], s51 offen sc1 lds
    s_add_u32 m0, s55, 23552
    s_add_u32 s51, s50, 3072
    buffer_load_dwordx4 v122, s[8:11], s51 offen sc1 lds
    s_add_u32 m0, s55, 24576
    s_add_u32 s51, s50, 4096
    buffer_load_dwordx4 v122, s[8:11], s51 offen sc1 lds
    s_waitcnt vmcnt(20)
    s_barrier
    s_mov_b32 s50, 40960
    s_cmp_eq_u32 s44, 1
    s_cselect_b32 s50, 46080, s50
    s_cmp_eq_u32 s44, 2
    s_cselect_b32 s50, 51200, s50
    s_cmp_eq_u32 s44, 3
    s_cselect_b32 s50, 56320, s50
    s_add_u32 s50, s50, s54
    s_add_u32 m0, s55, 40960
    s_add_u32 s51, s50, 0
    buffer_load_dwordx4 v122, s[8:11], s51 offen sc1 lds
    s_add_u32 m0, s55, 41984
    s_add_u32 s51, s50, 1024
    buffer_load_dwordx4 v122, s[8:11], s51 offen sc1 lds
    s_add_u32 m0, s55, 43008
    s_add_u32 s51, s50, 2048
    buffer_load_dwordx4 v122, s[8:11], s51 offen sc1 lds
    s_add_u32 m0, s55, 44032
    s_add_u32 s51, s50, 3072
    buffer_load_dwordx4 v122, s[8:11], s51 offen sc1 lds
    s_add_u32 m0, s55, 45056
    s_add_u32 s51, s50, 4096
    buffer_load_dwordx4 v122, s[8:11], s51 offen sc1 lds
    s_waitcnt vmcnt(20)
    s_barrier
    s_mov_b32 s50, 61440
    s_cmp_eq_u32 s44, 1
    s_cselect_b32 s50, 66560, s50
    s_cmp_eq_u32 s44, 2
    s_cselect_b32 s50, 71680, s50
    s_cmp_eq_u32 s44, 3
    s_cselect_b32 s50, 76800, s50
    s_add_u32 s50, s50, s54
    s_add_u32 m0, s55, 61440
    s_add_u32 s51, s50, 0
    buffer_load_dwordx4 v122, s[8:11], s51 offen sc1 lds
    s_add_u32 m0, s55, 62464
    s_add_u32 s51, s50, 1024
    buffer_load_dwordx4 v122, s[8:11], s51 offen sc1 lds
    s_add_u32 m0, s55, 63488
    s_add_u32 s51, s50, 2048
    buffer_load_dwordx4 v122, s[8:11], s51 offen sc1 lds
    s_add_u32 m0, s55, 64512
    s_add_u32 s51, s50, 3072
    buffer_load_dwordx4 v122, s[8:11], s51 offen sc1 lds
    s_add_u32 m0, s55, 65536
    s_add_u32 s51, s50, 4096
    buffer_load_dwordx4 v122, s[8:11], s51 offen sc1 lds
    s_waitcnt vmcnt(20)
    s_barrier
    s_mov_b32 s50, 81920
    s_cmp_eq_u32 s44, 1
    s_cselect_b32 s50, 87040, s50
    s_cmp_eq_u32 s44, 2
    s_cselect_b32 s50, 92160, s50
    s_cmp_eq_u32 s44, 3
    s_cselect_b32 s50, 97280, s50
    s_add_u32 s50, s50, s54
    s_add_u32 m0, s55, 81920
    s_add_u32 s51, s50, 0
    buffer_load_dwordx4 v122, s[8:11], s51 offen sc1 lds
    s_add_u32 m0, s55, 82944
    s_add_u32 s51, s50, 1024
    buffer_load_dwordx4 v122, s[8:11], s51 offen sc1 lds
    s_add_u32 m0, s55, 83968
    s_add_u32 s51, s50, 2048
    buffer_load_dwordx4 v122, s[8:11], s51 offen sc1 lds
    s_add_u32 m0, s55, 84992
    s_add_u32 s51, s50, 3072
    buffer_load_dwordx4 v122, s[8:11], s51 offen sc1 lds
    s_add_u32 m0, s55, 86016
    s_add_u32 s51, s50, 4096
    buffer_load_dwordx4 v122, s[8:11], s51 offen sc1 lds
    s_waitcnt vmcnt(20)
    s_barrier
    s_mov_b32 s50, 102400
    s_cmp_eq_u32 s44, 1
    s_cselect_b32 s50, 107520, s50
    s_cmp_eq_u32 s44, 2
    s_cselect_b32 s50, 112640, s50
    s_cmp_eq_u32 s44, 3
    s_cselect_b32 s50, 117760, s50
    s_add_u32 s50, s50, s54
    s_add_u32 m0, s55, 102400
    s_add_u32 s51, s50, 0
    buffer_load_dwordx4 v122, s[8:11], s51 offen sc1 lds
    s_add_u32 m0, s55, 103424
    s_add_u32 s51, s50, 1024
    buffer_load_dwordx4 v122, s[8:11], s51 offen sc1 lds
    s_add_u32 m0, s55, 104448
    s_add_u32 s51, s50, 2048
    buffer_load_dwordx4 v122, s[8:11], s51 offen sc1 lds
    s_add_u32 m0, s55, 105472
    s_add_u32 s51, s50, 3072
    buffer_load_dwordx4 v122, s[8:11], s51 offen sc1 lds
    s_add_u32 m0, s55, 106496
    s_add_u32 s51, s50, 4096
    buffer_load_dwordx4 v122, s[8:11], s51 offen sc1 lds
    s_waitcnt vmcnt(20)
    s_barrier
    v_lshlrev_b32 v2, 4, v1
    v_and_b32 v5, 15, v1
    v_lshrrev_b32 v6, 4, v1
    s_lshl_b32 s42, s58, 6
    s_sub_u32 s43, s3, 4
    s_lshl_b32 s43, s43, 4
    s_add_u32 s42, s42, s43
    v_add_u32 v7, s42, v5
    s_mov_b32 s4, s30
    s_mov_b32 s5, s31
    s_mov_b32 s6, 2621440
    s_mov_b32 s7, 0x00020000
    v_lshrrev_b32 v21, 4, v7
    s_movk_i32 s42, 20480
    v_mul_lo_u32 v21, v21, s42
    v_lshl_add_u32 v21, v5, 4, v21
    v_and_b32 v22, 1, v6
    v_lshl_add_u32 v21, v22, 3, v21
    v_lshrrev_b32 v22, 1, v6
    s_mul_i32 s42, s59, 10
    v_add_u32 v22, s42, v22
    s_mov_b32 s42, 25165824
    v_lshrrev_b32 v23, 2, v22
    v_lshl_add_u32 v24, v23, 10, v21
    v_and_b32 v23, 3, v22
    v_lshl_add_u32 v24, v23, 8, v24
    buffer_load_dwordx2 v[112:113], v24, s[8:11], s42 offen sc1
    v_add_u32 v22, 2, v22
    v_lshrrev_b32 v23, 2, v22
    v_lshl_add_u32 v24, v23, 10, v21
    v_and_b32 v23, 3, v22
    v_lshl_add_u32 v24, v23, 8, v24
    buffer_load_dwordx2 v[114:115], v24, s[8:11], s42 offen sc1
    v_add_u32 v22, 2, v22
    v_lshrrev_b32 v23, 2, v22
    v_lshl_add_u32 v24, v23, 10, v21
    v_and_b32 v23, 3, v22
    v_lshl_add_u32 v24, v23, 8, v24
    buffer_load_dwordx2 v[116:117], v24, s[8:11], s42 offen sc1
    v_add_u32 v22, 2, v22
    v_lshrrev_b32 v23, 2, v22
    v_lshl_add_u32 v24, v23, 10, v21
    v_and_b32 v23, 3, v22
    v_lshl_add_u32 v24, v23, 8, v24
    buffer_load_dwordx2 v[118:119], v24, s[8:11], s42 offen sc1
    v_add_u32 v22, 2, v22
    v_lshrrev_b32 v23, 2, v22
    v_lshl_add_u32 v24, v23, 10, v21
    v_and_b32 v23, 3, v22
    v_lshl_add_u32 v24, v23, 8, v24
    buffer_load_dwordx2 v[120:121], v24, s[8:11], s42 offen sc1
    v_add_u32 v22, 2, v22
    s_sub_u32 s49, s3, 4
    s_and_b32 s36, s58, 1
    s_lshl_b32 s36, s36, 1
    s_lshr_b32 s37, s49, 1
    s_add_u32 s36, s36, s37
    s_lshl_b32 s37, s56, 2
    s_add_u32 s36, s36, s37
    s_lshl_b32 s36, s36, 7
    s_add_u32 s36, s36, 37888000
    v_lshl_add_u32 v25, v5, 2, s36
    v_add_u32 v26, 8192, v25
    v_add_u32 v27, 16384, v25
    s_lshl_b32 s42, s58, 2
    s_add_u32 s42, s42, s49
    s_mul_i32 s44, s42, 55296
    s_add_u32 s44, s44, 29360128
    v_mov_b32 v9, v2
    v_add_u32 v10, 61440, v2
    v_add_u32 v11, 122880, v2
    s_mov_b32 s51, 0
sequential_preLN__sliding_local_dilated__glu_gated_bilinear__prompt_kernel_poll30:
    buffer_load_dword v3, v25, s[8:11], 0 offen sc1
    s_add_u32 s51, s51, 1
    s_cmp_gt_u32 s51, 200000
    s_cbranch_scc1 sequential_preLN__sliding_local_dilated__glu_gated_bilinear__prompt_kernel_pollx31
    s_waitcnt vmcnt(0)
    v_cmp_ne_u32 vcc, s60, v3
    s_nop 1
    s_cbranch_vccz sequential_preLN__sliding_local_dilated__glu_gated_bilinear__prompt_kernel_pollx31
    s_sleep 2
    s_branch sequential_preLN__sliding_local_dilated__glu_gated_bilinear__prompt_kernel_poll30
sequential_preLN__sliding_local_dilated__glu_gated_bilinear__prompt_kernel_pollx31:
    s_waitcnt vmcnt(0)
    s_setprio 3
    s_add_u32 s45, s44, 0
    buffer_load_dwordx4 a[0:3], v2, s[8:11], s45 offen offset:0 sc1
    s_add_u32 s45, s44, 0
    buffer_load_dwordx4 a[4:7], v2, s[8:11], s45 offen offset:1024 sc1
    s_add_u32 s45, s44, 0
    buffer_load_dwordx4 a[8:11], v2, s[8:11], s45 offen offset:2048 sc1
    s_add_u32 s45, s44, 0
    buffer_load_dwordx4 a[12:15], v2, s[8:11], s45 offen offset:3072 sc1
    s_add_u32 s45, s44, 4096
    buffer_load_dwordx4 a[16:19], v2, s[8:11], s45 offen offset:0 sc1
    s_add_u32 s45, s44, 4096
    buffer_load_dwordx4 a[20:23], v2, s[8:11], s45 offen offset:1024 sc1
    s_add_u32 s45, s44, 4096
    buffer_load_dwordx4 a[24:27], v2, s[8:11], s45 offen offset:2048 sc1
    s_add_u32 s45, s44, 4096
    buffer_load_dwordx4 a[28:31], v2, s[8:11], s45 offen offset:3072 sc1
    s_add_u32 s45, s44, 8192
    buffer_load_dwordx4 a[32:35], v2, s[8:11], s45 offen offset:0 sc1
    s_add_u32 s45, s44, 8192
    buffer_load_dwordx4 a[36:39], v2, s[8:11], s45 offen offset:1024 sc1
    s_add_u32 s45, s44, 8192
    buffer_load_dwordx4 a[40:43], v2, s[8:11], s45 offen offset:2048 sc1
    s_add_u32 s45, s44, 8192
    buffer_load_dwordx4 a[44:47], v2, s[8:11], s45 offen offset:3072 sc1
    s_add_u32 s45, s44, 12288
    buffer_load_dwordx4 a[48:51], v2, s[8:11], s45 offen offset:0 sc1
    s_add_u32 s45, s44, 12288
    buffer_load_dwordx4 a[52:55], v2, s[8:11], s45 offen offset:1024 sc1
    s_add_u32 s45, s44, 12288
    buffer_load_dwordx4 a[56:59], v2, s[8:11], s45 offen offset:2048 sc1
    s_add_u32 s45, s44, 12288
    buffer_load_dwordx4 a[60:63], v2, s[8:11], s45 offen offset:3072 sc1
    s_add_u32 s45, s44, 16384
    buffer_load_dwordx4 a[64:67], v2, s[8:11], s45 offen offset:0 sc1
    s_add_u32 s45, s44, 16384
    buffer_load_dwordx4 a[68:71], v2, s[8:11], s45 offen offset:1024 sc1
    s_add_u32 s45, s44, 16384
    buffer_load_dwordx4 a[72:75], v2, s[8:11], s45 offen offset:2048 sc1
    s_add_u32 s45, s44, 16384
    buffer_load_dwordx4 a[76:79], v2, s[8:11], s45 offen offset:3072 sc1
    s_waitcnt vmcnt(19)
    ds_read_b128 v[64:67], v9 offset:0
    ds_read_b128 v[68:71], v9 offset:1024
    ds_read_b128 v[72:75], v9 offset:2048
    ds_read_b128 v[76:79], v9 offset:3072
    ds_read_b128 v[80:83], v9 offset:4096
    ds_read_b128 v[84:87], v9 offset:5120
    s_waitcnt lgkmcnt(5)
    v_mfma_f32_16x16x32_bf16 v[32:35], v[64:67], a[0:3], 0
    ds_read_b128 v[64:67], v9 offset:6144
    s_waitcnt lgkmcnt(5)
    v_mfma_f32_16x16x32_bf16 v[36:39], v[68:71], a[0:3], 0
    ds_read_b128 v[68:71], v9 offset:7168
    s_waitcnt lgkmcnt(5)
    v_mfma_f32_16x16x32_bf16 v[40:43], v[72:75], a[0:3], 0
    ds_read_b128 v[72:75], v9 offset:8192
    s_waitcnt lgkmcnt(5)
    v_mfma_f32_16x16x32_bf16 v[44:47], v[76:79], a[0:3], 0
    ds_read_b128 v[76:79], v9 offset:9216
    s_waitcnt lgkmcnt(5)
    v_mfma_f32_16x16x32_bf16 v[48:51], v[80:83], a[0:3], 0
    s_add_u32 s45, s44, 20480
    buffer_load_dwordx4 a[0:3], v2, s[8:11], s45 offen offset:0 sc1
    s_waitcnt vmcnt(19)
    ds_read_b128 v[80:83], v9 offset:10240
    s_waitcnt lgkmcnt(5)
    v_mfma_f32_16x16x32_bf16 v[32:35], v[84:87], a[4:7], v[32:35]
    ds_read_b128 v[84:87], v9 offset:11264
    s_waitcnt lgkmcnt(5)
    v_mfma_f32_16x16x32_bf16 v[36:39], v[64:67], a[4:7], v[36:39]
    ds_read_b128 v[64:67], v9 offset:12288
    s_waitcnt lgkmcnt(5)
    v_mfma_f32_16x16x32_bf16 v[40:43], v[68:71], a[4:7], v[40:43]
    ds_read_b128 v[68:71], v9 offset:13312
    s_waitcnt lgkmcnt(5)
    v_mfma_f32_16x16x32_bf16 v[44:47], v[72:75], a[4:7], v[44:47]
    ds_read_b128 v[72:75], v9 offset:14336
    s_waitcnt lgkmcnt(5)
    v_mfma_f32_16x16x32_bf16 v[48:51], v[76:79], a[4:7], v[48:51]
    s_add_u32 s45, s44, 20480
    buffer_load_dwordx4 a[4:7], v2, s[8:11], s45 offen offset:1024 sc1
    s_waitcnt vmcnt(19)
    ds_read_b128 v[76:79], v9 offset:15360
    s_waitcnt lgkmcnt(5)
    v_mfma_f32_16x16x32_bf16 v[32:35], v[80:83], a[8:11], v[32:35]
    ds_read_b128 v[80:83], v9 offset:16384
    s_waitcnt lgkmcnt(5)
    v_mfma_f32_16x16x32_bf16 v[36:39], v[84:87], a[8:11], v[36:39]
    ds_read_b128 v[84:87], v9 offset:17408
    s_waitcnt lgkmcnt(5)
    v_mfma_f32_16x16x32_bf16 v[40:43], v[64:67], a[8:11], v[40:43]
    ds_read_b128 v[64:67], v9 offset:18432
    s_waitcnt lgkmcnt(5)
    v_mfma_f32_16x16x32_bf16 v[44:47], v[68:71], a[8:11], v[44:47]
    ds_read_b128 v[68:71], v9 offset:19456
    s_waitcnt lgkmcnt(5)
    v_mfma_f32_16x16x32_bf16 v[48:51], v[72:75], a[8:11], v[48:51]
    s_add_u32 s45, s44, 20480
    buffer_load_dwordx4 a[8:11], v2, s[8:11], s45 offen offset:2048 sc1
    s_waitcnt vmcnt(19)
    ds_read_b128 v[72:75], v9 offset:20480
    s_waitcnt lgkmcnt(5)
    v_mfma_f32_16x16x32_bf16 v[32:35], v[76:79], a[12:15], v[32:35]
    ds_read_b128 v[76:79], v9 offset:21504
    s_waitcnt lgkmcnt(5)
    v_mfma_f32_16x16x32_bf16 v[36:39], v[80:83], a[12:15], v[36:39]
    ds_read_b128 v[80:83], v9 offset:22528
    s_waitcnt lgkmcnt(5)
    v_mfma_f32_16x16x32_bf16 v[40:43], v[84:87], a[12:15], v[40:43]
    ds_read_b128 v[84:87], v9 offset:23552
    s_waitcnt lgkmcnt(5)
    v_mfma_f32_16x16x32_bf16 v[44:47], v[64:67], a[12:15], v[44:47]
    ds_read_b128 v[64:67], v9 offset:24576
    s_waitcnt lgkmcnt(5)
    v_mfma_f32_16x16x32_bf16 v[48:51], v[68:71], a[12:15], v[48:51]
    s_add_u32 s45, s44, 20480
    buffer_load_dwordx4 a[12:15], v2, s[8:11], s45 offen offset:3072 sc1
    s_waitcnt vmcnt(19)
    ds_read_b128 v[68:71], v9 offset:25600
    s_waitcnt lgkmcnt(5)
    v_mfma_f32_16x16x32_bf16 v[32:35], v[72:75], a[16:19], v[32:35]
    ds_read_b128 v[72:75], v9 offset:26624
    s_waitcnt lgkmcnt(5)
    v_mfma_f32_16x16x32_bf16 v[36:39], v[76:79], a[16:19], v[36:39]
    ds_read_b128 v[76:79], v9 offset:27648
    s_waitcnt lgkmcnt(5)
    v_mfma_f32_16x16x32_bf16 v[40:43], v[80:83], a[16:19], v[40:43]
    ds_read_b128 v[80:83], v9 offset:28672
    s_waitcnt lgkmcnt(5)
    v_mfma_f32_16x16x32_bf16 v[44:47], v[84:87], a[16:19], v[44:47]
    ds_read_b128 v[84:87], v9 offset:29696
    s_waitcnt lgkmcnt(5)
    v_mfma_f32_16x16x32_bf16 v[48:51], v[64:67], a[16:19], v[48:51]
    s_add_u32 s45, s44, 24576
    buffer_load_dwordx4 a[16:19], v2, s[8:11], s45 offen offset:0 sc1
    s_waitcnt vmcnt(19)
    ds_read_b128 v[64:67], v9 offset:30720
    s_waitcnt lgkmcnt(5)
    v_mfma_f32_16x16x32_bf16 v[32:35], v[68:71], a[20:23], v[32:35]
    ds_read_b128 v[68:71], v9 offset:31744
    s_waitcnt lgkmcnt(5)
    v_mfma_f32_16x16x32_bf16 v[36:39], v[72:75], a[20:23], v[36:39]
    ds_read_b128 v[72:75], v9 offset:32768
    s_waitcnt lgkmcnt(5)
    v_mfma_f32_16x16x32_bf16 v[40:43], v[76:79], a[20:23], v[40:43]
    ds_read_b128 v[76:79], v9 offset:33792
    s_waitcnt lgkmcnt(5)
    v_mfma_f32_16x16x32_bf16 v[44:47], v[80:83], a[20:23], v[44:47]
    ds_read_b128 v[80:83], v9 offset:34816
    s_waitcnt lgkmcnt(5)
    v_mfma_f32_16x16x32_bf16 v[48:51], v[84:87], a[20:23], v[48:51]
    s_add_u32 s45, s44, 24576
    buffer_load_dwordx4 a[20:23], v2, s[8:11], s45 offen offset:1024 sc1
    s_waitcnt vmcnt(19)
    ds_read_b128 v[84:87], v9 offset:35840
    s_waitcnt lgkmcnt(5)
    v_mfma_f32_16x16x32_bf16 v[32:35], v[64:67], a[24:27], v[32:35]
    ds_read_b128 v[64:67], v9 offset:36864
    s_waitcnt lgkmcnt(5)
    v_mfma_f32_16x16x32_bf16 v[36:39], v[68:71], a[24:27], v[36:39]
    ds_read_b128 v[68:71], v9 offset:37888
    s_waitcnt lgkmcnt(5)
    v_mfma_f32_16x16x32_bf16 v[40:43], v[72:75], a[24:27], v[40:43]
    ds_read_b128 v[72:75], v9 offset:38912
    s_waitcnt lgkmcnt(5)
    v_mfma_f32_16x16x32_bf16 v[44:47], v[76:79], a[24:27], v[44:47]
    ds_read_b128 v[76:79], v9 offset:39936
    s_waitcnt lgkmcnt(5)
    v_mfma_f32_16x16x32_bf16 v[48:51], v[80:83], a[24:27], v[48:51]
    s_add_u32 s45, s44, 24576
    buffer_load_dwordx4 a[24:27], v2, s[8:11], s45 offen offset:2048 sc1
    s_waitcnt vmcnt(19)
    s_waitcnt lgkmcnt(4)
    v_mfma_f32_16x16x32_bf16 v[32:35], v[84:87], a[28:31], v[32:35]
    s_waitcnt lgkmcnt(3)
    v_mfma_f32_16x16x32_bf16 v[36:39], v[64:67], a[28:31], v[36:39]
    s_waitcnt lgkmcnt(2)
    v_mfma_f32_16x16x32_bf16 v[40:43], v[68:71], a[28:31], v[40:43]
    s_waitcnt lgkmcnt(1)
    v_mfma_f32_16x16x32_bf16 v[44:47], v[72:75], a[28:31], v[44:47]
    s_waitcnt lgkmcnt(0)
    v_mfma_f32_16x16x32_bf16 v[48:51], v[76:79], a[28:31], v[48:51]
    s_barrier
    s_add_u32 s45, s44, 24576
    buffer_load_dwordx4 a[28:31], v2, s[8:11], s45 offen offset:3072 sc1
    s_waitcnt vmcnt(19)
    ds_read_b128 v[80:83], v9 offset:40960
    ds_read_b128 v[84:87], v9 offset:41984
    ds_read_b128 v[64:67], v9 offset:43008
    ds_read_b128 v[68:71], v9 offset:44032
    ds_read_b128 v[72:75], v9 offset:45056
    ds_read_b128 v[76:79], v9 offset:46080
    s_waitcnt lgkmcnt(5)
    v_mfma_f32_16x16x32_bf16 v[32:35], v[80:83], a[32:35], v[32:35]
    ds_read_b128 v[80:83], v9 offset:47104
    s_waitcnt lgkmcnt(5)
    v_mfma_f32_16x16x32_bf16 v[36:39], v[84:87], a[32:35], v[36:39]
    ds_read_b128 v[84:87], v9 offset:48128
    s_waitcnt lgkmcnt(5)
    v_mfma_f32_16x16x32_bf16 v[40:43], v[64:67], a[32:35], v[40:43]
    ds_read_b128 v[64:67], v9 offset:49152
    s_waitcnt lgkmcnt(5)
    v_mfma_f32_16x16x32_bf16 v[44:47], v[68:71], a[32:35], v[44:47]
    ds_read_b128 v[68:71], v9 offset:50176
    s_waitcnt lgkmcnt(5)
    v_mfma_f32_16x16x32_bf16 v[48:51], v[72:75], a[32:35], v[48:51]
    s_add_u32 s45, s44, 28672
    buffer_load_dwordx4 a[32:35], v2, s[8:11], s45 offen offset:0 sc1
    s_waitcnt vmcnt(19)
    ds_read_b128 v[72:75], v9 offset:51200
    s_waitcnt lgkmcnt(5)
    v_mfma_f32_16x16x32_bf16 v[32:35], v[76:79], a[36:39], v[32:35]
    ds_read_b128 v[76:79], v9 offset:52224
    s_waitcnt lgkmcnt(5)
    v_mfma_f32_16x16x32_bf16 v[36:39], v[80:83], a[36:39], v[36:39]
    ds_read_b128 v[80:83], v9 offset:53248
    s_waitcnt lgkmcnt(5)
    v_mfma_f32_16x16x32_bf16 v[40:43], v[84:87], a[36:39], v[40:43]
    ds_read_b128 v[84:87], v9 offset:54272
    s_waitcnt lgkmcnt(5)
    v_mfma_f32_16x16x32_bf16 v[44:47], v[64:67], a[36:39], v[44:47]
    ds_read_b128 v[64:67], v9 offset:55296
    s_waitcnt lgkmcnt(5)
    v_mfma_f32_16x16x32_bf16 v[48:51], v[68:71], a[36:39], v[48:51]
    s_add_u32 s45, s44, 28672
    buffer_load_dwordx4 a[36:39], v2, s[8:11], s45 offen offset:1024 sc1
    s_waitcnt vmcnt(19)
    ds_read_b128 v[68:71], v9 offset:56320
    s_waitcnt lgkmcnt(5)
    v_mfma_f32_16x16x32_bf16 v[32:35], v[72:75], a[40:43], v[32:35]
    ds_read_b128 v[72:75], v9 offset:57344
    s_waitcnt lgkmcnt(5)
    v_mfma_f32_16x16x32_bf16 v[36:39], v[76:79], a[40:43], v[36:39]
    ds_read_b128 v[76:79], v9 offset:58368
    s_waitcnt lgkmcnt(5)
    v_mfma_f32_16x16x32_bf16 v[40:43], v[80:83], a[40:43], v[40:43]
    ds_read_b128 v[80:83], v9 offset:59392
    s_waitcnt lgkmcnt(5)
    v_mfma_f32_16x16x32_bf16 v[44:47], v[84:87], a[40:43], v[44:47]
    ds_read_b128 v[84:87], v9 offset:60416
    s_waitcnt lgkmcnt(5)
    v_mfma_f32_16x16x32_bf16 v[48:51], v[64:67], a[40:43], v[48:51]
    s_add_u32 s45, s44, 28672
    buffer_load_dwordx4 a[40:43], v2, s[8:11], s45 offen offset:2048 sc1
    s_waitcnt vmcnt(19)
    ds_read_b128 v[64:67], v10 offset:0
    s_waitcnt lgkmcnt(5)
    v_mfma_f32_16x16x32_bf16 v[32:35], v[68:71], a[44:47], v[32:35]
    ds_read_b128 v[68:71], v10 offset:1024
    s_waitcnt lgkmcnt(5)
    v_mfma_f32_16x16x32_bf16 v[36:39], v[72:75], a[44:47], v[36:39]
    ds_read_b128 v[72:75], v10 offset:2048
    s_waitcnt lgkmcnt(5)
    v_mfma_f32_16x16x32_bf16 v[40:43], v[76:79], a[44:47], v[40:43]
    ds_read_b128 v[76:79], v10 offset:3072
    s_waitcnt lgkmcnt(5)
    v_mfma_f32_16x16x32_bf16 v[44:47], v[80:83], a[44:47], v[44:47]
    ds_read_b128 v[80:83], v10 offset:4096
    s_waitcnt lgkmcnt(5)
    v_mfma_f32_16x16x32_bf16 v[48:51], v[84:87], a[44:47], v[48:51]
    s_add_u32 s45, s44, 28672
    buffer_load_dwordx4 a[44:47], v2, s[8:11], s45 offen offset:3072 sc1
    s_waitcnt vmcnt(19)
    ds_read_b128 v[84:87], v10 offset:5120
    s_waitcnt lgkmcnt(5)
    v_mfma_f32_16x16x32_bf16 v[32:35], v[64:67], a[48:51], v[32:35]
    ds_read_b128 v[64:67], v10 offset:6144
    s_waitcnt lgkmcnt(5)
    v_mfma_f32_16x16x32_bf16 v[36:39], v[68:71], a[48:51], v[36:39]
    ds_read_b128 v[68:71], v10 offset:7168
    s_waitcnt lgkmcnt(5)
    v_mfma_f32_16x16x32_bf16 v[40:43], v[72:75], a[48:51], v[40:43]
    ds_read_b128 v[72:75], v10 offset:8192
    s_waitcnt lgkmcnt(5)
    v_mfma_f32_16x16x32_bf16 v[44:47], v[76:79], a[48:51], v[44:47]
    ds_read_b128 v[76:79], v10 offset:9216
    s_waitcnt lgkmcnt(5)
    v_mfma_f32_16x16x32_bf16 v[48:51], v[80:83], a[48:51], v[48:51]
    s_waitcnt vmcnt(18)
    ds_read_b128 v[80:83], v10 offset:10240
    s_waitcnt lgkmcnt(5)
    v_mfma_f32_16x16x32_bf16 v[32:35], v[84:87], a[52:55], v[32:35]
    ds_read_b128 v[84:87], v10 offset:11264
    s_waitcnt lgkmcnt(5)
    v_mfma_f32_16x16x32_bf16 v[36:39], v[64:67], a[52:55], v[36:39]
    ds_read_b128 v[64:67], v10 offset:12288
    s_waitcnt lgkmcnt(5)
    v_mfma_f32_16x16x32_bf16 v[40:43], v[68:71], a[52:55], v[40:43]
    ds_read_b128 v[68:71], v10 offset:13312
    s_waitcnt lgkmcnt(5)
    v_mfma_f32_16x16x32_bf16 v[44:47], v[72:75], a[52:55], v[44:47]
    ds_read_b128 v[72:75], v10 offset:14336
    s_waitcnt lgkmcnt(5)
    v_mfma_f32_16x16x32_bf16 v[48:51], v[76:79], a[52:55], v[48:51]
    s_waitcnt vmcnt(17)
    ds_read_b128 v[76:79], v10 offset:15360
    s_waitcnt lgkmcnt(5)
    v_mfma_f32_16x16x32_bf16 v[32:35], v[80:83], a[56:59], v[32:35]
    ds_read_b128 v[80:83], v10 offset:16384
    s_waitcnt lgkmcnt(5)
    v_mfma_f32_16x16x32_bf16 v[36:39], v[84:87], a[56:59], v[36:39]
    ds_read_b128 v[84:87], v10 offset:17408
    s_waitcnt lgkmcnt(5)
    v_mfma_f32_16x16x32_bf16 v[40:43], v[64:67], a[56:59], v[40:43]
    ds_read_b128 v[64:67], v10 offset:18432
    s_waitcnt lgkmcnt(5)
    v_mfma_f32_16x16x32_bf16 v[44:47], v[68:71], a[56:59], v[44:47]
    ds_read_b128 v[68:71], v10 offset:19456
    s_waitcnt lgkmcnt(5)
    v_mfma_f32_16x16x32_bf16 v[48:51], v[72:75], a[56:59], v[48:51]
    s_waitcnt vmcnt(16)
    ds_read_b128 v[72:75], v10 offset:20480
    s_waitcnt lgkmcnt(5)
    v_mfma_f32_16x16x32_bf16 v[32:35], v[76:79], a[60:63], v[32:35]
    ds_read_b128 v[76:79], v10 offset:21504
    s_waitcnt lgkmcnt(5)
    v_mfma_f32_16x16x32_bf16 v[36:39], v[80:83], a[60:63], v[36:39]
    ds_read_b128 v[80:83], v10 offset:22528
    s_waitcnt lgkmcnt(5)
    v_mfma_f32_16x16x32_bf16 v[40:43], v[84:87], a[60:63], v[40:43]
    ds_read_b128 v[84:87], v10 offset:23552
    s_waitcnt lgkmcnt(5)
    v_mfma_f32_16x16x32_bf16 v[44:47], v[64:67], a[60:63], v[44:47]
    ds_read_b128 v[64:67], v10 offset:24576
    s_waitcnt lgkmcnt(5)
    v_mfma_f32_16x16x32_bf16 v[48:51], v[68:71], a[60:63], v[48:51]
    s_waitcnt vmcnt(15)
    ds_read_b128 v[68:71], v10 offset:25600
    s_waitcnt lgkmcnt(5)
    v_mfma_f32_16x16x32_bf16 v[32:35], v[72:75], a[64:67], v[32:35]
    ds_read_b128 v[72:75], v10 offset:26624
    s_waitcnt lgkmcnt(5)
    v_mfma_f32_16x16x32_bf16 v[36:39], v[76:79], a[64:67], v[36:39]
    ds_read_b128 v[76:79], v10 offset:27648
    s_waitcnt lgkmcnt(5)
    v_mfma_f32_16x16x32_bf16 v[40:43], v[80:83], a[64:67], v[40:43]
    ds_read_b128 v[80:83], v10 offset:28672
    s_waitcnt lgkmcnt(5)
    v_mfma_f32_16x16x32_bf16 v[44:47], v[84:87], a[64:67], v[44:47]
    ds_read_b128 v[84:87], v10 offset:29696
    s_waitcnt lgkmcnt(5)
    v_mfma_f32_16x16x32_bf16 v[48:51], v[64:67], a[64:67], v[48:51]
    s_waitcnt vmcnt(14)
    ds_read_b128 v[64:67], v10 offset:30720
    s_waitcnt lgkmcnt(5)
    v_mfma_f32_16x16x32_bf16 v[32:35], v[68:71], a[68:71], v[32:35]
    ds_read_b128 v[68:71], v10 offset:31744
    s_waitcnt lgkmcnt(5)
    v_mfma_f32_16x16x32_bf16 v[36:39], v[72:75], a[68:71], v[36:39]
    ds_read_b128 v[72:75], v10 offset:32768
    s_waitcnt lgkmcnt(5)
    v_mfma_f32_16x16x32_bf16 v[40:43], v[76:79], a[68:71], v[40:43]
    ds_read_b128 v[76:79], v10 offset:33792
    s_waitcnt lgkmcnt(5)
    v_mfma_f32_16x16x32_bf16 v[44:47], v[80:83], a[68:71], v[44:47]
    ds_read_b128 v[80:83], v10 offset:34816
    s_waitcnt lgkmcnt(5)
    v_mfma_f32_16x16x32_bf16 v[48:51], v[84:87], a[68:71], v[48:51]
    s_waitcnt vmcnt(13)
    ds_read_b128 v[84:87], v10 offset:35840
    s_waitcnt lgkmcnt(5)
    v_mfma_f32_16x16x32_bf16 v[32:35], v[64:67], a[72:75], v[32:35]
    ds_read_b128 v[64:67], v10 offset:36864
    s_waitcnt lgkmcnt(5)
    v_mfma_f32_16x16x32_bf16 v[36:39], v[68:71], a[72:75], v[36:39]
    ds_read_b128 v[68:71], v10 offset:37888
    s_waitcnt lgkmcnt(5)
    v_mfma_f32_16x16x32_bf16 v[40:43], v[72:75], a[72:75], v[40:43]
    ds_read_b128 v[72:75], v10 offset:38912
    s_waitcnt lgkmcnt(5)
    v_mfma_f32_16x16x32_bf16 v[44:47], v[76:79], a[72:75], v[44:47]
    ds_read_b128 v[76:79], v10 offset:39936
    s_waitcnt lgkmcnt(5)
    v_mfma_f32_16x16x32_bf16 v[48:51], v[80:83], a[72:75], v[48:51]
    s_waitcnt vmcnt(12)
    s_waitcnt lgkmcnt(4)
    v_mfma_f32_16x16x32_bf16 v[32:35], v[84:87], a[76:79], v[32:35]
    s_waitcnt lgkmcnt(3)
    v_mfma_f32_16x16x32_bf16 v[36:39], v[64:67], a[76:79], v[36:39]
    s_waitcnt lgkmcnt(2)
    v_mfma_f32_16x16x32_bf16 v[40:43], v[68:71], a[76:79], v[40:43]
    s_waitcnt lgkmcnt(1)
    v_mfma_f32_16x16x32_bf16 v[44:47], v[72:75], a[76:79], v[44:47]
    s_waitcnt lgkmcnt(0)
    v_mfma_f32_16x16x32_bf16 v[48:51], v[76:79], a[76:79], v[48:51]
    s_barrier
    buffer_load_dword v28, v26, s[8:11], 0 offen sc1
    s_waitcnt vmcnt(12)
    ds_read_b128 v[80:83], v10 offset:40960
    ds_read_b128 v[84:87], v10 offset:41984
    ds_read_b128 v[64:67], v10 offset:43008
    ds_read_b128 v[68:71], v10 offset:44032
    ds_read_b128 v[72:75], v10 offset:45056
    ds_read_b128 v[76:79], v10 offset:46080
    s_waitcnt lgkmcnt(5)
    v_mfma_f32_16x16x32_bf16 v[32:35], v[80:83], a[0:3], v[32:35]
    ds_read_b128 v[80:83], v10 offset:47104
    s_waitcnt lgkmcnt(5)
    v_mfma_f32_16x16x32_bf16 v[36:39], v[84:87], a[0:3], v[36:39]
    ds_read_b128 v[84:87], v10 offset:48128
    s_waitcnt lgkmcnt(5)
    v_mfma_f32_16x16x32_bf16 v[40:43], v[64:67], a[0:3], v[40:43]
    ds_read_b128 v[64:67], v10 offset:49152
    s_waitcnt lgkmcnt(5)
    v_mfma_f32_16x16x32_bf16 v[44:47], v[68:71], a[0:3], v[44:47]
    ds_read_b128 v[68:71], v10 offset:50176
    s_waitcnt lgkmcnt(5)
    v_mfma_f32_16x16x32_bf16 v[48:51], v[72:75], a[0:3], v[48:51]
    s_waitcnt vmcnt(11)
    ds_read_b128 v[72:75], v10 offset:51200
    s_waitcnt lgkmcnt(5)
    v_mfma_f32_16x16x32_bf16 v[32:35], v[76:79], a[4:7], v[32:35]
    ds_read_b128 v[76:79], v10 offset:52224
    s_waitcnt lgkmcnt(5)
    v_mfma_f32_16x16x32_bf16 v[36:39], v[80:83], a[4:7], v[36:39]
    ds_read_b128 v[80:83], v10 offset:53248
    s_waitcnt lgkmcnt(5)
    v_mfma_f32_16x16x32_bf16 v[40:43], v[84:87], a[4:7], v[40:43]
    ds_read_b128 v[84:87], v10 offset:54272
    s_waitcnt lgkmcnt(5)
    v_mfma_f32_16x16x32_bf16 v[44:47], v[64:67], a[4:7], v[44:47]
    ds_read_b128 v[64:67], v10 offset:55296
    s_waitcnt lgkmcnt(5)
    v_mfma_f32_16x16x32_bf16 v[48:51], v[68:71], a[4:7], v[48:51]
    s_waitcnt vmcnt(10)
    ds_read_b128 v[68:71], v10 offset:56320
    s_waitcnt lgkmcnt(5)
    v_mfma_f32_16x16x32_bf16 v[32:35], v[72:75], a[8:11], v[32:35]
    ds_read_b128 v[72:75], v10 offset:57344
    s_waitcnt lgkmcnt(5)
    v_mfma_f32_16x16x32_bf16 v[36:39], v[76:79], a[8:11], v[36:39]
    ds_read_b128 v[76:79], v10 offset:58368
    s_waitcnt lgkmcnt(5)
    v_mfma_f32_16x16x32_bf16 v[40:43], v[80:83], a[8:11], v[40:43]
    ds_read_b128 v[80:83], v10 offset:59392
    s_waitcnt lgkmcnt(5)
    v_mfma_f32_16x16x32_bf16 v[44:47], v[84:87], a[8:11], v[44:47]
    ds_read_b128 v[84:87], v10 offset:60416
    s_waitcnt lgkmcnt(5)
    v_mfma_f32_16x16x32_bf16 v[48:51], v[64:67], a[8:11], v[48:51]
    s_waitcnt vmcnt(9)
    ds_read_b128 v[64:67], v11 offset:0
    s_waitcnt lgkmcnt(5)
    v_mfma_f32_16x16x32_bf16 v[32:35], v[68:71], a[12:15], v[32:35]
    ds_read_b128 v[68:71], v11 offset:1024
    s_waitcnt lgkmcnt(5)
    v_mfma_f32_16x16x32_bf16 v[36:39], v[72:75], a[12:15], v[36:39]
    ds_read_b128 v[72:75], v11 offset:2048
    s_waitcnt lgkmcnt(5)
    v_mfma_f32_16x16x32_bf16 v[40:43], v[76:79], a[12:15], v[40:43]
    ds_read_b128 v[76:79], v11 offset:3072
    s_waitcnt lgkmcnt(5)
    v_mfma_f32_16x16x32_bf16 v[44:47], v[80:83], a[12:15], v[44:47]
    ds_read_b128 v[80:83], v11 offset:4096
    s_waitcnt lgkmcnt(5)
    v_mfma_f32_16x16x32_bf16 v[48:51], v[84:87], a[12:15], v[48:51]
    s_waitcnt vmcnt(8)
    ds_read_b128 v[84:87], v11 offset:5120
    s_waitcnt lgkmcnt(5)
    v_mfma_f32_16x16x32_bf16 v[32:35], v[64:67], a[16:19], v[32:35]
    ds_read_b128 v[64:67], v11 offset:6144
    s_waitcnt lgkmcnt(5)
    v_mfma_f32_16x16x32_bf16 v[36:39], v[68:71], a[16:19], v[36:39]
    ds_read_b128 v[68:71], v11 offset:7168
    s_waitcnt lgkmcnt(5)
    v_mfma_f32_16x16x32_bf16 v[40:43], v[72:75], a[16:19], v[40:43]
    ds_read_b128 v[72:75], v11 offset:8192
    s_waitcnt lgkmcnt(5)
    v_mfma_f32_16x16x32_bf16 v[44:47], v[76:79], a[16:19], v[44:47]
    ds_read_b128 v[76:79], v11 offset:9216
    s_waitcnt lgkmcnt(5)
    v_mfma_f32_16x16x32_bf16 v[48:51], v[80:83], a[16:19], v[48:51]
    s_waitcnt vmcnt(7)
    ds_read_b128 v[80:83], v11 offset:10240
    s_waitcnt lgkmcnt(5)
    v_mfma_f32_16x16x32_bf16 v[32:35], v[84:87], a[20:23], v[32:35]
    ds_read_b128 v[84:87], v11 offset:11264
    s_waitcnt lgkmcnt(5)
    v_mfma_f32_16x16x32_bf16 v[36:39], v[64:67], a[20:23], v[36:39]
    ds_read_b128 v[64:67], v11 offset:12288
    s_waitcnt lgkmcnt(5)
    v_mfma_f32_16x16x32_bf16 v[40:43], v[68:71], a[20:23], v[40:43]
    ds_read_b128 v[68:71], v11 offset:13312
    s_waitcnt lgkmcnt(5)
    v_mfma_f32_16x16x32_bf16 v[44:47], v[72:75], a[20:23], v[44:47]
    ds_read_b128 v[72:75], v11 offset:14336
    s_waitcnt lgkmcnt(5)
    v_mfma_f32_16x16x32_bf16 v[48:51], v[76:79], a[20:23], v[48:51]
    s_waitcnt vmcnt(0)
    v_cmp_ne_u32 vcc, s60, v28
    s_nop 1
    s_cbranch_vccz sequential_preLN__sliding_local_dilated__glu_gated_bilinear__prompt_kernel_p4ok32
    s_mov_b32 s51, 0
sequential_preLN__sliding_local_dilated__glu_gated_bilinear__prompt_kernel_poll33:
    buffer_load_dword v3, v26, s[8:11], 0 offen sc1
    s_add_u32 s51, s51, 1
    s_cmp_gt_u32 s51, 200000
    s_cbranch_scc1 sequential_preLN__sliding_local_dilated__glu_gated_bilinear__prompt_kernel_pollx34
    s_waitcnt vmcnt(0)
    v_cmp_ne_u32 vcc, s60, v3
    s_nop 1
    s_cbranch_vccz sequential_preLN__sliding_local_dilated__glu_gated_bilinear__prompt_kernel_pollx34
    s_sleep 2
    s_branch sequential_preLN__sliding_local_dilated__glu_gated_bilinear__prompt_kernel_poll33
sequential_preLN__sliding_local_dilated__glu_gated_bilinear__prompt_kernel_pollx34:
    s_waitcnt vmcnt(0)
sequential_preLN__sliding_local_dilated__glu_gated_bilinear__prompt_kernel_p4ok32:
    s_add_u32 s45, s44, 32768
    buffer_load_dwordx4 a[48:51], v2, s[8:11], s45 offen offset:0 sc1
    s_add_u32 s45, s44, 32768
    buffer_load_dwordx4 a[52:55], v2, s[8:11], s45 offen offset:1024 sc1
    s_add_u32 s45, s44, 32768
    buffer_load_dwordx4 a[56:59], v2, s[8:11], s45 offen offset:2048 sc1
    s_add_u32 s45, s44, 32768
    buffer_load_dwordx4 a[60:63], v2, s[8:11], s45 offen offset:3072 sc1
    s_add_u32 s45, s44, 36864
    buffer_load_dwordx4 a[64:67], v2, s[8:11], s45 offen offset:0 sc1
    s_add_u32 s45, s44, 36864
    buffer_load_dwordx4 a[68:71], v2, s[8:11], s45 offen offset:1024 sc1
    s_add_u32 s45, s44, 36864
    buffer_load_dwordx4 a[72:75], v2, s[8:11], s45 offen offset:2048 sc1
    s_add_u32 s45, s44, 36864
    buffer_load_dwordx4 a[76:79], v2, s[8:11], s45 offen offset:3072 sc1
    s_add_u32 s45, s44, 40960
    buffer_load_dwordx4 a[0:3], v2, s[8:11], s45 offen offset:0 sc1
    s_add_u32 s45, s44, 40960
    buffer_load_dwordx4 a[4:7], v2, s[8:11], s45 offen offset:1024 sc1
    s_add_u32 s45, s44, 40960
    buffer_load_dwordx4 a[8:11], v2, s[8:11], s45 offen offset:2048 sc1
    s_add_u32 s45, s44, 40960
    buffer_load_dwordx4 a[12:15], v2, s[8:11], s45 offen offset:3072 sc1
    s_add_u32 s45, s44, 45056
    buffer_load_dwordx4 a[16:19], v2, s[8:11], s45 offen offset:0 sc1
    s_add_u32 s45, s44, 45056
    buffer_load_dwordx4 a[20:23], v2, s[8:11], s45 offen offset:1024 sc1
    ds_read_b128 v[76:79], v11 offset:15360
    s_waitcnt lgkmcnt(5)
    v_mfma_f32_16x16x32_bf16 v[32:35], v[80:83], a[24:27], v[32:35]
    ds_read_b128 v[80:83], v11 offset:16384
    s_waitcnt lgkmcnt(5)
    v_mfma_f32_16x16x32_bf16 v[36:39], v[84:87], a[24:27], v[36:39]
    ds_read_b128 v[84:87], v11 offset:17408
    s_waitcnt lgkmcnt(5)
    v_mfma_f32_16x16x32_bf16 v[40:43], v[64:67], a[24:27], v[40:43]
    ds_read_b128 v[64:67], v11 offset:18432
    s_waitcnt lgkmcnt(5)
    v_mfma_f32_16x16x32_bf16 v[44:47], v[68:71], a[24:27], v[44:47]
    ds_read_b128 v[68:71], v11 offset:19456
    s_waitcnt lgkmcnt(5)
    v_mfma_f32_16x16x32_bf16 v[48:51], v[72:75], a[24:27], v[48:51]
    ds_read_b128 v[72:75], v9 offset:0
    s_waitcnt lgkmcnt(5)
    v_mfma_f32_16x16x32_bf16 v[32:35], v[76:79], a[28:31], v[32:35]
    ds_read_b128 v[76:79], v9 offset:1024
    s_waitcnt lgkmcnt(5)
    v_mfma_f32_16x16x32_bf16 v[36:39], v[80:83], a[28:31], v[36:39]
    ds_read_b128 v[80:83], v9 offset:2048
    s_waitcnt lgkmcnt(5)
    v_mfma_f32_16x16x32_bf16 v[40:43], v[84:87], a[28:31], v[40:43]
    ds_read_b128 v[84:87], v9 offset:3072
    s_waitcnt lgkmcnt(5)
    v_mfma_f32_16x16x32_bf16 v[44:47], v[64:67], a[28:31], v[44:47]
    ds_read_b128 v[64:67], v9 offset:4096
    s_waitcnt lgkmcnt(5)
    v_mfma_f32_16x16x32_bf16 v[48:51], v[68:71], a[28:31], v[48:51]
    ds_read_b128 v[68:71], v9 offset:5120
    s_waitcnt lgkmcnt(5)
    v_mfma_f32_16x16x32_bf16 v[32:35], v[72:75], a[32:35], v[32:35]
    ds_read_b128 v[72:75], v9 offset:6144
    s_waitcnt lgkmcnt(5)
    v_mfma_f32_16x16x32_bf16 v[36:39], v[76:79], a[32:35], v[36:39]
    ds_read_b128 v[76:79], v9 offset:7168
    s_waitcnt lgkmcnt(5)
    v_mfma_f32_16x16x32_bf16 v[40:43], v[80:83], a[32:35], v[40:43]
    ds_read_b128 v[80:83], v9 offset:8192
    s_waitcnt lgkmcnt(5)
    v_mfma_f32_16x16x32_bf16 v[44:47], v[84:87], a[32:35], v[44:47]
    ds_read_b128 v[84:87], v9 offset:9216
    s_waitcnt lgkmcnt(5)
    v_mfma_f32_16x16x32_bf16 v[48:51], v[64:67], a[32:35], v[48:51]
    ds_read_b128 v[64:67], v9 offset:10240
    s_waitcnt lgkmcnt(5)
    v_mfma_f32_16x16x32_bf16 v[32:35], v[68:71], a[36:39], v[32:35]
    ds_read_b128 v[68:71], v9 offset:11264
    s_waitcnt lgkmcnt(5)
    v_mfma_f32_16x16x32_bf16 v[36:39], v[72:75], a[36:39], v[36:39]
    ds_read_b128 v[72:75], v9 offset:12288
    s_waitcnt lgkmcnt(5)
    v_mfma_f32_16x16x32_bf16 v[40:43], v[76:79], a[36:39], v[40:43]
    ds_read_b128 v[76:79], v9 offset:13312
    s_waitcnt lgkmcnt(5)
    v_mfma_f32_16x16x32_bf16 v[44:47], v[80:83], a[36:39], v[44:47]
    ds_read_b128 v[80:83], v9 offset:14336
    s_waitcnt lgkmcnt(5)
    v_mfma_f32_16x16x32_bf16 v[48:51], v[84:87], a[36:39], v[48:51]
    ds_read_b128 v[84:87], v9 offset:15360
    s_waitcnt lgkmcnt(5)
    v_mfma_f32_16x16x32_bf16 v[32:35], v[64:67], a[40:43], v[32:35]
    ds_read_b128 v[64:67], v9 offset:16384
    s_waitcnt lgkmcnt(5)
    v_mfma_f32_16x16x32_bf16 v[36:39], v[68:71], a[40:43], v[36:39]
    ds_read_b128 v[68:71], v9 offset:17408
    s_waitcnt lgkmcnt(5)
    v_mfma_f32_16x16x32_bf16 v[40:43], v[72:75], a[40:43], v[40:43]
    ds_read_b128 v[72:75], v9 offset:18432
    s_waitcnt lgkmcnt(5)
    v_mfma_f32_16x16x32_bf16 v[44:47], v[76:79], a[40:43], v[44:47]
    ds_read_b128 v[76:79], v9 offset:19456
    s_waitcnt lgkmcnt(5)
    v_mfma_f32_16x16x32_bf16 v[48:51], v[80:83], a[40:43], v[48:51]
    s_waitcnt lgkmcnt(4)
    v_mfma_f32_16x16x32_bf16 v[32:35], v[84:87], a[44:47], v[32:35]
    s_waitcnt lgkmcnt(3)
    v_mfma_f32_16x16x32_bf16 v[36:39], v[64:67], a[44:47], v[36:39]
    s_waitcnt lgkmcnt(2)
    v_mfma_f32_16x16x32_bf16 v[40:43], v[68:71], a[44:47], v[40:43]
    s_waitcnt lgkmcnt(1)
    v_mfma_f32_16x16x32_bf16 v[44:47], v[72:75], a[44:47], v[44:47]
    s_waitcnt lgkmcnt(0)
    v_mfma_f32_16x16x32_bf16 v[48:51], v[76:79], a[44:47], v[48:51]
    s_barrier
    s_waitcnt vmcnt(13)
    ds_read_b128 v[80:83], v9 offset:20480
    ds_read_b128 v[84:87], v9 offset:21504
    ds_read_b128 v[64:67], v9 offset:22528
    ds_read_b128 v[68:71], v9 offset:23552
    ds_read_b128 v[72:75], v9 offset:24576
    ds_read_b128 v[76:79], v9 offset:25600
    s_waitcnt lgkmcnt(5)
    v_mfma_f32_16x16x32_bf16 v[32:35], v[80:83], a[48:51], v[32:35]
    ds_read_b128 v[80:83], v9 offset:26624
    s_waitcnt lgkmcnt(5)
    v_mfma_f32_16x16x32_bf16 v[36:39], v[84:87], a[48:51], v[36:39]
    ds_read_b128 v[84:87], v9 offset:27648
    s_waitcnt lgkmcnt(5)
    v_mfma_f32_16x16x32_bf16 v[40:43], v[64:67], a[48:51], v[40:43]
    ds_read_b128 v[64:67], v9 offset:28672
    s_waitcnt lgkmcnt(5)
    v_mfma_f32_16x16x32_bf16 v[44:47], v[68:71], a[48:51], v[44:47]
    ds_read_b128 v[68:71], v9 offset:29696
    s_waitcnt lgkmcnt(5)
    v_mfma_f32_16x16x32_bf16 v[48:51], v[72:75], a[48:51], v[48:51]
    s_waitcnt vmcnt(12)
    ds_read_b128 v[72:75], v9 offset:30720
    s_waitcnt lgkmcnt(5)
    v_mfma_f32_16x16x32_bf16 v[32:35], v[76:79], a[52:55], v[32:35]
    ds_read_b128 v[76:79], v9 offset:31744
    s_waitcnt lgkmcnt(5)
    v_mfma_f32_16x16x32_bf16 v[36:39], v[80:83], a[52:55], v[36:39]
    ds_read_b128 v[80:83], v9 offset:32768
    s_waitcnt lgkmcnt(5)
    v_mfma_f32_16x16x32_bf16 v[40:43], v[84:87], a[52:55], v[40:43]
    ds_read_b128 v[84:87], v9 offset:33792
    s_waitcnt lgkmcnt(5)
    v_mfma_f32_16x16x32_bf16 v[44:47], v[64:67], a[52:55], v[44:47]
    ds_read_b128 v[64:67], v9 offset:34816
    s_waitcnt lgkmcnt(5)
    v_mfma_f32_16x16x32_bf16 v[48:51], v[68:71], a[52:55], v[48:51]
    buffer_load_dword v28, v27, s[8:11], 0 offen sc1
    s_waitcnt vmcnt(12)
    ds_read_b128 v[68:71], v9 offset:35840
    s_waitcnt lgkmcnt(5)
    v_mfma_f32_16x16x32_bf16 v[32:35], v[72:75], a[56:59], v[32:35]
    ds_read_b128 v[72:75], v9 offset:36864
    s_waitcnt lgkmcnt(5)
    v_mfma_f32_16x16x32_bf16 v[36:39], v[76:79], a[56:59], v[36:39]
    ds_read_b128 v[76:79], v9 offset:37888
    s_waitcnt lgkmcnt(5)
    v_mfma_f32_16x16x32_bf16 v[40:43], v[80:83], a[56:59], v[40:43]
    ds_read_b128 v[80:83], v9 offset:38912
    s_waitcnt lgkmcnt(5)
    v_mfma_f32_16x16x32_bf16 v[44:47], v[84:87], a[56:59], v[44:47]
    ds_read_b128 v[84:87], v9 offset:39936
    s_waitcnt lgkmcnt(5)
    v_mfma_f32_16x16x32_bf16 v[48:51], v[64:67], a[56:59], v[48:51]
    s_waitcnt vmcnt(11)
    ds_read_b128 v[64:67], v9 offset:40960
    s_waitcnt lgkmcnt(5)
    v_mfma_f32_16x16x32_bf16 v[32:35], v[68:71], a[60:63], v[32:35]
    ds_read_b128 v[68:71], v9 offset:41984
    s_waitcnt lgkmcnt(5)
    v_mfma_f32_16x16x32_bf16 v[36:39], v[72:75], a[60:63], v[36:39]
    ds_read_b128 v[72:75], v9 offset:43008
    s_waitcnt lgkmcnt(5)
    v_mfma_f32_16x16x32_bf16 v[40:43], v[76:79], a[60:63], v[40:43]
    ds_read_b128 v[76:79], v9 offset:44032
    s_waitcnt lgkmcnt(5)
    v_mfma_f32_16x16x32_bf16 v[44:47], v[80:83], a[60:63], v[44:47]
    ds_read_b128 v[80:83], v9 offset:45056
    s_waitcnt lgkmcnt(5)
    v_mfma_f32_16x16x32_bf16 v[48:51], v[84:87], a[60:63], v[48:51]
    s_waitcnt vmcnt(10)
    ds_read_b128 v[84:87], v9 offset:46080
    s_waitcnt lgkmcnt(5)
    v_mfma_f32_16x16x32_bf16 v[32:35], v[64:67], a[64:67], v[32:35]
    ds_read_b128 v[64:67], v9 offset:47104
    s_waitcnt lgkmcnt(5)
    v_mfma_f32_16x16x32_bf16 v[36:39], v[68:71], a[64:67], v[36:39]
    ds_read_b128 v[68:71], v9 offset:48128
    s_waitcnt lgkmcnt(5)
    v_mfma_f32_16x16x32_bf16 v[40:43], v[72:75], a[64:67], v[40:43]
    ds_read_b128 v[72:75], v9 offset:49152
    s_waitcnt lgkmcnt(5)
    v_mfma_f32_16x16x32_bf16 v[44:47], v[76:79], a[64:67], v[44:47]
    ds_read_b128 v[76:79], v9 offset:50176
    s_waitcnt lgkmcnt(5)
    v_mfma_f32_16x16x32_bf16 v[48:51], v[80:83], a[64:67], v[48:51]
    s_waitcnt vmcnt(9)
    ds_read_b128 v[80:83], v9 offset:51200
    s_waitcnt lgkmcnt(5)
    v_mfma_f32_16x16x32_bf16 v[32:35], v[84:87], a[68:71], v[32:35]
    ds_read_b128 v[84:87], v9 offset:52224
    s_waitcnt lgkmcnt(5)
    v_mfma_f32_16x16x32_bf16 v[36:39], v[64:67], a[68:71], v[36:39]
    ds_read_b128 v[64:67], v9 offset:53248
    s_waitcnt lgkmcnt(5)
    v_mfma_f32_16x16x32_bf16 v[40:43], v[68:71], a[68:71], v[40:43]
    ds_read_b128 v[68:71], v9 offset:54272
    s_waitcnt lgkmcnt(5)
    v_mfma_f32_16x16x32_bf16 v[44:47], v[72:75], a[68:71], v[44:47]
    ds_read_b128 v[72:75], v9 offset:55296
    s_waitcnt lgkmcnt(5)
    v_mfma_f32_16x16x32_bf16 v[48:51], v[76:79], a[68:71], v[48:51]
    s_waitcnt vmcnt(8)
    ds_read_b128 v[76:79], v9 offset:56320
    s_waitcnt lgkmcnt(5)
    v_mfma_f32_16x16x32_bf16 v[32:35], v[80:83], a[72:75], v[32:35]
    ds_read_b128 v[80:83], v9 offset:57344
    s_waitcnt lgkmcnt(5)
    v_mfma_f32_16x16x32_bf16 v[36:39], v[84:87], a[72:75], v[36:39]
    ds_read_b128 v[84:87], v9 offset:58368
    s_waitcnt lgkmcnt(5)
    v_mfma_f32_16x16x32_bf16 v[40:43], v[64:67], a[72:75], v[40:43]
    ds_read_b128 v[64:67], v9 offset:59392
    s_waitcnt lgkmcnt(5)
    v_mfma_f32_16x16x32_bf16 v[44:47], v[68:71], a[72:75], v[44:47]
    ds_read_b128 v[68:71], v9 offset:60416
    s_waitcnt lgkmcnt(5)
    v_mfma_f32_16x16x32_bf16 v[48:51], v[72:75], a[72:75], v[48:51]
    s_waitcnt vmcnt(7)
    ds_read_b128 v[72:75], v10 offset:0
    s_waitcnt lgkmcnt(5)
    v_mfma_f32_16x16x32_bf16 v[32:35], v[76:79], a[76:79], v[32:35]
    ds_read_b128 v[76:79], v10 offset:1024
    s_waitcnt lgkmcnt(5)
    v_mfma_f32_16x16x32_bf16 v[36:39], v[80:83], a[76:79], v[36:39]
    ds_read_b128 v[80:83], v10 offset:2048
    s_waitcnt lgkmcnt(5)
    v_mfma_f32_16x16x32_bf16 v[40:43], v[84:87], a[76:79], v[40:43]
    ds_read_b128 v[84:87], v10 offset:3072
    s_waitcnt lgkmcnt(5)
    v_mfma_f32_16x16x32_bf16 v[44:47], v[64:67], a[76:79], v[44:47]
    ds_read_b128 v[64:67], v10 offset:4096
    s_waitcnt lgkmcnt(5)
    v_mfma_f32_16x16x32_bf16 v[48:51], v[68:71], a[76:79], v[48:51]
    s_waitcnt vmcnt(0)
    v_cmp_ne_u32 vcc, s60, v28
    s_nop 1
    s_cbranch_vccz sequential_preLN__sliding_local_dilated__glu_gated_bilinear__prompt_kernel_p4ok35
    s_mov_b32 s51, 0
sequential_preLN__sliding_local_dilated__glu_gated_bilinear__prompt_kernel_poll36:
    buffer_load_dword v3, v27, s[8:11], 0 offen sc1
    s_add_u32 s51, s51, 1
    s_cmp_gt_u32 s51, 200000
    s_cbranch_scc1 sequential_preLN__sliding_local_dilated__glu_gated_bilinear__prompt_kernel_pollx37
    s_waitcnt vmcnt(0)
    v_cmp_ne_u32 vcc, s60, v3
    s_nop 1
    s_cbranch_vccz sequential_preLN__sliding_local_dilated__glu_gated_bilinear__prompt_kernel_pollx37
    s_sleep 2
    s_branch sequential_preLN__sliding_local_dilated__glu_gated_bilinear__prompt_kernel_poll36
sequential_preLN__sliding_local_dilated__glu_gated_bilinear__prompt_kernel_pollx37:
    s_waitcnt vmcnt(0)
sequential_preLN__sliding_local_dilated__glu_gated_bilinear__prompt_kernel_p4ok35:
    s_add_u32 s45, s44, 45056
    buffer_load_dwordx4 a[24:27], v2, s[8:11], s45 offen offset:2048 sc1
    s_add_u32 s45, s44, 45056
    buffer_load_dwordx4 a[28:31], v2, s[8:11], s45 offen offset:3072 sc1
    s_add_u32 s45, s44, 49152
    buffer_load_dwordx4 a[32:35], v2, s[8:11], s45 offen offset:0 sc1
    s_add_u32 s45, s44, 49152
    buffer_load_dwordx4 a[36:39], v2, s[8:11], s45 offen offset:1024 sc1
    s_add_u32 s45, s44, 49152
    buffer_load_dwordx4 a[40:43], v2, s[8:11], s45 offen offset:2048 sc1
    s_add_u32 s45, s44, 49152
    buffer_load_dwordx4 a[44:47], v2, s[8:11], s45 offen offset:3072 sc1
    s_add_u32 s45, s44, 53248
    buffer_load_dwordx4 a[48:51], v2, s[8:11], s45 offen offset:0 sc1
    s_add_u32 s45, s44, 53248
    buffer_load_dwordx4 a[52:55], v2, s[8:11], s45 offen offset:1024 sc1
    ds_read_b128 v[68:71], v10 offset:5120
    s_waitcnt lgkmcnt(5)
    v_mfma_f32_16x16x32_bf16 v[32:35], v[72:75], a[0:3], v[32:35]
    ds_read_b128 v[72:75], v10 offset:6144
    s_waitcnt lgkmcnt(5)
    v_mfma_f32_16x16x32_bf16 v[36:39], v[76:79], a[0:3], v[36:39]
    ds_read_b128 v[76:79], v10 offset:7168
    s_waitcnt lgkmcnt(5)
    v_mfma_f32_16x16x32_bf16 v[40:43], v[80:83], a[0:3], v[40:43]
    ds_read_b128 v[80:83], v10 offset:8192
    s_waitcnt lgkmcnt(5)
    v_mfma_f32_16x16x32_bf16 v[44:47], v[84:87], a[0:3], v[44:47]
    ds_read_b128 v[84:87], v10 offset:9216
    s_waitcnt lgkmcnt(5)
    v_mfma_f32_16x16x32_bf16 v[48:51], v[64:67], a[0:3], v[48:51]
    ds_read_b128 v[64:67], v10 offset:10240
    s_waitcnt lgkmcnt(5)
    v_mfma_f32_16x16x32_bf16 v[32:35], v[68:71], a[4:7], v[32:35]
    ds_read_b128 v[68:71], v10 offset:11264
    s_waitcnt lgkmcnt(5)
    v_mfma_f32_16x16x32_bf16 v[36:39], v[72:75], a[4:7], v[36:39]
    ds_read_b128 v[72:75], v10 offset:12288
    s_waitcnt lgkmcnt(5)
    v_mfma_f32_16x16x32_bf16 v[40:43], v[76:79], a[4:7], v[40:43]
    ds_read_b128 v[76:79], v10 offset:13312
    s_waitcnt lgkmcnt(5)
    v_mfma_f32_16x16x32_bf16 v[44:47], v[80:83], a[4:7], v[44:47]
    ds_read_b128 v[80:83], v10 offset:14336
    s_waitcnt lgkmcnt(5)
    v_mfma_f32_16x16x32_bf16 v[48:51], v[84:87], a[4:7], v[48:51]
    ds_read_b128 v[84:87], v10 offset:15360
    s_waitcnt lgkmcnt(5)
    v_mfma_f32_16x16x32_bf16 v[32:35], v[64:67], a[8:11], v[32:35]
    ds_read_b128 v[64:67], v10 offset:16384
    s_waitcnt lgkmcnt(5)
    v_mfma_f32_16x16x32_bf16 v[36:39], v[68:71], a[8:11], v[36:39]
    ds_read_b128 v[68:71], v10 offset:17408
    s_waitcnt lgkmcnt(5)
    v_mfma_f32_16x16x32_bf16 v[40:43], v[72:75], a[8:11], v[40:43]
    ds_read_b128 v[72:75], v10 offset:18432
    s_waitcnt lgkmcnt(5)
    v_mfma_f32_16x16x32_bf16 v[44:47], v[76:79], a[8:11], v[44:47]
    ds_read_b128 v[76:79], v10 offset:19456
    s_waitcnt lgkmcnt(5)
    v_mfma_f32_16x16x32_bf16 v[48:51], v[80:83], a[8:11], v[48:51]
    s_waitcnt lgkmcnt(4)
    v_mfma_f32_16x16x32_bf16 v[32:35], v[84:87], a[12:15], v[32:35]
    s_waitcnt lgkmcnt(3)
    v_mfma_f32_16x16x32_bf16 v[36:39], v[64:67], a[12:15], v[36:39]
    s_waitcnt lgkmcnt(2)
    v_mfma_f32_16x16x32_bf16 v[40:43], v[68:71], a[12:15], v[40:43]
    s_waitcnt lgkmcnt(1)
    v_mfma_f32_16x16x32_bf16 v[44:47], v[72:75], a[12:15], v[44:47]
    s_waitcnt lgkmcnt(0)
    v_mfma_f32_16x16x32_bf16 v[48:51], v[76:79], a[12:15], v[48:51]
    s_barrier
    ds_read_b128 v[80:83], v10 offset:20480
    ds_read_b128 v[84:87], v10 offset:21504
    ds_read_b128 v[64:67], v10 offset:22528
    ds_read_b128 v[68:71], v10 offset:23552
    ds_read_b128 v[72:75], v10 offset:24576
    ds_read_b128 v[76:79], v10 offset:25600
    s_waitcnt lgkmcnt(5)
    v_mfma_f32_16x16x32_bf16 v[32:35], v[80:83], a[16:19], v[32:35]
    ds_read_b128 v[80:83], v10 offset:26624
    s_waitcnt lgkmcnt(5)
    v_mfma_f32_16x16x32_bf16 v[36:39], v[84:87], a[16:19], v[36:39]
    ds_read_b128 v[84:87], v10 offset:27648
    s_waitcnt lgkmcnt(5)
    v_mfma_f32_16x16x32_bf16 v[40:43], v[64:67], a[16:19], v[40:43]
    ds_read_b128 v[64:67], v10 offset:28672
    s_waitcnt lgkmcnt(5)
    v_mfma_f32_16x16x32_bf16 v[44:47], v[68:71], a[16:19], v[44:47]
    ds_read_b128 v[68:71], v10 offset:29696
    s_waitcnt lgkmcnt(5)
    v_mfma_f32_16x16x32_bf16 v[48:51], v[72:75], a[16:19], v[48:51]
    ds_read_b128 v[72:75], v10 offset:30720
    s_waitcnt lgkmcnt(5)
    v_mfma_f32_16x16x32_bf16 v[32:35], v[76:79], a[20:23], v[32:35]
    ds_read_b128 v[76:79], v10 offset:31744
    s_waitcnt lgkmcnt(5)
    v_mfma_f32_16x16x32_bf16 v[36:39], v[80:83], a[20:23], v[36:39]
    ds_read_b128 v[80:83], v10 offset:32768
    s_waitcnt lgkmcnt(5)
    v_mfma_f32_16x16x32_bf16 v[40:43], v[84:87], a[20:23], v[40:43]
    ds_read_b128 v[84:87], v10 offset:33792
    s_waitcnt lgkmcnt(5)
    v_mfma_f32_16x16x32_bf16 v[44:47], v[64:67], a[20:23], v[44:47]
    ds_read_b128 v[64:67], v10 offset:34816
    s_waitcnt lgkmcnt(5)
    v_mfma_f32_16x16x32_bf16 v[48:51], v[68:71], a[20:23], v[48:51]
    s_waitcnt vmcnt(7)
    ds_read_b128 v[68:71], v10 offset:35840
    s_waitcnt lgkmcnt(5)
    v_mfma_f32_16x16x32_bf16 v[32:35], v[72:75], a[24:27], v[32:35]
    ds_read_b128 v[72:75], v10 offset:36864
    s_waitcnt lgkmcnt(5)
    v_mfma_f32_16x16x32_bf16 v[36:39], v[76:79], a[24:27], v[36:39]
    ds_read_b128 v[76:79], v10 offset:37888
    s_waitcnt lgkmcnt(5)
    v_mfma_f32_16x16x32_bf16 v[40:43], v[80:83], a[24:27], v[40:43]
    ds_read_b128 v[80:83], v10 offset:38912
    s_waitcnt lgkmcnt(5)
    v_mfma_f32_16x16x32_bf16 v[44:47], v[84:87], a[24:27], v[44:47]
    ds_read_b128 v[84:87], v10 offset:39936
    s_waitcnt lgkmcnt(5)
    v_mfma_f32_16x16x32_bf16 v[48:51], v[64:67], a[24:27], v[48:51]
    s_waitcnt vmcnt(6)
    ds_read_b128 v[64:67], v10 offset:40960
    s_waitcnt lgkmcnt(5)
    v_mfma_f32_16x16x32_bf16 v[32:35], v[68:71], a[28:31], v[32:35]
    ds_read_b128 v[68:71], v10 offset:41984
    s_waitcnt lgkmcnt(5)
    v_mfma_f32_16x16x32_bf16 v[36:39], v[72:75], a[28:31], v[36:39]
    ds_read_b128 v[72:75], v10 offset:43008
    s_waitcnt lgkmcnt(5)
    v_mfma_f32_16x16x32_bf16 v[40:43], v[76:79], a[28:31], v[40:43]
    ds_read_b128 v[76:79], v10 offset:44032
    s_waitcnt lgkmcnt(5)
    v_mfma_f32_16x16x32_bf16 v[44:47], v[80:83], a[28:31], v[44:47]
    ds_read_b128 v[80:83], v10 offset:45056
    s_waitcnt lgkmcnt(5)
    v_mfma_f32_16x16x32_bf16 v[48:51], v[84:87], a[28:31], v[48:51]
    s_waitcnt vmcnt(5)
    ds_read_b128 v[84:87], v10 offset:46080
    s_waitcnt lgkmcnt(5)
    v_mfma_f32_16x16x32_bf16 v[32:35], v[64:67], a[32:35], v[32:35]
    ds_read_b128 v[64:67], v10 offset:47104
    s_waitcnt lgkmcnt(5)
    v_mfma_f32_16x16x32_bf16 v[36:39], v[68:71], a[32:35], v[36:39]
    ds_read_b128 v[68:71], v10 offset:48128
    s_waitcnt lgkmcnt(5)
    v_mfma_f32_16x16x32_bf16 v[40:43], v[72:75], a[32:35], v[40:43]
    ds_read_b128 v[72:75], v10 offset:49152
    s_waitcnt lgkmcnt(5)
    v_mfma_f32_16x16x32_bf16 v[44:47], v[76:79], a[32:35], v[44:47]
    ds_read_b128 v[76:79], v10 offset:50176
    s_waitcnt lgkmcnt(5)
    v_mfma_f32_16x16x32_bf16 v[48:51], v[80:83], a[32:35], v[48:51]
    s_waitcnt vmcnt(4)
    ds_read_b128 v[80:83], v10 offset:51200
    s_waitcnt lgkmcnt(5)
    v_mfma_f32_16x16x32_bf16 v[32:35], v[84:87], a[36:39], v[32:35]
    ds_read_b128 v[84:87], v10 offset:52224
    s_waitcnt lgkmcnt(5)
    v_mfma_f32_16x16x32_bf16 v[36:39], v[64:67], a[36:39], v[36:39]
    ds_read_b128 v[64:67], v10 offset:53248
    s_waitcnt lgkmcnt(5)
    v_mfma_f32_16x16x32_bf16 v[40:43], v[68:71], a[36:39], v[40:43]
    ds_read_b128 v[68:71], v10 offset:54272
    s_waitcnt lgkmcnt(5)
    v_mfma_f32_16x16x32_bf16 v[44:47], v[72:75], a[36:39], v[44:47]
    ds_read_b128 v[72:75], v10 offset:55296
    s_waitcnt lgkmcnt(5)
    v_mfma_f32_16x16x32_bf16 v[48:51], v[76:79], a[36:39], v[48:51]
    s_waitcnt vmcnt(3)
    ds_read_b128 v[76:79], v10 offset:56320
    s_waitcnt lgkmcnt(5)
    v_mfma_f32_16x16x32_bf16 v[32:35], v[80:83], a[40:43], v[32:35]
    ds_read_b128 v[80:83], v10 offset:57344
    s_waitcnt lgkmcnt(5)
    v_mfma_f32_16x16x32_bf16 v[36:39], v[84:87], a[40:43], v[36:39]
    ds_read_b128 v[84:87], v10 offset:58368
    s_waitcnt lgkmcnt(5)
    v_mfma_f32_16x16x32_bf16 v[40:43], v[64:67], a[40:43], v[40:43]
    ds_read_b128 v[64:67], v10 offset:59392
    s_waitcnt lgkmcnt(5)
    v_mfma_f32_16x16x32_bf16 v[44:47], v[68:71], a[40:43], v[44:47]
    ds_read_b128 v[68:71], v10 offset:60416
    s_waitcnt lgkmcnt(5)
    v_mfma_f32_16x16x32_bf16 v[48:51], v[72:75], a[40:43], v[48:51]
    s_waitcnt vmcnt(2)
    ds_read_b128 v[72:75], v11 offset:0
    s_waitcnt lgkmcnt(5)
    v_mfma_f32_16x16x32_bf16 v[32:35], v[76:79], a[44:47], v[32:35]
    ds_read_b128 v[76:79], v11 offset:1024
    s_waitcnt lgkmcnt(5)
    v_mfma_f32_16x16x32_bf16 v[36:39], v[80:83], a[44:47], v[36:39]
    ds_read_b128 v[80:83], v11 offset:2048
    s_waitcnt lgkmcnt(5)
    v_mfma_f32_16x16x32_bf16 v[40:43], v[84:87], a[44:47], v[40:43]
    ds_read_b128 v[84:87], v11 offset:3072
    s_waitcnt lgkmcnt(5)
    v_mfma_f32_16x16x32_bf16 v[44:47], v[64:67], a[44:47], v[44:47]
    ds_read_b128 v[64:67], v11 offset:4096
    s_waitcnt lgkmcnt(5)
    v_mfma_f32_16x16x32_bf16 v[48:51], v[68:71], a[44:47], v[48:51]
    s_waitcnt vmcnt(1)
    ds_read_b128 v[68:71], v11 offset:5120
    s_waitcnt lgkmcnt(5)
    v_mfma_f32_16x16x32_bf16 v[32:35], v[72:75], a[48:51], v[32:35]
    ds_read_b128 v[72:75], v11 offset:6144
    s_waitcnt lgkmcnt(5)
    v_mfma_f32_16x16x32_bf16 v[36:39], v[76:79], a[48:51], v[36:39]
    ds_read_b128 v[76:79], v11 offset:7168
    s_waitcnt lgkmcnt(5)
    v_mfma_f32_16x16x32_bf16 v[40:43], v[80:83], a[48:51], v[40:43]
    ds_read_b128 v[80:83], v11 offset:8192
    s_waitcnt lgkmcnt(5)
    v_mfma_f32_16x16x32_bf16 v[44:47], v[84:87], a[48:51], v[44:47]
    ds_read_b128 v[84:87], v11 offset:9216
    s_waitcnt lgkmcnt(5)
    v_mfma_f32_16x16x32_bf16 v[48:51], v[64:67], a[48:51], v[48:51]
    s_waitcnt vmcnt(0)
    s_waitcnt lgkmcnt(4)
    v_mfma_f32_16x16x32_bf16 v[32:35], v[68:71], a[52:55], v[32:35]
    s_waitcnt lgkmcnt(3)
    v_mfma_f32_16x16x32_bf16 v[36:39], v[72:75], a[52:55], v[36:39]
    s_waitcnt lgkmcnt(2)
    v_mfma_f32_16x16x32_bf16 v[40:43], v[76:79], a[52:55], v[40:43]
    s_waitcnt lgkmcnt(1)
    v_mfma_f32_16x16x32_bf16 v[44:47], v[80:83], a[52:55], v[44:47]
    s_waitcnt lgkmcnt(0)
    v_mfma_f32_16x16x32_bf16 v[48:51], v[84:87], a[52:55], v[48:51]
    s_nop 7
    v_lshlrev_b32 v16, 16, v112
    v_and_b32 v17, 0xffff0000, v112
    v_add_f32 v32, v32, v16
    v_add_f32 v33, v33, v17
    v_lshlrev_b32 v16, 16, v113
    v_and_b32 v17, 0xffff0000, v113
    v_add_f32 v34, v34, v16
    v_add_f32 v35, v35, v17
    v_lshlrev_b32 v16, 16, v114
    v_and_b32 v17, 0xffff0000, v114
    v_add_f32 v36, v36, v16
    v_add_f32 v37, v37, v17
    v_lshlrev_b32 v16, 16, v115
    v_and_b32 v17, 0xffff0000, v115
    v_add_f32 v38, v38, v16
    v_add_f32 v39, v39, v17
    v_lshlrev_b32 v16, 16, v116
    v_and_b32 v17, 0xffff0000, v116
    v_add_f32 v40, v40, v16
    v_add_f32 v41, v41, v17
    v_lshlrev_b32 v16, 16, v117
    v_and_b32 v17, 0xffff0000, v117
    v_add_f32 v42, v42, v16
    v_add_f32 v43, v43, v17
    v_lshlrev_b32 v16, 16, v118
    v_and_b32 v17, 0xffff0000, v118
    v_add_f32 v44, v44, v16
    v_add_f32 v45, v45, v17
    v_lshlrev_b32 v16, 16, v119
    v_and_b32 v17, 0xffff0000, v119
    v_add_f32 v46, v46, v16
    v_add_f32 v47, v47, v17
    v_lshlrev_b32 v16, 16, v120
    v_and_b32 v17, 0xffff0000, v120
    v_add_f32 v48, v48, v16
    v_add_f32 v49, v49, v17
    v_lshlrev_b32 v16, 16, v121
    v_and_b32 v17, 0xffff0000, v121
    v_add_f32 v50, v50, v16
    v_add_f32 v51, v51, v17
    v_cvt_pk_bf16_f32 v56, v32, v33
    v_cvt_pk_bf16_f32 v57, v34, v35
    v_cvt_pk_bf16_f32 v58, v36, v37
    v_cvt_pk_bf16_f32 v59, v38, v39
    v_cvt_pk_bf16_f32 v60, v40, v41
    v_cvt_pk_bf16_f32 v61, v42, v43
    v_cvt_pk_bf16_f32 v62, v44, v45
    v_cvt_pk_bf16_f32 v63, v46, v47
    v_cvt_pk_bf16_f32 v64, v48, v49
    v_cvt_pk_bf16_f32 v65, v50, v51
    s_movk_i32 s42, 1280
    v_mul_lo_u32 v8, v7, s42
    s_mul_i32 s42, s59, 160
    v_add_u32 v8, s42, v8
    s_sub_u32 s49, s3, 4
    s_mul_i32 s45, s49, 2560
    v_mul_u32_u24 v16, 0xa0, v5
    v_lshl_add_u32 v16, v6, 3, v16
    v_add_u32 v16, s45, v16
    ds_write_b64 v16, v[56:57] offset:0
    ds_write_b64 v16, v[58:59] offset:32
    ds_write_b64 v16, v[60:61] offset:64
    ds_write_b64 v16, v[62:63] offset:96
    ds_write_b64 v16, v[64:65] offset:128
    v_lshlrev_b32 v17, 4, v1
    v_add_u32 v17, s45, v17
    s_lshl_b32 s46, s58, 6
    s_lshl_b32 s47, s49, 4
    s_add_u32 s46, s46, s47
    s_mul_i32 s46, s46, 1280
    s_mul_i32 s47, s59, 160
    s_add_u32 s46, s46, s47
    v_add_u32 v18, 0, v1
    v_mul_u32_u24 v19, 0xcd, v18
    v_lshrrev_b32 v19, 11, v19
    v_mul_u32_u24 v20, 10, v19
    v_sub_u32 v20, v18, v20
    v_mul_u32_u24 v19, 0x500, v19
    v_lshl_add_u32 v21, v20, 4, v19
    v_add_u32 v18, 64, v1
    v_mul_u32_u24 v19, 0xcd, v18
    v_lshrrev_b32 v19, 11, v19
    v_mul_u32_u24 v20, 10, v19
    v_sub_u32 v20, v18, v20
    v_mul_u32_u24 v19, 0x500, v19
    v_lshl_add_u32 v22, v20, 4, v19
    v_add_u32 v18, 128, v1
    v_mul_u32_u24 v19, 0xcd, v18
    v_lshrrev_b32 v19, 11, v19
    v_mul_u32_u24 v20, 10, v19
    v_sub_u32 v20, v18, v20
    v_mul_u32_u24 v19, 0x500, v19
    v_lshl_add_u32 v23, v20, 4, v19
    v_mov_b32 v18, 0x80000000
    v_cmp_gt_u32 vcc, 32, v1
    s_waitcnt lgkmcnt(0)
    s_nop 0
    v_cndmask_b32 v23, v18, v23, vcc
    ds_read_b128 v[32:35], v17 offset:0
    ds_read_b128 v[36:39], v17 offset:1024
    ds_read_b128 v[40:43], v17 offset:2048
    s_waitcnt lgkmcnt(2)
    buffer_store_dwordx4 v[32:35], v21, s[4:7], s46 offen
    s_waitcnt lgkmcnt(1)
    buffer_store_dwordx4 v[36:39], v22, s[4:7], s46 offen
    s_waitcnt lgkmcnt(0)
    buffer_store_dwordx4 v[40:43], v23, s[4:7], s46 offen
    s_waitcnt vmcnt(0)
P_end:
    s_endpgm
.section .rodata,"a"
.p2align 6
.amdhsa_kernel sequential_preLN__sliding_local_dilated__glu_gated_bilinear__prompt_kernel
  .amdhsa_next_free_vgpr 256
  .amdhsa_next_free_sgpr 102
  .amdhsa_accum_offset 128
  .amdhsa_group_segment_fixed_size 0
  .amdhsa_kernarg_size 80
  .amdhsa_user_sgpr_count 2
  .amdhsa_user_sgpr_kernarg_segment_ptr 1
  .amdhsa_system_sgpr_workgroup_id_x 1
.end_amdhsa_kernel
```
